```python
import torch

def _softmax(x, axis=-1):
    return torch.softmax(x, dim=axis)
def _gelu(x):
    return torch.nn.functional.gelu(x, approximate="tanh")
def _silu(x):
    return torch.nn.functional.silu(x)
def _sigmoid(x):
    return torch.sigmoid(x)
def _layernorm(x, axis=-1, eps=1e-5):
    m = x.mean(dim=axis, keepdim=True)
    v = x.var(dim=axis, keepdim=True, unbiased=False)
    return (x - m) / torch.sqrt(v + eps)
def _scatter_add(tgt, idx, src, axis=0):
    return tgt.clone().index_add_(axis, idx, src)
def _segment_sum(src, seg, n):
    out = torch.zeros((n,) + src.shape[1:], dtype=src.dtype)
    return out.index_add_(0, seg, src)
def _pad(x, pw):
    flat = tuple(v for pair in reversed(pw) for v in pair)
    return torch.nn.functional.pad(x, flat)

kernel_name = 'sequential_preLN__softmax_full_mha__mixer_s_mlp__prompt'

def setup_inputs():

    _w = (lambda a: (lambda t: t.to(torch.bfloat16) if t.is_floating_point() else t)(torch.as_tensor(a)))
    def _A_setup():
        B, S, D = 1, 2048, 512
        return {
            "x": _w((lambda *s: torch.randn(*s, dtype=torch.bfloat16) * 0.05)(B, S, D)),
            "wqkv": _w((lambda *s: torch.randn(*s, dtype=torch.bfloat16) * 0.05)(D, 3 * D)),
            "wo": _w((lambda *s: torch.randn(*s, dtype=torch.bfloat16) * 0.05)(D, D)),
        }
    _A_in = _A_setup()

    def _B_setup():
        B, S, D, F = 1, 2048, 512, 1376
        return {
            "x":  _w((lambda *s: torch.randn(*s, dtype=torch.bfloat16) * 0.05)(B, S, D)),
            "w1": _w((lambda *s: torch.randn(*s, dtype=torch.bfloat16) * 3.2)(D, D) * (D ** -0.5)),
            "w2": _w((lambda *s: torch.randn(*s, dtype=torch.bfloat16) * 3.2)(D, D) * (D ** -0.5)),
            "w3": _w((lambda *s: torch.randn(*s, dtype=torch.bfloat16) * 3.2)(D, F) * (D ** -0.5)),
            "w4": _w((lambda *s: torch.randn(*s, dtype=torch.bfloat16) * 3.2)(F, D) * (F ** -0.5)),
        }
    _B_in = _B_setup()

    return {
        "A_x": _A_in["x"],
        "A_wqkv": _A_in["wqkv"],
        "A_wo": _A_in["wo"],
        "B_x": _B_in["x"],
        "B_w1": _B_in["w1"],
        "B_w2": _B_in["w2"],
        "B_w3": _B_in["w3"],
        "B_w4": _B_in["w4"],
    }

def reference(A_x, A_wqkv, A_wo, B_x, B_w1, B_w2, B_w3, B_w4):
    def _A_ref(x, wqkv, wo):
        B, S, D = x.shape
        H = 32; Dh = D // H
        qkv = (lambda x, *d: x.permute(*d))((x @ wqkv).reshape(B, S, 3, H, Dh), 2, 0, 3, 1, 4)
        q, k, v = qkv[0], qkv[1], qkv[2]
        scale = Dh ** -0.5
        scores = torch.einsum("bhqd,bhkd->bhqk", q, k) * scale
        p = _softmax(scores, axis=-1)
        o = torch.einsum("bhqk,bhkd->bhqd", p, v)
        return (lambda x, *d: x.permute(*d))(o, 0, 2, 1, 3).reshape(B, S, D) @ wo

    def _B_ref(x, w1, w2, w3, w4):
        B, S, D = x.shape
        h = _gelu(_layernorm(x, axis=-1) @ w1)
        c = D // 4
        g0 = _pad(h[:, :, 0*c:1*c], ((0, 0), (1, 0), (0, 0)))[:, :S, :]
        g1 = _pad(h[:, :, 1*c:2*c], ((0, 0), (0, 1), (0, 0)))[:, 1:, :]
        g2 = _pad(h[:, :, 2*c:3*c], ((0, 0), (2, 0), (0, 0)))[:, :S, :]
        g3 = _pad(h[:, :, 3*c:   ], ((0, 0), (0, 2), (0, 0)))[:, 2:, :]
        hs = torch.concatenate([g0, g1, g2, g3], axis=-1) @ w2
        x1 = x + hs
        h2 = _gelu(_layernorm(x1, axis=-1) @ w3) @ w4
        return x1 + h2

    x = A_x
    h = x + _A_ref(_layernorm(x, axis=-1), A_wqkv, A_wo)
    h2 = h + _B_ref(_layernorm(h, axis=-1), B_w1, B_w2, B_w3, B_w4)
    return h2
```

```asm
; @launch kernel=prep_kernel grid=(878,1,1) block=(256,1,1) lds=0
; @launch kernel=qkv_kernel grid=(192,1,1) block=(256,1,1) lds=0
; @launch kernel=attn_kernel grid=(512,1,1) block=(256,1,1) lds=0
; @launch kernel=wo_kernel grid=(256,1,1) block=(256,1,1) lds=0
; @launch kernel=ln2_kernel grid=(512,1,1) block=(256,1,1) lds=0
; @launch kernel=w1_kernel grid=(256,1,1) block=(256,1,1) lds=0
; @launch kernel=w2_kernel grid=(256,1,1) block=(256,1,1) lds=0
; @launch kernel=ln3_kernel grid=(512,1,1) block=(256,1,1) lds=0
; @launch kernel=w3_kernel grid=(176,1,1) block=(256,1,1) lds=0
; @launch kernel=w4_kernel grid=(256,1,1) block=(256,1,1) lds=0
.amdgcn_target "amdgcn-amd-amdhsa--gfx950"
.text
.globl prep_kernel
.p2align 8
.type prep_kernel,@function
prep_kernel:
    s_load_dwordx16 s[64:79], s[0:1], 0
    s_load_dwordx4 s[80:83], s[0:1], 64
    s_load_dwordx2 s[84:85], s[0:1], 80
    v_lshrrev_b32 v1, 6, v0
    s_nop 1
    v_readfirstlane_b32 s20, v1
    s_lshl_b32 s3, s2, 2
    s_add_u32 s20, s20, s3
    s_cmp_ge_u32 s20, 3512
    s_cbranch_scc1 L_end_prep_kernel
    v_and_b32 v0, 63, v0
    s_cmp_ge_u32 s20, 384
    s_cbranch_scc1 L_prep_next0
    s_sub_u32 s21, s20, 0
    s_lshr_b32 s22, s21, 4
    s_and_b32 s23, s21, 15
    s_waitcnt lgkmcnt(0)
    s_add_u32 s4, s66, 0x0
    s_addc_u32 s5, s67, 0
    s_mov_b32 s6, 0x180000
    s_mov_b32 s7, 0x00020000
    s_waitcnt lgkmcnt(0)
    s_add_u32 s8, s84, 0x0
    s_addc_u32 s9, s85, 0
    s_mov_b32 s10, 0x180000
    s_mov_b32 s11, 0x00020000
    s_lshl_b32 s22, s22, 6
    v_add_u32 v2, s22, v0
    s_mov_b32 s25, 1536
    v_cmp_gt_u32 vcc, s25, v2
    s_and_saveexec_b64 s[26:27], vcc
    s_cbranch_execz L_end_prep_kernel
    s_mul_i32 s24, s23, 98304
    v_lshlrev_b32 v3, 1, v2
    v_add_u32 v3, s24, v3
    buffer_load_ushort v10, v3, s[4:7], 0 offen offset:0
    buffer_load_ushort v11, v3, s[4:7], 0 offen offset:3072
    s_mov_b32 s28, 6144
    buffer_load_ushort v12, v3, s[4:7], s28 offen
    s_mov_b32 s28, 9216
    buffer_load_ushort v13, v3, s[4:7], s28 offen
    s_mov_b32 s28, 12288
    buffer_load_ushort v14, v3, s[4:7], s28 offen
    s_mov_b32 s28, 15360
    buffer_load_ushort v15, v3, s[4:7], s28 offen
    s_mov_b32 s28, 18432
    buffer_load_ushort v16, v3, s[4:7], s28 offen
    s_mov_b32 s28, 21504
    buffer_load_ushort v17, v3, s[4:7], s28 offen
    s_mov_b32 s28, 24576
    buffer_load_ushort v18, v3, s[4:7], s28 offen
    s_mov_b32 s28, 27648
    buffer_load_ushort v19, v3, s[4:7], s28 offen
    s_mov_b32 s28, 30720
    buffer_load_ushort v20, v3, s[4:7], s28 offen
    s_mov_b32 s28, 33792
    buffer_load_ushort v21, v3, s[4:7], s28 offen
    s_mov_b32 s28, 36864
    buffer_load_ushort v22, v3, s[4:7], s28 offen
    s_mov_b32 s28, 39936
    buffer_load_ushort v23, v3, s[4:7], s28 offen
    s_mov_b32 s28, 43008
    buffer_load_ushort v24, v3, s[4:7], s28 offen
    s_mov_b32 s28, 46080
    buffer_load_ushort v25, v3, s[4:7], s28 offen
    s_mov_b32 s28, 49152
    buffer_load_ushort v26, v3, s[4:7], s28 offen
    s_mov_b32 s28, 52224
    buffer_load_ushort v27, v3, s[4:7], s28 offen
    s_mov_b32 s28, 55296
    buffer_load_ushort v28, v3, s[4:7], s28 offen
    s_mov_b32 s28, 58368
    buffer_load_ushort v29, v3, s[4:7], s28 offen
    s_mov_b32 s28, 61440
    buffer_load_ushort v30, v3, s[4:7], s28 offen
    s_mov_b32 s28, 64512
    buffer_load_ushort v31, v3, s[4:7], s28 offen
    s_mov_b32 s28, 67584
    buffer_load_ushort v32, v3, s[4:7], s28 offen
    s_mov_b32 s28, 70656
    buffer_load_ushort v33, v3, s[4:7], s28 offen
    s_mov_b32 s28, 73728
    buffer_load_ushort v34, v3, s[4:7], s28 offen
    s_mov_b32 s28, 76800
    buffer_load_ushort v35, v3, s[4:7], s28 offen
    s_mov_b32 s28, 79872
    buffer_load_ushort v36, v3, s[4:7], s28 offen
    s_mov_b32 s28, 82944
    buffer_load_ushort v37, v3, s[4:7], s28 offen
    s_mov_b32 s28, 86016
    buffer_load_ushort v38, v3, s[4:7], s28 offen
    s_mov_b32 s28, 89088
    buffer_load_ushort v39, v3, s[4:7], s28 offen
    s_mov_b32 s28, 92160
    buffer_load_ushort v40, v3, s[4:7], s28 offen
    s_mov_b32 s28, 95232
    buffer_load_ushort v41, v3, s[4:7], s28 offen
    s_waitcnt vmcnt(0)
    v_lshl_or_b32 v50, v11, 16, v10
    v_lshl_or_b32 v51, v13, 16, v12
    v_lshl_or_b32 v52, v15, 16, v14
    v_lshl_or_b32 v53, v17, 16, v16
    v_lshl_or_b32 v54, v19, 16, v18
    v_lshl_or_b32 v55, v21, 16, v20
    v_lshl_or_b32 v56, v23, 16, v22
    v_lshl_or_b32 v57, v25, 16, v24
    v_lshl_or_b32 v58, v27, 16, v26
    v_lshl_or_b32 v59, v29, 16, v28
    v_lshl_or_b32 v60, v31, 16, v30
    v_lshl_or_b32 v61, v33, 16, v32
    v_lshl_or_b32 v62, v35, 16, v34
    v_lshl_or_b32 v63, v37, 16, v36
    v_lshl_or_b32 v64, v39, 16, v38
    v_lshl_or_b32 v65, v41, 16, v40
    s_lshl_b32 s24, s23, 5
    v_mov_b32 v5, s24
    v_add_u32 v5, 0, v5
    v_lshrrev_b32 v6, 5, v2
    s_mov_b32 s36, 32
    v_mul_lo_u32 v6, v6, s36
    v_lshrrev_b32 v7, 4, v5
    v_add_u32 v6, v6, v7
    v_lshlrev_b32 v4, 10, v6
    v_and_b32 v6, 31, v2
    v_lshlrev_b32 v6, 4, v6
    v_add_u32 v4, v4, v6
    v_lshrrev_b32 v6, 3, v5
    v_and_b32 v6, 1, v6
    v_lshlrev_b32 v6, 9, v6
    v_add_u32 v4, v4, v6
    v_and_b32 v6, 7, v5
    v_lshlrev_b32 v6, 1, v6
    v_add_u32 v4, v4, v6
    buffer_store_dwordx4 v[50:53], v4, s[8:11], 0 offen
    v_mov_b32 v5, s24
    v_add_u32 v5, 8, v5
    v_lshrrev_b32 v6, 5, v2
    s_mov_b32 s36, 32
    v_mul_lo_u32 v6, v6, s36
    v_lshrrev_b32 v7, 4, v5
    v_add_u32 v6, v6, v7
    v_lshlrev_b32 v4, 10, v6
    v_and_b32 v6, 31, v2
    v_lshlrev_b32 v6, 4, v6
    v_add_u32 v4, v4, v6
    v_lshrrev_b32 v6, 3, v5
    v_and_b32 v6, 1, v6
    v_lshlrev_b32 v6, 9, v6
    v_add_u32 v4, v4, v6
    v_and_b32 v6, 7, v5
    v_lshlrev_b32 v6, 1, v6
    v_add_u32 v4, v4, v6
    buffer_store_dwordx4 v[54:57], v4, s[8:11], 0 offen
    v_mov_b32 v5, s24
    v_add_u32 v5, 16, v5
    v_lshrrev_b32 v6, 5, v2
    s_mov_b32 s36, 32
    v_mul_lo_u32 v6, v6, s36
    v_lshrrev_b32 v7, 4, v5
    v_add_u32 v6, v6, v7
    v_lshlrev_b32 v4, 10, v6
    v_and_b32 v6, 31, v2
    v_lshlrev_b32 v6, 4, v6
    v_add_u32 v4, v4, v6
    v_lshrrev_b32 v6, 3, v5
    v_and_b32 v6, 1, v6
    v_lshlrev_b32 v6, 9, v6
    v_add_u32 v4, v4, v6
    v_and_b32 v6, 7, v5
    v_lshlrev_b32 v6, 1, v6
    v_add_u32 v4, v4, v6
    buffer_store_dwordx4 v[58:61], v4, s[8:11], 0 offen
    v_mov_b32 v5, s24
    v_add_u32 v5, 24, v5
    v_lshrrev_b32 v6, 5, v2
    s_mov_b32 s36, 32
    v_mul_lo_u32 v6, v6, s36
    v_lshrrev_b32 v7, 4, v5
    v_add_u32 v6, v6, v7
    v_lshlrev_b32 v4, 10, v6
    v_and_b32 v6, 31, v2
    v_lshlrev_b32 v6, 4, v6
    v_add_u32 v4, v4, v6
    v_lshrrev_b32 v6, 3, v5
    v_and_b32 v6, 1, v6
    v_lshlrev_b32 v6, 9, v6
    v_add_u32 v4, v4, v6
    v_and_b32 v6, 7, v5
    v_lshlrev_b32 v6, 1, v6
    v_add_u32 v4, v4, v6
    buffer_store_dwordx4 v[62:65], v4, s[8:11], 0 offen
    s_branch L_end_prep_kernel
L_prep_next0:
    s_cmp_ge_u32 s20, 512
    s_cbranch_scc1 L_prep_next1
    s_sub_u32 s21, s20, 384
    s_lshr_b32 s22, s21, 4
    s_and_b32 s23, s21, 15
    s_waitcnt lgkmcnt(0)
    s_add_u32 s4, s68, 0x0
    s_addc_u32 s5, s69, 0
    s_mov_b32 s6, 0x80000
    s_mov_b32 s7, 0x00020000
    s_waitcnt lgkmcnt(0)
    s_add_u32 s8, s84, 0x180000
    s_addc_u32 s9, s85, 0
    s_mov_b32 s10, 0x80000
    s_mov_b32 s11, 0x00020000
    s_lshl_b32 s22, s22, 6
    v_add_u32 v2, s22, v0
    s_mov_b32 s25, 512
    v_cmp_gt_u32 vcc, s25, v2
    s_and_saveexec_b64 s[26:27], vcc
    s_cbranch_execz L_end_prep_kernel
    s_mul_i32 s24, s23, 32768
    v_lshlrev_b32 v3, 1, v2
    v_add_u32 v3, s24, v3
    buffer_load_ushort v10, v3, s[4:7], 0 offen offset:0
    buffer_load_ushort v11, v3, s[4:7], 0 offen offset:1024
    buffer_load_ushort v12, v3, s[4:7], 0 offen offset:2048
    buffer_load_ushort v13, v3, s[4:7], 0 offen offset:3072
    s_mov_b32 s28, 4096
    buffer_load_ushort v14, v3, s[4:7], s28 offen
    s_mov_b32 s28, 5120
    buffer_load_ushort v15, v3, s[4:7], s28 offen
    s_mov_b32 s28, 6144
    buffer_load_ushort v16, v3, s[4:7], s28 offen
    s_mov_b32 s28, 7168
    buffer_load_ushort v17, v3, s[4:7], s28 offen
    s_mov_b32 s28, 8192
    buffer_load_ushort v18, v3, s[4:7], s28 offen
    s_mov_b32 s28, 9216
    buffer_load_ushort v19, v3, s[4:7], s28 offen
    s_mov_b32 s28, 10240
    buffer_load_ushort v20, v3, s[4:7], s28 offen
    s_mov_b32 s28, 11264
    buffer_load_ushort v21, v3, s[4:7], s28 offen
    s_mov_b32 s28, 12288
    buffer_load_ushort v22, v3, s[4:7], s28 offen
    s_mov_b32 s28, 13312
    buffer_load_ushort v23, v3, s[4:7], s28 offen
    s_mov_b32 s28, 14336
    buffer_load_ushort v24, v3, s[4:7], s28 offen
    s_mov_b32 s28, 15360
    buffer_load_ushort v25, v3, s[4:7], s28 offen
    s_mov_b32 s28, 16384
    buffer_load_ushort v26, v3, s[4:7], s28 offen
    s_mov_b32 s28, 17408
    buffer_load_ushort v27, v3, s[4:7], s28 offen
    s_mov_b32 s28, 18432
    buffer_load_ushort v28, v3, s[4:7], s28 offen
    s_mov_b32 s28, 19456
    buffer_load_ushort v29, v3, s[4:7], s28 offen
    s_mov_b32 s28, 20480
    buffer_load_ushort v30, v3, s[4:7], s28 offen
    s_mov_b32 s28, 21504
    buffer_load_ushort v31, v3, s[4:7], s28 offen
    s_mov_b32 s28, 22528
    buffer_load_ushort v32, v3, s[4:7], s28 offen
    s_mov_b32 s28, 23552
    buffer_load_ushort v33, v3, s[4:7], s28 offen
    s_mov_b32 s28, 24576
    buffer_load_ushort v34, v3, s[4:7], s28 offen
    s_mov_b32 s28, 25600
    buffer_load_ushort v35, v3, s[4:7], s28 offen
    s_mov_b32 s28, 26624
    buffer_load_ushort v36, v3, s[4:7], s28 offen
    s_mov_b32 s28, 27648
    buffer_load_ushort v37, v3, s[4:7], s28 offen
    s_mov_b32 s28, 28672
    buffer_load_ushort v38, v3, s[4:7], s28 offen
    s_mov_b32 s28, 29696
    buffer_load_ushort v39, v3, s[4:7], s28 offen
    s_mov_b32 s28, 30720
    buffer_load_ushort v40, v3, s[4:7], s28 offen
    s_mov_b32 s28, 31744
    buffer_load_ushort v41, v3, s[4:7], s28 offen
    s_waitcnt vmcnt(0)
    v_lshl_or_b32 v50, v11, 16, v10
    v_lshl_or_b32 v51, v13, 16, v12
    v_lshl_or_b32 v52, v15, 16, v14
    v_lshl_or_b32 v53, v17, 16, v16
    v_lshl_or_b32 v54, v19, 16, v18
    v_lshl_or_b32 v55, v21, 16, v20
    v_lshl_or_b32 v56, v23, 16, v22
    v_lshl_or_b32 v57, v25, 16, v24
    v_lshl_or_b32 v58, v27, 16, v26
    v_lshl_or_b32 v59, v29, 16, v28
    v_lshl_or_b32 v60, v31, 16, v30
    v_lshl_or_b32 v61, v33, 16, v32
    v_lshl_or_b32 v62, v35, 16, v34
    v_lshl_or_b32 v63, v37, 16, v36
    v_lshl_or_b32 v64, v39, 16, v38
    v_lshl_or_b32 v65, v41, 16, v40
    s_lshl_b32 s24, s23, 5
    v_mov_b32 v5, s24
    v_add_u32 v5, 0, v5
    v_lshrrev_b32 v6, 5, v2
    s_mov_b32 s36, 32
    v_mul_lo_u32 v6, v6, s36
    v_lshrrev_b32 v7, 4, v5
    v_add_u32 v6, v6, v7
    v_lshlrev_b32 v4, 10, v6
    v_and_b32 v6, 31, v2
    v_lshlrev_b32 v6, 4, v6
    v_add_u32 v4, v4, v6
    v_lshrrev_b32 v6, 3, v5
    v_and_b32 v6, 1, v6
    v_lshlrev_b32 v6, 9, v6
    v_add_u32 v4, v4, v6
    v_and_b32 v6, 7, v5
    v_lshlrev_b32 v6, 1, v6
    v_add_u32 v4, v4, v6
    buffer_store_dwordx4 v[50:53], v4, s[8:11], 0 offen
    v_mov_b32 v5, s24
    v_add_u32 v5, 8, v5
    v_lshrrev_b32 v6, 5, v2
    s_mov_b32 s36, 32
    v_mul_lo_u32 v6, v6, s36
    v_lshrrev_b32 v7, 4, v5
    v_add_u32 v6, v6, v7
    v_lshlrev_b32 v4, 10, v6
    v_and_b32 v6, 31, v2
    v_lshlrev_b32 v6, 4, v6
    v_add_u32 v4, v4, v6
    v_lshrrev_b32 v6, 3, v5
    v_and_b32 v6, 1, v6
    v_lshlrev_b32 v6, 9, v6
    v_add_u32 v4, v4, v6
    v_and_b32 v6, 7, v5
    v_lshlrev_b32 v6, 1, v6
    v_add_u32 v4, v4, v6
    buffer_store_dwordx4 v[54:57], v4, s[8:11], 0 offen
    v_mov_b32 v5, s24
    v_add_u32 v5, 16, v5
    v_lshrrev_b32 v6, 5, v2
    s_mov_b32 s36, 32
    v_mul_lo_u32 v6, v6, s36
    v_lshrrev_b32 v7, 4, v5
    v_add_u32 v6, v6, v7
    v_lshlrev_b32 v4, 10, v6
    v_and_b32 v6, 31, v2
    v_lshlrev_b32 v6, 4, v6
    v_add_u32 v4, v4, v6
    v_lshrrev_b32 v6, 3, v5
    v_and_b32 v6, 1, v6
    v_lshlrev_b32 v6, 9, v6
    v_add_u32 v4, v4, v6
    v_and_b32 v6, 7, v5
    v_lshlrev_b32 v6, 1, v6
    v_add_u32 v4, v4, v6
    buffer_store_dwordx4 v[58:61], v4, s[8:11], 0 offen
    v_mov_b32 v5, s24
    v_add_u32 v5, 24, v5
    v_lshrrev_b32 v6, 5, v2
    s_mov_b32 s36, 32
    v_mul_lo_u32 v6, v6, s36
    v_lshrrev_b32 v7, 4, v5
    v_add_u32 v6, v6, v7
    v_lshlrev_b32 v4, 10, v6
    v_and_b32 v6, 31, v2
    v_lshlrev_b32 v6, 4, v6
    v_add_u32 v4, v4, v6
    v_lshrrev_b32 v6, 3, v5
    v_and_b32 v6, 1, v6
    v_lshlrev_b32 v6, 9, v6
    v_add_u32 v4, v4, v6
    v_and_b32 v6, 7, v5
    v_lshlrev_b32 v6, 1, v6
    v_add_u32 v4, v4, v6
    buffer_store_dwordx4 v[62:65], v4, s[8:11], 0 offen
    s_branch L_end_prep_kernel
L_prep_next1:
    s_cmp_ge_u32 s20, 640
    s_cbranch_scc1 L_prep_next2
    s_sub_u32 s21, s20, 512
    s_lshr_b32 s22, s21, 4
    s_and_b32 s23, s21, 15
    s_waitcnt lgkmcnt(0)
    s_add_u32 s4, s72, 0x0
    s_addc_u32 s5, s73, 0
    s_mov_b32 s6, 0x80000
    s_mov_b32 s7, 0x00020000
    s_waitcnt lgkmcnt(0)
    s_add_u32 s8, s84, 0x200000
    s_addc_u32 s9, s85, 0
    s_mov_b32 s10, 0x80000
    s_mov_b32 s11, 0x00020000
    s_lshl_b32 s22, s22, 6
    v_add_u32 v2, s22, v0
    s_mov_b32 s25, 512
    v_cmp_gt_u32 vcc, s25, v2
    s_and_saveexec_b64 s[26:27], vcc
    s_cbranch_execz L_end_prep_kernel
    s_mul_i32 s24, s23, 32768
    v_lshlrev_b32 v3, 1, v2
    v_add_u32 v3, s24, v3
    buffer_load_ushort v10, v3, s[4:7], 0 offen offset:0
    buffer_load_ushort v11, v3, s[4:7], 0 offen offset:1024
    buffer_load_ushort v12, v3, s[4:7], 0 offen offset:2048
    buffer_load_ushort v13, v3, s[4:7], 0 offen offset:3072
    s_mov_b32 s28, 4096
    buffer_load_ushort v14, v3, s[4:7], s28 offen
    s_mov_b32 s28, 5120
    buffer_load_ushort v15, v3, s[4:7], s28 offen
    s_mov_b32 s28, 6144
    buffer_load_ushort v16, v3, s[4:7], s28 offen
    s_mov_b32 s28, 7168
    buffer_load_ushort v17, v3, s[4:7], s28 offen
    s_mov_b32 s28, 8192
    buffer_load_ushort v18, v3, s[4:7], s28 offen
    s_mov_b32 s28, 9216
    buffer_load_ushort v19, v3, s[4:7], s28 offen
    s_mov_b32 s28, 10240
    buffer_load_ushort v20, v3, s[4:7], s28 offen
    s_mov_b32 s28, 11264
    buffer_load_ushort v21, v3, s[4:7], s28 offen
    s_mov_b32 s28, 12288
    buffer_load_ushort v22, v3, s[4:7], s28 offen
    s_mov_b32 s28, 13312
    buffer_load_ushort v23, v3, s[4:7], s28 offen
    s_mov_b32 s28, 14336
    buffer_load_ushort v24, v3, s[4:7], s28 offen
    s_mov_b32 s28, 15360
    buffer_load_ushort v25, v3, s[4:7], s28 offen
    s_mov_b32 s28, 16384
    buffer_load_ushort v26, v3, s[4:7], s28 offen
    s_mov_b32 s28, 17408
    buffer_load_ushort v27, v3, s[4:7], s28 offen
    s_mov_b32 s28, 18432
    buffer_load_ushort v28, v3, s[4:7], s28 offen
    s_mov_b32 s28, 19456
    buffer_load_ushort v29, v3, s[4:7], s28 offen
    s_mov_b32 s28, 20480
    buffer_load_ushort v30, v3, s[4:7], s28 offen
    s_mov_b32 s28, 21504
    buffer_load_ushort v31, v3, s[4:7], s28 offen
    s_mov_b32 s28, 22528
    buffer_load_ushort v32, v3, s[4:7], s28 offen
    s_mov_b32 s28, 23552
    buffer_load_ushort v33, v3, s[4:7], s28 offen
    s_mov_b32 s28, 24576
    buffer_load_ushort v34, v3, s[4:7], s28 offen
    s_mov_b32 s28, 25600
    buffer_load_ushort v35, v3, s[4:7], s28 offen
    s_mov_b32 s28, 26624
    buffer_load_ushort v36, v3, s[4:7], s28 offen
    s_mov_b32 s28, 27648
    buffer_load_ushort v37, v3, s[4:7], s28 offen
    s_mov_b32 s28, 28672
    buffer_load_ushort v38, v3, s[4:7], s28 offen
    s_mov_b32 s28, 29696
    buffer_load_ushort v39, v3, s[4:7], s28 offen
    s_mov_b32 s28, 30720
    buffer_load_ushort v40, v3, s[4:7], s28 offen
    s_mov_b32 s28, 31744
    buffer_load_ushort v41, v3, s[4:7], s28 offen
    s_waitcnt vmcnt(0)
    v_lshl_or_b32 v50, v11, 16, v10
    v_lshl_or_b32 v51, v13, 16, v12
    v_lshl_or_b32 v52, v15, 16, v14
    v_lshl_or_b32 v53, v17, 16, v16
    v_lshl_or_b32 v54, v19, 16, v18
    v_lshl_or_b32 v55, v21, 16, v20
    v_lshl_or_b32 v56, v23, 16, v22
    v_lshl_or_b32 v57, v25, 16, v24
    v_lshl_or_b32 v58, v27, 16, v26
    v_lshl_or_b32 v59, v29, 16, v28
    v_lshl_or_b32 v60, v31, 16, v30
    v_lshl_or_b32 v61, v33, 16, v32
    v_lshl_or_b32 v62, v35, 16, v34
    v_lshl_or_b32 v63, v37, 16, v36
    v_lshl_or_b32 v64, v39, 16, v38
    v_lshl_or_b32 v65, v41, 16, v40
    s_lshl_b32 s24, s23, 5
    v_mov_b32 v5, s24
    v_add_u32 v5, 0, v5
    v_lshrrev_b32 v6, 5, v2
    s_mov_b32 s36, 32
    v_mul_lo_u32 v6, v6, s36
    v_lshrrev_b32 v7, 4, v5
    v_add_u32 v6, v6, v7
    v_lshlrev_b32 v4, 10, v6
    v_and_b32 v6, 31, v2
    v_lshlrev_b32 v6, 4, v6
    v_add_u32 v4, v4, v6
    v_lshrrev_b32 v6, 3, v5
    v_and_b32 v6, 1, v6
    v_lshlrev_b32 v6, 9, v6
    v_add_u32 v4, v4, v6
    v_and_b32 v6, 7, v5
    v_lshlrev_b32 v6, 1, v6
    v_add_u32 v4, v4, v6
    buffer_store_dwordx4 v[50:53], v4, s[8:11], 0 offen
    v_mov_b32 v5, s24
    v_add_u32 v5, 8, v5
    v_lshrrev_b32 v6, 5, v2
    s_mov_b32 s36, 32
    v_mul_lo_u32 v6, v6, s36
    v_lshrrev_b32 v7, 4, v5
    v_add_u32 v6, v6, v7
    v_lshlrev_b32 v4, 10, v6
    v_and_b32 v6, 31, v2
    v_lshlrev_b32 v6, 4, v6
    v_add_u32 v4, v4, v6
    v_lshrrev_b32 v6, 3, v5
    v_and_b32 v6, 1, v6
    v_lshlrev_b32 v6, 9, v6
    v_add_u32 v4, v4, v6
    v_and_b32 v6, 7, v5
    v_lshlrev_b32 v6, 1, v6
    v_add_u32 v4, v4, v6
    buffer_store_dwordx4 v[54:57], v4, s[8:11], 0 offen
    v_mov_b32 v5, s24
    v_add_u32 v5, 16, v5
    v_lshrrev_b32 v6, 5, v2
    s_mov_b32 s36, 32
    v_mul_lo_u32 v6, v6, s36
    v_lshrrev_b32 v7, 4, v5
    v_add_u32 v6, v6, v7
    v_lshlrev_b32 v4, 10, v6
    v_and_b32 v6, 31, v2
    v_lshlrev_b32 v6, 4, v6
    v_add_u32 v4, v4, v6
    v_lshrrev_b32 v6, 3, v5
    v_and_b32 v6, 1, v6
    v_lshlrev_b32 v6, 9, v6
    v_add_u32 v4, v4, v6
    v_and_b32 v6, 7, v5
    v_lshlrev_b32 v6, 1, v6
    v_add_u32 v4, v4, v6
    buffer_store_dwordx4 v[58:61], v4, s[8:11], 0 offen
    v_mov_b32 v5, s24
    v_add_u32 v5, 24, v5
    v_lshrrev_b32 v6, 5, v2
    s_mov_b32 s36, 32
    v_mul_lo_u32 v6, v6, s36
    v_lshrrev_b32 v7, 4, v5
    v_add_u32 v6, v6, v7
    v_lshlrev_b32 v4, 10, v6
    v_and_b32 v6, 31, v2
    v_lshlrev_b32 v6, 4, v6
    v_add_u32 v4, v4, v6
    v_lshrrev_b32 v6, 3, v5
    v_and_b32 v6, 1, v6
    v_lshlrev_b32 v6, 9, v6
    v_add_u32 v4, v4, v6
    v_and_b32 v6, 7, v5
    v_lshlrev_b32 v6, 1, v6
    v_add_u32 v4, v4, v6
    buffer_store_dwordx4 v[62:65], v4, s[8:11], 0 offen
    s_branch L_end_prep_kernel
L_prep_next2:
    s_cmp_ge_u32 s20, 768
    s_cbranch_scc1 L_prep_next3
    s_sub_u32 s21, s20, 640
    s_lshr_b32 s22, s21, 4
    s_and_b32 s23, s21, 15
    s_waitcnt lgkmcnt(0)
    s_add_u32 s4, s74, 0x0
    s_addc_u32 s5, s75, 0
    s_mov_b32 s6, 0x80000
    s_mov_b32 s7, 0x00020000
    s_waitcnt lgkmcnt(0)
    s_add_u32 s8, s84, 0x280000
    s_addc_u32 s9, s85, 0
    s_mov_b32 s10, 0x80000
    s_mov_b32 s11, 0x00020000
    s_lshl_b32 s22, s22, 6
    v_add_u32 v2, s22, v0
    s_mov_b32 s25, 512
    v_cmp_gt_u32 vcc, s25, v2
    s_and_saveexec_b64 s[26:27], vcc
    s_cbranch_execz L_end_prep_kernel
    s_mul_i32 s24, s23, 32768
    v_lshlrev_b32 v3, 1, v2
    v_add_u32 v3, s24, v3
    buffer_load_ushort v10, v3, s[4:7], 0 offen offset:0
    buffer_load_ushort v11, v3, s[4:7], 0 offen offset:1024
    buffer_load_ushort v12, v3, s[4:7], 0 offen offset:2048
    buffer_load_ushort v13, v3, s[4:7], 0 offen offset:3072
    s_mov_b32 s28, 4096
    buffer_load_ushort v14, v3, s[4:7], s28 offen
    s_mov_b32 s28, 5120
    buffer_load_ushort v15, v3, s[4:7], s28 offen
    s_mov_b32 s28, 6144
    buffer_load_ushort v16, v3, s[4:7], s28 offen
    s_mov_b32 s28, 7168
    buffer_load_ushort v17, v3, s[4:7], s28 offen
    s_mov_b32 s28, 8192
    buffer_load_ushort v18, v3, s[4:7], s28 offen
    s_mov_b32 s28, 9216
    buffer_load_ushort v19, v3, s[4:7], s28 offen
    s_mov_b32 s28, 10240
    buffer_load_ushort v20, v3, s[4:7], s28 offen
    s_mov_b32 s28, 11264
    buffer_load_ushort v21, v3, s[4:7], s28 offen
    s_mov_b32 s28, 12288
    buffer_load_ushort v22, v3, s[4:7], s28 offen
    s_mov_b32 s28, 13312
    buffer_load_ushort v23, v3, s[4:7], s28 offen
    s_mov_b32 s28, 14336
    buffer_load_ushort v24, v3, s[4:7], s28 offen
    s_mov_b32 s28, 15360
    buffer_load_ushort v25, v3, s[4:7], s28 offen
    s_mov_b32 s28, 16384
    buffer_load_ushort v26, v3, s[4:7], s28 offen
    s_mov_b32 s28, 17408
    buffer_load_ushort v27, v3, s[4:7], s28 offen
    s_mov_b32 s28, 18432
    buffer_load_ushort v28, v3, s[4:7], s28 offen
    s_mov_b32 s28, 19456
    buffer_load_ushort v29, v3, s[4:7], s28 offen
    s_mov_b32 s28, 20480
    buffer_load_ushort v30, v3, s[4:7], s28 offen
    s_mov_b32 s28, 21504
    buffer_load_ushort v31, v3, s[4:7], s28 offen
    s_mov_b32 s28, 22528
    buffer_load_ushort v32, v3, s[4:7], s28 offen
    s_mov_b32 s28, 23552
    buffer_load_ushort v33, v3, s[4:7], s28 offen
    s_mov_b32 s28, 24576
    buffer_load_ushort v34, v3, s[4:7], s28 offen
    s_mov_b32 s28, 25600
    buffer_load_ushort v35, v3, s[4:7], s28 offen
    s_mov_b32 s28, 26624
    buffer_load_ushort v36, v3, s[4:7], s28 offen
    s_mov_b32 s28, 27648
    buffer_load_ushort v37, v3, s[4:7], s28 offen
    s_mov_b32 s28, 28672
    buffer_load_ushort v38, v3, s[4:7], s28 offen
    s_mov_b32 s28, 29696
    buffer_load_ushort v39, v3, s[4:7], s28 offen
    s_mov_b32 s28, 30720
    buffer_load_ushort v40, v3, s[4:7], s28 offen
    s_mov_b32 s28, 31744
    buffer_load_ushort v41, v3, s[4:7], s28 offen
    s_waitcnt vmcnt(0)
    v_lshl_or_b32 v50, v11, 16, v10
    v_lshl_or_b32 v51, v13, 16, v12
    v_lshl_or_b32 v52, v15, 16, v14
    v_lshl_or_b32 v53, v17, 16, v16
    v_lshl_or_b32 v54, v19, 16, v18
    v_lshl_or_b32 v55, v21, 16, v20
    v_lshl_or_b32 v56, v23, 16, v22
    v_lshl_or_b32 v57, v25, 16, v24
    v_lshl_or_b32 v58, v27, 16, v26
    v_lshl_or_b32 v59, v29, 16, v28
    v_lshl_or_b32 v60, v31, 16, v30
    v_lshl_or_b32 v61, v33, 16, v32
    v_lshl_or_b32 v62, v35, 16, v34
    v_lshl_or_b32 v63, v37, 16, v36
    v_lshl_or_b32 v64, v39, 16, v38
    v_lshl_or_b32 v65, v41, 16, v40
    s_lshl_b32 s24, s23, 5
    v_mov_b32 v5, s24
    v_add_u32 v5, 0, v5
    v_lshrrev_b32 v6, 5, v2
    s_mov_b32 s36, 32
    v_mul_lo_u32 v6, v6, s36
    v_lshrrev_b32 v7, 4, v5
    v_add_u32 v6, v6, v7
    v_lshlrev_b32 v4, 10, v6
    v_and_b32 v6, 31, v2
    v_lshlrev_b32 v6, 4, v6
    v_add_u32 v4, v4, v6
    v_lshrrev_b32 v6, 3, v5
    v_and_b32 v6, 1, v6
    v_lshlrev_b32 v6, 9, v6
    v_add_u32 v4, v4, v6
    v_and_b32 v6, 7, v5
    v_lshlrev_b32 v6, 1, v6
    v_add_u32 v4, v4, v6
    buffer_store_dwordx4 v[50:53], v4, s[8:11], 0 offen
    v_mov_b32 v5, s24
    v_add_u32 v5, 8, v5
    v_lshrrev_b32 v6, 5, v2
    s_mov_b32 s36, 32
    v_mul_lo_u32 v6, v6, s36
    v_lshrrev_b32 v7, 4, v5
    v_add_u32 v6, v6, v7
    v_lshlrev_b32 v4, 10, v6
    v_and_b32 v6, 31, v2
    v_lshlrev_b32 v6, 4, v6
    v_add_u32 v4, v4, v6
    v_lshrrev_b32 v6, 3, v5
    v_and_b32 v6, 1, v6
    v_lshlrev_b32 v6, 9, v6
    v_add_u32 v4, v4, v6
    v_and_b32 v6, 7, v5
    v_lshlrev_b32 v6, 1, v6
    v_add_u32 v4, v4, v6
    buffer_store_dwordx4 v[54:57], v4, s[8:11], 0 offen
    v_mov_b32 v5, s24
    v_add_u32 v5, 16, v5
    v_lshrrev_b32 v6, 5, v2
    s_mov_b32 s36, 32
    v_mul_lo_u32 v6, v6, s36
    v_lshrrev_b32 v7, 4, v5
    v_add_u32 v6, v6, v7
    v_lshlrev_b32 v4, 10, v6
    v_and_b32 v6, 31, v2
    v_lshlrev_b32 v6, 4, v6
    v_add_u32 v4, v4, v6
    v_lshrrev_b32 v6, 3, v5
    v_and_b32 v6, 1, v6
    v_lshlrev_b32 v6, 9, v6
    v_add_u32 v4, v4, v6
    v_and_b32 v6, 7, v5
    v_lshlrev_b32 v6, 1, v6
    v_add_u32 v4, v4, v6
    buffer_store_dwordx4 v[58:61], v4, s[8:11], 0 offen
    v_mov_b32 v5, s24
    v_add_u32 v5, 24, v5
    v_lshrrev_b32 v6, 5, v2
    s_mov_b32 s36, 32
    v_mul_lo_u32 v6, v6, s36
    v_lshrrev_b32 v7, 4, v5
    v_add_u32 v6, v6, v7
    v_lshlrev_b32 v4, 10, v6
    v_and_b32 v6, 31, v2
    v_lshlrev_b32 v6, 4, v6
    v_add_u32 v4, v4, v6
    v_lshrrev_b32 v6, 3, v5
    v_and_b32 v6, 1, v6
    v_lshlrev_b32 v6, 9, v6
    v_add_u32 v4, v4, v6
    v_and_b32 v6, 7, v5
    v_lshlrev_b32 v6, 1, v6
    v_add_u32 v4, v4, v6
    buffer_store_dwordx4 v[62:65], v4, s[8:11], 0 offen
    s_branch L_end_prep_kernel
L_prep_next3:
    s_cmp_ge_u32 s20, 1120
    s_cbranch_scc1 L_prep_next4
    s_sub_u32 s21, s20, 768
    s_lshr_b32 s22, s21, 4
    s_and_b32 s23, s21, 15
    s_waitcnt lgkmcnt(0)
    s_add_u32 s4, s76, 0x0
    s_addc_u32 s5, s77, 0
    s_mov_b32 s6, 0x158000
    s_mov_b32 s7, 0x00020000
    s_waitcnt lgkmcnt(0)
    s_add_u32 s8, s84, 0x300000
    s_addc_u32 s9, s85, 0
    s_mov_b32 s10, 0x158000
    s_mov_b32 s11, 0x00020000
    s_lshl_b32 s22, s22, 6
    v_add_u32 v2, s22, v0
    s_mov_b32 s25, 1376
    v_cmp_gt_u32 vcc, s25, v2
    s_and_saveexec_b64 s[26:27], vcc
    s_cbranch_execz L_end_prep_kernel
    s_mul_i32 s24, s23, 88064
    v_lshlrev_b32 v3, 1, v2
    v_add_u32 v3, s24, v3
    buffer_load_ushort v10, v3, s[4:7], 0 offen offset:0
    buffer_load_ushort v11, v3, s[4:7], 0 offen offset:2752
    s_mov_b32 s28, 5504
    buffer_load_ushort v12, v3, s[4:7], s28 offen
    s_mov_b32 s28, 8256
    buffer_load_ushort v13, v3, s[4:7], s28 offen
    s_mov_b32 s28, 11008
    buffer_load_ushort v14, v3, s[4:7], s28 offen
    s_mov_b32 s28, 13760
    buffer_load_ushort v15, v3, s[4:7], s28 offen
    s_mov_b32 s28, 16512
    buffer_load_ushort v16, v3, s[4:7], s28 offen
    s_mov_b32 s28, 19264
    buffer_load_ushort v17, v3, s[4:7], s28 offen
    s_mov_b32 s28, 22016
    buffer_load_ushort v18, v3, s[4:7], s28 offen
    s_mov_b32 s28, 24768
    buffer_load_ushort v19, v3, s[4:7], s28 offen
    s_mov_b32 s28, 27520
    buffer_load_ushort v20, v3, s[4:7], s28 offen
    s_mov_b32 s28, 30272
    buffer_load_ushort v21, v3, s[4:7], s28 offen
    s_mov_b32 s28, 33024
    buffer_load_ushort v22, v3, s[4:7], s28 offen
    s_mov_b32 s28, 35776
    buffer_load_ushort v23, v3, s[4:7], s28 offen
    s_mov_b32 s28, 38528
    buffer_load_ushort v24, v3, s[4:7], s28 offen
    s_mov_b32 s28, 41280
    buffer_load_ushort v25, v3, s[4:7], s28 offen
    s_mov_b32 s28, 44032
    buffer_load_ushort v26, v3, s[4:7], s28 offen
    s_mov_b32 s28, 46784
    buffer_load_ushort v27, v3, s[4:7], s28 offen
    s_mov_b32 s28, 49536
    buffer_load_ushort v28, v3, s[4:7], s28 offen
    s_mov_b32 s28, 52288
    buffer_load_ushort v29, v3, s[4:7], s28 offen
    s_mov_b32 s28, 55040
    buffer_load_ushort v30, v3, s[4:7], s28 offen
    s_mov_b32 s28, 57792
    buffer_load_ushort v31, v3, s[4:7], s28 offen
    s_mov_b32 s28, 60544
    buffer_load_ushort v32, v3, s[4:7], s28 offen
    s_mov_b32 s28, 63296
    buffer_load_ushort v33, v3, s[4:7], s28 offen
    s_mov_b32 s28, 66048
    buffer_load_ushort v34, v3, s[4:7], s28 offen
    s_mov_b32 s28, 68800
    buffer_load_ushort v35, v3, s[4:7], s28 offen
    s_mov_b32 s28, 71552
    buffer_load_ushort v36, v3, s[4:7], s28 offen
    s_mov_b32 s28, 74304
    buffer_load_ushort v37, v3, s[4:7], s28 offen
    s_mov_b32 s28, 77056
    buffer_load_ushort v38, v3, s[4:7], s28 offen
    s_mov_b32 s28, 79808
    buffer_load_ushort v39, v3, s[4:7], s28 offen
    s_mov_b32 s28, 82560
    buffer_load_ushort v40, v3, s[4:7], s28 offen
    s_mov_b32 s28, 85312
    buffer_load_ushort v41, v3, s[4:7], s28 offen
    s_waitcnt vmcnt(0)
    v_lshl_or_b32 v50, v11, 16, v10
    v_lshl_or_b32 v51, v13, 16, v12
    v_lshl_or_b32 v52, v15, 16, v14
    v_lshl_or_b32 v53, v17, 16, v16
    v_lshl_or_b32 v54, v19, 16, v18
    v_lshl_or_b32 v55, v21, 16, v20
    v_lshl_or_b32 v56, v23, 16, v22
    v_lshl_or_b32 v57, v25, 16, v24
    v_lshl_or_b32 v58, v27, 16, v26
    v_lshl_or_b32 v59, v29, 16, v28
    v_lshl_or_b32 v60, v31, 16, v30
    v_lshl_or_b32 v61, v33, 16, v32
    v_lshl_or_b32 v62, v35, 16, v34
    v_lshl_or_b32 v63, v37, 16, v36
    v_lshl_or_b32 v64, v39, 16, v38
    v_lshl_or_b32 v65, v41, 16, v40
    s_lshl_b32 s24, s23, 5
    v_mov_b32 v5, s24
    v_add_u32 v5, 0, v5
    v_lshrrev_b32 v6, 5, v2
    s_mov_b32 s36, 32
    v_mul_lo_u32 v6, v6, s36
    v_lshrrev_b32 v7, 4, v5
    v_add_u32 v6, v6, v7
    v_lshlrev_b32 v4, 10, v6
    v_and_b32 v6, 31, v2
    v_lshlrev_b32 v6, 4, v6
    v_add_u32 v4, v4, v6
    v_lshrrev_b32 v6, 3, v5
    v_and_b32 v6, 1, v6
    v_lshlrev_b32 v6, 9, v6
    v_add_u32 v4, v4, v6
    v_and_b32 v6, 7, v5
    v_lshlrev_b32 v6, 1, v6
    v_add_u32 v4, v4, v6
    buffer_store_dwordx4 v[50:53], v4, s[8:11], 0 offen
    v_mov_b32 v5, s24
    v_add_u32 v5, 8, v5
    v_lshrrev_b32 v6, 5, v2
    s_mov_b32 s36, 32
    v_mul_lo_u32 v6, v6, s36
    v_lshrrev_b32 v7, 4, v5
    v_add_u32 v6, v6, v7
    v_lshlrev_b32 v4, 10, v6
    v_and_b32 v6, 31, v2
    v_lshlrev_b32 v6, 4, v6
    v_add_u32 v4, v4, v6
    v_lshrrev_b32 v6, 3, v5
    v_and_b32 v6, 1, v6
    v_lshlrev_b32 v6, 9, v6
    v_add_u32 v4, v4, v6
    v_and_b32 v6, 7, v5
    v_lshlrev_b32 v6, 1, v6
    v_add_u32 v4, v4, v6
    buffer_store_dwordx4 v[54:57], v4, s[8:11], 0 offen
    v_mov_b32 v5, s24
    v_add_u32 v5, 16, v5
    v_lshrrev_b32 v6, 5, v2
    s_mov_b32 s36, 32
    v_mul_lo_u32 v6, v6, s36
    v_lshrrev_b32 v7, 4, v5
    v_add_u32 v6, v6, v7
    v_lshlrev_b32 v4, 10, v6
    v_and_b32 v6, 31, v2
    v_lshlrev_b32 v6, 4, v6
    v_add_u32 v4, v4, v6
    v_lshrrev_b32 v6, 3, v5
    v_and_b32 v6, 1, v6
    v_lshlrev_b32 v6, 9, v6
    v_add_u32 v4, v4, v6
    v_and_b32 v6, 7, v5
    v_lshlrev_b32 v6, 1, v6
    v_add_u32 v4, v4, v6
    buffer_store_dwordx4 v[58:61], v4, s[8:11], 0 offen
    v_mov_b32 v5, s24
    v_add_u32 v5, 24, v5
    v_lshrrev_b32 v6, 5, v2
    s_mov_b32 s36, 32
    v_mul_lo_u32 v6, v6, s36
    v_lshrrev_b32 v7, 4, v5
    v_add_u32 v6, v6, v7
    v_lshlrev_b32 v4, 10, v6
    v_and_b32 v6, 31, v2
    v_lshlrev_b32 v6, 4, v6
    v_add_u32 v4, v4, v6
    v_lshrrev_b32 v6, 3, v5
    v_and_b32 v6, 1, v6
    v_lshlrev_b32 v6, 9, v6
    v_add_u32 v4, v4, v6
    v_and_b32 v6, 7, v5
    v_lshlrev_b32 v6, 1, v6
    v_add_u32 v4, v4, v6
    buffer_store_dwordx4 v[62:65], v4, s[8:11], 0 offen
    s_branch L_end_prep_kernel
L_prep_next4:
    s_cmp_ge_u32 s20, 1464
    s_cbranch_scc1 L_prep_next5
    s_sub_u32 s21, s20, 1120
    s_mov_b32 s24, 0x5f417d1
    s_mul_hi_u32 s22, s21, s24
    s_mul_i32 s24, s22, 43
    s_sub_u32 s23, s21, s24
    s_waitcnt lgkmcnt(0)
    s_add_u32 s4, s78, 0x0
    s_addc_u32 s5, s79, 0
    s_mov_b32 s6, 0x158000
    s_mov_b32 s7, 0x00020000
    s_waitcnt lgkmcnt(0)
    s_add_u32 s8, s84, 0x480000
    s_addc_u32 s9, s85, 0
    s_mov_b32 s10, 0x158000
    s_mov_b32 s11, 0x00020000
    s_lshl_b32 s22, s22, 6
    v_add_u32 v2, s22, v0
    s_mov_b32 s25, 512
    v_cmp_gt_u32 vcc, s25, v2
    s_and_saveexec_b64 s[26:27], vcc
    s_cbranch_execz L_end_prep_kernel
    s_mul_i32 s24, s23, 32768
    v_lshlrev_b32 v3, 1, v2
    v_add_u32 v3, s24, v3
    buffer_load_ushort v10, v3, s[4:7], 0 offen offset:0
    buffer_load_ushort v11, v3, s[4:7], 0 offen offset:1024
    buffer_load_ushort v12, v3, s[4:7], 0 offen offset:2048
    buffer_load_ushort v13, v3, s[4:7], 0 offen offset:3072
    s_mov_b32 s28, 4096
    buffer_load_ushort v14, v3, s[4:7], s28 offen
    s_mov_b32 s28, 5120
    buffer_load_ushort v15, v3, s[4:7], s28 offen
    s_mov_b32 s28, 6144
    buffer_load_ushort v16, v3, s[4:7], s28 offen
    s_mov_b32 s28, 7168
    buffer_load_ushort v17, v3, s[4:7], s28 offen
    s_mov_b32 s28, 8192
    buffer_load_ushort v18, v3, s[4:7], s28 offen
    s_mov_b32 s28, 9216
    buffer_load_ushort v19, v3, s[4:7], s28 offen
    s_mov_b32 s28, 10240
    buffer_load_ushort v20, v3, s[4:7], s28 offen
    s_mov_b32 s28, 11264
    buffer_load_ushort v21, v3, s[4:7], s28 offen
    s_mov_b32 s28, 12288
    buffer_load_ushort v22, v3, s[4:7], s28 offen
    s_mov_b32 s28, 13312
    buffer_load_ushort v23, v3, s[4:7], s28 offen
    s_mov_b32 s28, 14336
    buffer_load_ushort v24, v3, s[4:7], s28 offen
    s_mov_b32 s28, 15360
    buffer_load_ushort v25, v3, s[4:7], s28 offen
    s_mov_b32 s28, 16384
    buffer_load_ushort v26, v3, s[4:7], s28 offen
    s_mov_b32 s28, 17408
    buffer_load_ushort v27, v3, s[4:7], s28 offen
    s_mov_b32 s28, 18432
    buffer_load_ushort v28, v3, s[4:7], s28 offen
    s_mov_b32 s28, 19456
    buffer_load_ushort v29, v3, s[4:7], s28 offen
    s_mov_b32 s28, 20480
    buffer_load_ushort v30, v3, s[4:7], s28 offen
    s_mov_b32 s28, 21504
    buffer_load_ushort v31, v3, s[4:7], s28 offen
    s_mov_b32 s28, 22528
    buffer_load_ushort v32, v3, s[4:7], s28 offen
    s_mov_b32 s28, 23552
    buffer_load_ushort v33, v3, s[4:7], s28 offen
    s_mov_b32 s28, 24576
    buffer_load_ushort v34, v3, s[4:7], s28 offen
    s_mov_b32 s28, 25600
    buffer_load_ushort v35, v3, s[4:7], s28 offen
    s_mov_b32 s28, 26624
    buffer_load_ushort v36, v3, s[4:7], s28 offen
    s_mov_b32 s28, 27648
    buffer_load_ushort v37, v3, s[4:7], s28 offen
    s_mov_b32 s28, 28672
    buffer_load_ushort v38, v3, s[4:7], s28 offen
    s_mov_b32 s28, 29696
    buffer_load_ushort v39, v3, s[4:7], s28 offen
    s_mov_b32 s28, 30720
    buffer_load_ushort v40, v3, s[4:7], s28 offen
    s_mov_b32 s28, 31744
    buffer_load_ushort v41, v3, s[4:7], s28 offen
    s_waitcnt vmcnt(0)
    v_lshl_or_b32 v50, v11, 16, v10
    v_lshl_or_b32 v51, v13, 16, v12
    v_lshl_or_b32 v52, v15, 16, v14
    v_lshl_or_b32 v53, v17, 16, v16
    v_lshl_or_b32 v54, v19, 16, v18
    v_lshl_or_b32 v55, v21, 16, v20
    v_lshl_or_b32 v56, v23, 16, v22
    v_lshl_or_b32 v57, v25, 16, v24
    v_lshl_or_b32 v58, v27, 16, v26
    v_lshl_or_b32 v59, v29, 16, v28
    v_lshl_or_b32 v60, v31, 16, v30
    v_lshl_or_b32 v61, v33, 16, v32
    v_lshl_or_b32 v62, v35, 16, v34
    v_lshl_or_b32 v63, v37, 16, v36
    v_lshl_or_b32 v64, v39, 16, v38
    v_lshl_or_b32 v65, v41, 16, v40
    s_lshl_b32 s24, s23, 5
    v_mov_b32 v5, s24
    v_add_u32 v5, 0, v5
    v_lshrrev_b32 v6, 5, v2
    s_mov_b32 s36, 86
    v_mul_lo_u32 v6, v6, s36
    v_lshrrev_b32 v7, 4, v5
    v_add_u32 v6, v6, v7
    v_lshlrev_b32 v4, 10, v6
    v_and_b32 v6, 31, v2
    v_lshlrev_b32 v6, 4, v6
    v_add_u32 v4, v4, v6
    v_lshrrev_b32 v6, 3, v5
    v_and_b32 v6, 1, v6
    v_lshlrev_b32 v6, 9, v6
    v_add_u32 v4, v4, v6
    v_and_b32 v6, 7, v5
    v_lshlrev_b32 v6, 1, v6
    v_add_u32 v4, v4, v6
    buffer_store_dwordx4 v[50:53], v4, s[8:11], 0 offen
    v_mov_b32 v5, s24
    v_add_u32 v5, 8, v5
    v_lshrrev_b32 v6, 5, v2
    s_mov_b32 s36, 86
    v_mul_lo_u32 v6, v6, s36
    v_lshrrev_b32 v7, 4, v5
    v_add_u32 v6, v6, v7
    v_lshlrev_b32 v4, 10, v6
    v_and_b32 v6, 31, v2
    v_lshlrev_b32 v6, 4, v6
    v_add_u32 v4, v4, v6
    v_lshrrev_b32 v6, 3, v5
    v_and_b32 v6, 1, v6
    v_lshlrev_b32 v6, 9, v6
    v_add_u32 v4, v4, v6
    v_and_b32 v6, 7, v5
    v_lshlrev_b32 v6, 1, v6
    v_add_u32 v4, v4, v6
    buffer_store_dwordx4 v[54:57], v4, s[8:11], 0 offen
    v_mov_b32 v5, s24
    v_add_u32 v5, 16, v5
    v_lshrrev_b32 v6, 5, v2
    s_mov_b32 s36, 86
    v_mul_lo_u32 v6, v6, s36
    v_lshrrev_b32 v7, 4, v5
    v_add_u32 v6, v6, v7
    v_lshlrev_b32 v4, 10, v6
    v_and_b32 v6, 31, v2
    v_lshlrev_b32 v6, 4, v6
    v_add_u32 v4, v4, v6
    v_lshrrev_b32 v6, 3, v5
    v_and_b32 v6, 1, v6
    v_lshlrev_b32 v6, 9, v6
    v_add_u32 v4, v4, v6
    v_and_b32 v6, 7, v5
    v_lshlrev_b32 v6, 1, v6
    v_add_u32 v4, v4, v6
    buffer_store_dwordx4 v[58:61], v4, s[8:11], 0 offen
    v_mov_b32 v5, s24
    v_add_u32 v5, 24, v5
    v_lshrrev_b32 v6, 5, v2
    s_mov_b32 s36, 86
    v_mul_lo_u32 v6, v6, s36
    v_lshrrev_b32 v7, 4, v5
    v_add_u32 v6, v6, v7
    v_lshlrev_b32 v4, 10, v6
    v_and_b32 v6, 31, v2
    v_lshlrev_b32 v6, 4, v6
    v_add_u32 v4, v4, v6
    v_lshrrev_b32 v6, 3, v5
    v_and_b32 v6, 1, v6
    v_lshlrev_b32 v6, 9, v6
    v_add_u32 v4, v4, v6
    v_and_b32 v6, 7, v5
    v_lshlrev_b32 v6, 1, v6
    v_add_u32 v4, v4, v6
    buffer_store_dwordx4 v[62:65], v4, s[8:11], 0 offen
    s_branch L_end_prep_kernel
L_prep_next5:
    s_sub_u32 s21, s20, 1464
    s_waitcnt lgkmcnt(0)
    s_add_u32 s4, s64, 0x0
    s_addc_u32 s5, s65, 0
    s_mov_b32 s6, 0x200000
    s_mov_b32 s7, 0x00020000
    s_waitcnt lgkmcnt(0)
    s_add_u32 s8, s84, 0x600000
    s_addc_u32 s9, s85, 0
    s_mov_b32 s10, 0x200000
    s_mov_b32 s11, 0x00020000
    s_lshl_b32 s21, s21, 10
    v_lshlrev_b32 v2, 4, v0
    v_add_u32 v2, s21, v2
    buffer_load_dwordx4 v[10:13], v2, s[4:7], 0 offen
    s_waitcnt vmcnt(0)
    v_lshlrev_b32 v30, 16, v10
    v_and_b32 v31, 0xffff0000, v10
    v_lshlrev_b32 v32, 16, v11
    v_and_b32 v33, 0xffff0000, v11
    v_lshlrev_b32 v34, 16, v12
    v_and_b32 v35, 0xffff0000, v12
    v_lshlrev_b32 v36, 16, v13
    v_and_b32 v37, 0xffff0000, v13
    v_add_f32 v40, v30, v31
    v_add_f32 v40, v40, v32
    v_add_f32 v40, v40, v33
    v_add_f32 v40, v40, v34
    v_add_f32 v40, v40, v35
    v_add_f32 v40, v40, v36
    v_add_f32 v40, v40, v37
    v_xor_b32 v42, 32, v0
    v_lshlrev_b32 v42, 2, v42
    ds_bpermute_b32 v41, v42, v40
    s_waitcnt lgkmcnt(0)
    v_add_f32 v40, v40, v41
    v_xor_b32 v42, 16, v0
    v_lshlrev_b32 v42, 2, v42
    ds_bpermute_b32 v41, v42, v40
    s_waitcnt lgkmcnt(0)
    v_add_f32 v40, v40, v41
    v_xor_b32 v42, 8, v0
    v_lshlrev_b32 v42, 2, v42
    ds_bpermute_b32 v41, v42, v40
    s_waitcnt lgkmcnt(0)
    v_add_f32 v40, v40, v41
    v_xor_b32 v42, 4, v0
    v_lshlrev_b32 v42, 2, v42
    ds_bpermute_b32 v41, v42, v40
    s_waitcnt lgkmcnt(0)
    v_add_f32 v40, v40, v41
    v_xor_b32 v42, 2, v0
    v_lshlrev_b32 v42, 2, v42
    ds_bpermute_b32 v41, v42, v40
    s_waitcnt lgkmcnt(0)
    v_add_f32 v40, v40, v41
    v_xor_b32 v42, 1, v0
    v_lshlrev_b32 v42, 2, v42
    ds_bpermute_b32 v41, v42, v40
    s_waitcnt lgkmcnt(0)
    v_add_f32 v40, v40, v41
    v_mul_f32 v40, 0x3b000000, v40
    v_sub_f32 v30, v30, v40
    v_sub_f32 v31, v31, v40
    v_sub_f32 v32, v32, v40
    v_sub_f32 v33, v33, v40
    v_sub_f32 v34, v34, v40
    v_sub_f32 v35, v35, v40
    v_sub_f32 v36, v36, v40
    v_sub_f32 v37, v37, v40
    v_mul_f32 v43, v30, v30
    v_fma_f32 v43, v31, v31, v43
    v_fma_f32 v43, v32, v32, v43
    v_fma_f32 v43, v33, v33, v43
    v_fma_f32 v43, v34, v34, v43
    v_fma_f32 v43, v35, v35, v43
    v_fma_f32 v43, v36, v36, v43
    v_fma_f32 v43, v37, v37, v43
    v_xor_b32 v42, 32, v0
    v_lshlrev_b32 v42, 2, v42
    ds_bpermute_b32 v41, v42, v43
    s_waitcnt lgkmcnt(0)
    v_add_f32 v43, v43, v41
    v_xor_b32 v42, 16, v0
    v_lshlrev_b32 v42, 2, v42
    ds_bpermute_b32 v41, v42, v43
    s_waitcnt lgkmcnt(0)
    v_add_f32 v43, v43, v41
    v_xor_b32 v42, 8, v0
    v_lshlrev_b32 v42, 2, v42
    ds_bpermute_b32 v41, v42, v43
    s_waitcnt lgkmcnt(0)
    v_add_f32 v43, v43, v41
    v_xor_b32 v42, 4, v0
    v_lshlrev_b32 v42, 2, v42
    ds_bpermute_b32 v41, v42, v43
    s_waitcnt lgkmcnt(0)
    v_add_f32 v43, v43, v41
    v_xor_b32 v42, 2, v0
    v_lshlrev_b32 v42, 2, v42
    ds_bpermute_b32 v41, v42, v43
    s_waitcnt lgkmcnt(0)
    v_add_f32 v43, v43, v41
    v_xor_b32 v42, 1, v0
    v_lshlrev_b32 v42, 2, v42
    ds_bpermute_b32 v41, v42, v43
    s_waitcnt lgkmcnt(0)
    v_add_f32 v43, v43, v41
    v_mov_b32 v44, 0x3727c5ac
    v_mul_f32 v43, 0x3b000000, v43
    v_add_f32 v43, v43, v44
    v_rsq_f32 v43, v43
    s_nop 1
    v_mul_f32 v30, v30, v43
    v_mul_f32 v31, v31, v43
    v_mul_f32 v32, v32, v43
    v_mul_f32 v33, v33, v43
    v_mul_f32 v34, v34, v43
    v_mul_f32 v35, v35, v43
    v_mul_f32 v36, v36, v43
    v_mul_f32 v37, v37, v43
    v_cvt_pk_bf16_f32 v20, v30, v31
    v_cvt_pk_bf16_f32 v21, v32, v33
    v_cvt_pk_bf16_f32 v22, v34, v35
    v_cvt_pk_bf16_f32 v23, v36, v37
    s_lshr_b32 s21, s21, 10
    v_mov_b32 v5, s21
    v_lshlrev_b32 v6, 3, v0
    v_lshrrev_b32 v7, 5, v5
    s_mov_b32 s36, 32
    v_mul_lo_u32 v7, v7, s36
    v_lshrrev_b32 v8, 4, v6
    v_add_u32 v7, v7, v8
    v_lshlrev_b32 v2, 10, v7
    v_and_b32 v7, 31, v5
    v_lshlrev_b32 v7, 4, v7
    v_add_u32 v2, v2, v7
    v_lshrrev_b32 v7, 3, v6
    v_and_b32 v7, 1, v7
    v_lshlrev_b32 v7, 9, v7
    v_add_u32 v2, v2, v7
    v_and_b32 v7, 7, v6
    v_lshlrev_b32 v7, 1, v7
    v_add_u32 v2, v2, v7
    buffer_store_dwordx4 v[20:23], v2, s[8:11], 0 offen
L_end_prep_kernel:
    s_endpgm
.globl qkv_kernel
.p2align 8
.type qkv_kernel,@function
qkv_kernel:
    s_load_dwordx16 s[64:79], s[0:1], 0
    s_load_dwordx4 s[80:83], s[0:1], 64
    s_load_dwordx2 s[84:85], s[0:1], 80
    v_lshrrev_b32 v1, 6, v0
    s_nop 1
    v_readfirstlane_b32 s20, v1
    s_lshl_b32 s3, s2, 2
    s_add_u32 s20, s20, s3
    s_cmp_ge_u32 s20, 768
    s_cbranch_scc1 L_end_qkv_kernel
    v_and_b32 v0, 63, v0
    s_and_b32 s21, s20, 31
    s_lshr_b32 s22, s20, 5
    s_waitcnt lgkmcnt(0)
    s_add_u32 s4, s84, 0x600000
    s_addc_u32 s5, s85, 0
    s_mov_b32 s6, 0x200000
    s_mov_b32 s7, 0x00020000
    s_waitcnt lgkmcnt(0)
    s_add_u32 s8, s84, 0x0
    s_addc_u32 s9, s85, 0
    s_mov_b32 s10, 0x180000
    s_mov_b32 s11, 0x00020000
    v_and_b32 v2, 31, v0
    v_lshrrev_b32 v3, 5, v0
    v_lshlrev_b32 v8, 4, v0
    s_mul_i32 s25, s21, 65536
    s_add_u32 s25, s25, 0
    v_add_u32 v232, s25, v8
    s_mul_i32 s25, s21, 65536
    s_add_u32 s25, s25, 32768
    v_add_u32 v233, s25, v8
    s_mul_i32 s25, s22, 65536
    s_add_u32 s25, s25, 0
    v_add_u32 v234, s25, v8
    s_mul_i32 s25, s22, 65536
    s_add_u32 s25, s25, 32768
    v_add_u32 v235, s25, v8
    v_mov_b32 v160, 0
    v_mov_b32 v161, 0
    v_mov_b32 v162, 0
    v_mov_b32 v163, 0
    v_mov_b32 v164, 0
    v_mov_b32 v165, 0
    v_mov_b32 v166, 0
    v_mov_b32 v167, 0
    v_mov_b32 v168, 0
    v_mov_b32 v169, 0
    v_mov_b32 v170, 0
    v_mov_b32 v171, 0
    v_mov_b32 v172, 0
    v_mov_b32 v173, 0
    v_mov_b32 v174, 0
    v_mov_b32 v175, 0
    v_mov_b32 v176, 0
    v_mov_b32 v177, 0
    v_mov_b32 v178, 0
    v_mov_b32 v179, 0
    v_mov_b32 v180, 0
    v_mov_b32 v181, 0
    v_mov_b32 v182, 0
    v_mov_b32 v183, 0
    v_mov_b32 v184, 0
    v_mov_b32 v185, 0
    v_mov_b32 v186, 0
    v_mov_b32 v187, 0
    v_mov_b32 v188, 0
    v_mov_b32 v189, 0
    v_mov_b32 v190, 0
    v_mov_b32 v191, 0
    v_mov_b32 v192, 0
    v_mov_b32 v193, 0
    v_mov_b32 v194, 0
    v_mov_b32 v195, 0
    v_mov_b32 v196, 0
    v_mov_b32 v197, 0
    v_mov_b32 v198, 0
    v_mov_b32 v199, 0
    v_mov_b32 v200, 0
    v_mov_b32 v201, 0
    v_mov_b32 v202, 0
    v_mov_b32 v203, 0
    v_mov_b32 v204, 0
    v_mov_b32 v205, 0
    v_mov_b32 v206, 0
    v_mov_b32 v207, 0
    v_mov_b32 v208, 0
    v_mov_b32 v209, 0
    v_mov_b32 v210, 0
    v_mov_b32 v211, 0
    v_mov_b32 v212, 0
    v_mov_b32 v213, 0
    v_mov_b32 v214, 0
    v_mov_b32 v215, 0
    v_mov_b32 v216, 0
    v_mov_b32 v217, 0
    v_mov_b32 v218, 0
    v_mov_b32 v219, 0
    v_mov_b32 v220, 0
    v_mov_b32 v221, 0
    v_mov_b32 v222, 0
    v_mov_b32 v223, 0
    s_mov_b32 s27, 0
    buffer_load_dwordx4 v[32:35], v232, s[4:7], s27 offen
    buffer_load_dwordx4 v[36:39], v233, s[4:7], s27 offen
    buffer_load_dwordx4 v[96:99], v234, s[8:11], s27 offen
    buffer_load_dwordx4 v[100:103], v235, s[8:11], s27 offen
    s_mov_b32 s27, 1024
    buffer_load_dwordx4 v[40:43], v232, s[4:7], s27 offen
    buffer_load_dwordx4 v[44:47], v233, s[4:7], s27 offen
    buffer_load_dwordx4 v[104:107], v234, s[8:11], s27 offen
    buffer_load_dwordx4 v[108:111], v235, s[8:11], s27 offen
    s_mov_b32 s27, 2048
    buffer_load_dwordx4 v[48:51], v232, s[4:7], s27 offen
    buffer_load_dwordx4 v[52:55], v233, s[4:7], s27 offen
    buffer_load_dwordx4 v[112:115], v234, s[8:11], s27 offen
    buffer_load_dwordx4 v[116:119], v235, s[8:11], s27 offen
    s_mov_b32 s27, 3072
    buffer_load_dwordx4 v[56:59], v232, s[4:7], s27 offen
    buffer_load_dwordx4 v[60:63], v233, s[4:7], s27 offen
    buffer_load_dwordx4 v[120:123], v234, s[8:11], s27 offen
    buffer_load_dwordx4 v[124:127], v235, s[8:11], s27 offen
    s_mov_b32 s27, 4096
    buffer_load_dwordx4 v[64:67], v232, s[4:7], s27 offen
    buffer_load_dwordx4 v[68:71], v233, s[4:7], s27 offen
    buffer_load_dwordx4 v[128:131], v234, s[8:11], s27 offen
    buffer_load_dwordx4 v[132:135], v235, s[8:11], s27 offen
    s_mov_b32 s27, 5120
    buffer_load_dwordx4 v[72:75], v232, s[4:7], s27 offen
    buffer_load_dwordx4 v[76:79], v233, s[4:7], s27 offen
    buffer_load_dwordx4 v[136:139], v234, s[8:11], s27 offen
    buffer_load_dwordx4 v[140:143], v235, s[8:11], s27 offen
    s_mov_b32 s27, 6144
    buffer_load_dwordx4 v[80:83], v232, s[4:7], s27 offen
    buffer_load_dwordx4 v[84:87], v233, s[4:7], s27 offen
    buffer_load_dwordx4 v[144:147], v234, s[8:11], s27 offen
    buffer_load_dwordx4 v[148:151], v235, s[8:11], s27 offen
    s_mov_b32 s27, 7168
    buffer_load_dwordx4 v[88:91], v232, s[4:7], s27 offen
    buffer_load_dwordx4 v[92:95], v233, s[4:7], s27 offen
    buffer_load_dwordx4 v[152:155], v234, s[8:11], s27 offen
    buffer_load_dwordx4 v[156:159], v235, s[8:11], s27 offen
    s_waitcnt vmcnt(28)
    v_mfma_f32_32x32x16_bf16 v[160:175], v[96:99], v[32:35], v[160:175]
    v_mfma_f32_32x32x16_bf16 v[176:191], v[100:103], v[32:35], v[176:191]
    v_mfma_f32_32x32x16_bf16 v[192:207], v[96:99], v[36:39], v[192:207]
    v_mfma_f32_32x32x16_bf16 v[208:223], v[100:103], v[36:39], v[208:223]
    s_mov_b32 s27, 8192
    buffer_load_dwordx4 v[32:35], v232, s[4:7], s27 offen
    buffer_load_dwordx4 v[36:39], v233, s[4:7], s27 offen
    buffer_load_dwordx4 v[96:99], v234, s[8:11], s27 offen
    buffer_load_dwordx4 v[100:103], v235, s[8:11], s27 offen
    s_waitcnt vmcnt(28)
    v_mfma_f32_32x32x16_bf16 v[160:175], v[104:107], v[40:43], v[160:175]
    v_mfma_f32_32x32x16_bf16 v[176:191], v[108:111], v[40:43], v[176:191]
    v_mfma_f32_32x32x16_bf16 v[192:207], v[104:107], v[44:47], v[192:207]
    v_mfma_f32_32x32x16_bf16 v[208:223], v[108:111], v[44:47], v[208:223]
    s_mov_b32 s27, 9216
    buffer_load_dwordx4 v[40:43], v232, s[4:7], s27 offen
    buffer_load_dwordx4 v[44:47], v233, s[4:7], s27 offen
    buffer_load_dwordx4 v[104:107], v234, s[8:11], s27 offen
    buffer_load_dwordx4 v[108:111], v235, s[8:11], s27 offen
    s_waitcnt vmcnt(28)
    v_mfma_f32_32x32x16_bf16 v[160:175], v[112:115], v[48:51], v[160:175]
    v_mfma_f32_32x32x16_bf16 v[176:191], v[116:119], v[48:51], v[176:191]
    v_mfma_f32_32x32x16_bf16 v[192:207], v[112:115], v[52:55], v[192:207]
    v_mfma_f32_32x32x16_bf16 v[208:223], v[116:119], v[52:55], v[208:223]
    s_mov_b32 s27, 10240
    buffer_load_dwordx4 v[48:51], v232, s[4:7], s27 offen
    buffer_load_dwordx4 v[52:55], v233, s[4:7], s27 offen
    buffer_load_dwordx4 v[112:115], v234, s[8:11], s27 offen
    buffer_load_dwordx4 v[116:119], v235, s[8:11], s27 offen
    s_waitcnt vmcnt(28)
    v_mfma_f32_32x32x16_bf16 v[160:175], v[120:123], v[56:59], v[160:175]
    v_mfma_f32_32x32x16_bf16 v[176:191], v[124:127], v[56:59], v[176:191]
    v_mfma_f32_32x32x16_bf16 v[192:207], v[120:123], v[60:63], v[192:207]
    v_mfma_f32_32x32x16_bf16 v[208:223], v[124:127], v[60:63], v[208:223]
    s_mov_b32 s27, 11264
    buffer_load_dwordx4 v[56:59], v232, s[4:7], s27 offen
    buffer_load_dwordx4 v[60:63], v233, s[4:7], s27 offen
    buffer_load_dwordx4 v[120:123], v234, s[8:11], s27 offen
    buffer_load_dwordx4 v[124:127], v235, s[8:11], s27 offen
    s_waitcnt vmcnt(28)
    v_mfma_f32_32x32x16_bf16 v[160:175], v[128:131], v[64:67], v[160:175]
    v_mfma_f32_32x32x16_bf16 v[176:191], v[132:135], v[64:67], v[176:191]
    v_mfma_f32_32x32x16_bf16 v[192:207], v[128:131], v[68:71], v[192:207]
    v_mfma_f32_32x32x16_bf16 v[208:223], v[132:135], v[68:71], v[208:223]
    s_mov_b32 s27, 12288
    buffer_load_dwordx4 v[64:67], v232, s[4:7], s27 offen
    buffer_load_dwordx4 v[68:71], v233, s[4:7], s27 offen
    buffer_load_dwordx4 v[128:131], v234, s[8:11], s27 offen
    buffer_load_dwordx4 v[132:135], v235, s[8:11], s27 offen
    s_waitcnt vmcnt(28)
    v_mfma_f32_32x32x16_bf16 v[160:175], v[136:139], v[72:75], v[160:175]
    v_mfma_f32_32x32x16_bf16 v[176:191], v[140:143], v[72:75], v[176:191]
    v_mfma_f32_32x32x16_bf16 v[192:207], v[136:139], v[76:79], v[192:207]
    v_mfma_f32_32x32x16_bf16 v[208:223], v[140:143], v[76:79], v[208:223]
    s_mov_b32 s27, 13312
    buffer_load_dwordx4 v[72:75], v232, s[4:7], s27 offen
    buffer_load_dwordx4 v[76:79], v233, s[4:7], s27 offen
    buffer_load_dwordx4 v[136:139], v234, s[8:11], s27 offen
    buffer_load_dwordx4 v[140:143], v235, s[8:11], s27 offen
    s_waitcnt vmcnt(28)
    v_mfma_f32_32x32x16_bf16 v[160:175], v[144:147], v[80:83], v[160:175]
    v_mfma_f32_32x32x16_bf16 v[176:191], v[148:151], v[80:83], v[176:191]
    v_mfma_f32_32x32x16_bf16 v[192:207], v[144:147], v[84:87], v[192:207]
    v_mfma_f32_32x32x16_bf16 v[208:223], v[148:151], v[84:87], v[208:223]
    s_mov_b32 s27, 14336
    buffer_load_dwordx4 v[80:83], v232, s[4:7], s27 offen
    buffer_load_dwordx4 v[84:87], v233, s[4:7], s27 offen
    buffer_load_dwordx4 v[144:147], v234, s[8:11], s27 offen
    buffer_load_dwordx4 v[148:151], v235, s[8:11], s27 offen
    s_waitcnt vmcnt(28)
    v_mfma_f32_32x32x16_bf16 v[160:175], v[152:155], v[88:91], v[160:175]
    v_mfma_f32_32x32x16_bf16 v[176:191], v[156:159], v[88:91], v[176:191]
    v_mfma_f32_32x32x16_bf16 v[192:207], v[152:155], v[92:95], v[192:207]
    v_mfma_f32_32x32x16_bf16 v[208:223], v[156:159], v[92:95], v[208:223]
    s_mov_b32 s27, 15360
    buffer_load_dwordx4 v[88:91], v232, s[4:7], s27 offen
    buffer_load_dwordx4 v[92:95], v233, s[4:7], s27 offen
    buffer_load_dwordx4 v[152:155], v234, s[8:11], s27 offen
    buffer_load_dwordx4 v[156:159], v235, s[8:11], s27 offen
    s_waitcnt vmcnt(28)
    v_mfma_f32_32x32x16_bf16 v[160:175], v[96:99], v[32:35], v[160:175]
    v_mfma_f32_32x32x16_bf16 v[176:191], v[100:103], v[32:35], v[176:191]
    v_mfma_f32_32x32x16_bf16 v[192:207], v[96:99], v[36:39], v[192:207]
    v_mfma_f32_32x32x16_bf16 v[208:223], v[100:103], v[36:39], v[208:223]
    s_mov_b32 s27, 16384
    buffer_load_dwordx4 v[32:35], v232, s[4:7], s27 offen
    buffer_load_dwordx4 v[36:39], v233, s[4:7], s27 offen
    buffer_load_dwordx4 v[96:99], v234, s[8:11], s27 offen
    buffer_load_dwordx4 v[100:103], v235, s[8:11], s27 offen
    s_waitcnt vmcnt(28)
    v_mfma_f32_32x32x16_bf16 v[160:175], v[104:107], v[40:43], v[160:175]
    v_mfma_f32_32x32x16_bf16 v[176:191], v[108:111], v[40:43], v[176:191]
    v_mfma_f32_32x32x16_bf16 v[192:207], v[104:107], v[44:47], v[192:207]
    v_mfma_f32_32x32x16_bf16 v[208:223], v[108:111], v[44:47], v[208:223]
    s_mov_b32 s27, 17408
    buffer_load_dwordx4 v[40:43], v232, s[4:7], s27 offen
    buffer_load_dwordx4 v[44:47], v233, s[4:7], s27 offen
    buffer_load_dwordx4 v[104:107], v234, s[8:11], s27 offen
    buffer_load_dwordx4 v[108:111], v235, s[8:11], s27 offen
    s_waitcnt vmcnt(28)
    v_mfma_f32_32x32x16_bf16 v[160:175], v[112:115], v[48:51], v[160:175]
    v_mfma_f32_32x32x16_bf16 v[176:191], v[116:119], v[48:51], v[176:191]
    v_mfma_f32_32x32x16_bf16 v[192:207], v[112:115], v[52:55], v[192:207]
    v_mfma_f32_32x32x16_bf16 v[208:223], v[116:119], v[52:55], v[208:223]
    s_mov_b32 s27, 18432
    buffer_load_dwordx4 v[48:51], v232, s[4:7], s27 offen
    buffer_load_dwordx4 v[52:55], v233, s[4:7], s27 offen
    buffer_load_dwordx4 v[112:115], v234, s[8:11], s27 offen
    buffer_load_dwordx4 v[116:119], v235, s[8:11], s27 offen
    s_waitcnt vmcnt(28)
    v_mfma_f32_32x32x16_bf16 v[160:175], v[120:123], v[56:59], v[160:175]
    v_mfma_f32_32x32x16_bf16 v[176:191], v[124:127], v[56:59], v[176:191]
    v_mfma_f32_32x32x16_bf16 v[192:207], v[120:123], v[60:63], v[192:207]
    v_mfma_f32_32x32x16_bf16 v[208:223], v[124:127], v[60:63], v[208:223]
    s_mov_b32 s27, 19456
    buffer_load_dwordx4 v[56:59], v232, s[4:7], s27 offen
    buffer_load_dwordx4 v[60:63], v233, s[4:7], s27 offen
    buffer_load_dwordx4 v[120:123], v234, s[8:11], s27 offen
    buffer_load_dwordx4 v[124:127], v235, s[8:11], s27 offen
    s_waitcnt vmcnt(28)
    v_mfma_f32_32x32x16_bf16 v[160:175], v[128:131], v[64:67], v[160:175]
    v_mfma_f32_32x32x16_bf16 v[176:191], v[132:135], v[64:67], v[176:191]
    v_mfma_f32_32x32x16_bf16 v[192:207], v[128:131], v[68:71], v[192:207]
    v_mfma_f32_32x32x16_bf16 v[208:223], v[132:135], v[68:71], v[208:223]
    s_mov_b32 s27, 20480
    buffer_load_dwordx4 v[64:67], v232, s[4:7], s27 offen
    buffer_load_dwordx4 v[68:71], v233, s[4:7], s27 offen
    buffer_load_dwordx4 v[128:131], v234, s[8:11], s27 offen
    buffer_load_dwordx4 v[132:135], v235, s[8:11], s27 offen
    s_waitcnt vmcnt(28)
    v_mfma_f32_32x32x16_bf16 v[160:175], v[136:139], v[72:75], v[160:175]
    v_mfma_f32_32x32x16_bf16 v[176:191], v[140:143], v[72:75], v[176:191]
    v_mfma_f32_32x32x16_bf16 v[192:207], v[136:139], v[76:79], v[192:207]
    v_mfma_f32_32x32x16_bf16 v[208:223], v[140:143], v[76:79], v[208:223]
    s_mov_b32 s27, 21504
    buffer_load_dwordx4 v[72:75], v232, s[4:7], s27 offen
    buffer_load_dwordx4 v[76:79], v233, s[4:7], s27 offen
    buffer_load_dwordx4 v[136:139], v234, s[8:11], s27 offen
    buffer_load_dwordx4 v[140:143], v235, s[8:11], s27 offen
    s_waitcnt vmcnt(28)
    v_mfma_f32_32x32x16_bf16 v[160:175], v[144:147], v[80:83], v[160:175]
    v_mfma_f32_32x32x16_bf16 v[176:191], v[148:151], v[80:83], v[176:191]
    v_mfma_f32_32x32x16_bf16 v[192:207], v[144:147], v[84:87], v[192:207]
    v_mfma_f32_32x32x16_bf16 v[208:223], v[148:151], v[84:87], v[208:223]
    s_mov_b32 s27, 22528
    buffer_load_dwordx4 v[80:83], v232, s[4:7], s27 offen
    buffer_load_dwordx4 v[84:87], v233, s[4:7], s27 offen
    buffer_load_dwordx4 v[144:147], v234, s[8:11], s27 offen
    buffer_load_dwordx4 v[148:151], v235, s[8:11], s27 offen
    s_waitcnt vmcnt(28)
    v_mfma_f32_32x32x16_bf16 v[160:175], v[152:155], v[88:91], v[160:175]
    v_mfma_f32_32x32x16_bf16 v[176:191], v[156:159], v[88:91], v[176:191]
    v_mfma_f32_32x32x16_bf16 v[192:207], v[152:155], v[92:95], v[192:207]
    v_mfma_f32_32x32x16_bf16 v[208:223], v[156:159], v[92:95], v[208:223]
    s_mov_b32 s27, 23552
    buffer_load_dwordx4 v[88:91], v232, s[4:7], s27 offen
    buffer_load_dwordx4 v[92:95], v233, s[4:7], s27 offen
    buffer_load_dwordx4 v[152:155], v234, s[8:11], s27 offen
    buffer_load_dwordx4 v[156:159], v235, s[8:11], s27 offen
    s_waitcnt vmcnt(28)
    v_mfma_f32_32x32x16_bf16 v[160:175], v[96:99], v[32:35], v[160:175]
    v_mfma_f32_32x32x16_bf16 v[176:191], v[100:103], v[32:35], v[176:191]
    v_mfma_f32_32x32x16_bf16 v[192:207], v[96:99], v[36:39], v[192:207]
    v_mfma_f32_32x32x16_bf16 v[208:223], v[100:103], v[36:39], v[208:223]
    s_mov_b32 s27, 24576
    buffer_load_dwordx4 v[32:35], v232, s[4:7], s27 offen
    buffer_load_dwordx4 v[36:39], v233, s[4:7], s27 offen
    buffer_load_dwordx4 v[96:99], v234, s[8:11], s27 offen
    buffer_load_dwordx4 v[100:103], v235, s[8:11], s27 offen
    s_waitcnt vmcnt(28)
    v_mfma_f32_32x32x16_bf16 v[160:175], v[104:107], v[40:43], v[160:175]
    v_mfma_f32_32x32x16_bf16 v[176:191], v[108:111], v[40:43], v[176:191]
    v_mfma_f32_32x32x16_bf16 v[192:207], v[104:107], v[44:47], v[192:207]
    v_mfma_f32_32x32x16_bf16 v[208:223], v[108:111], v[44:47], v[208:223]
    s_mov_b32 s27, 25600
    buffer_load_dwordx4 v[40:43], v232, s[4:7], s27 offen
    buffer_load_dwordx4 v[44:47], v233, s[4:7], s27 offen
    buffer_load_dwordx4 v[104:107], v234, s[8:11], s27 offen
    buffer_load_dwordx4 v[108:111], v235, s[8:11], s27 offen
    s_waitcnt vmcnt(28)
    v_mfma_f32_32x32x16_bf16 v[160:175], v[112:115], v[48:51], v[160:175]
    v_mfma_f32_32x32x16_bf16 v[176:191], v[116:119], v[48:51], v[176:191]
    v_mfma_f32_32x32x16_bf16 v[192:207], v[112:115], v[52:55], v[192:207]
    v_mfma_f32_32x32x16_bf16 v[208:223], v[116:119], v[52:55], v[208:223]
    s_mov_b32 s27, 26624
    buffer_load_dwordx4 v[48:51], v232, s[4:7], s27 offen
    buffer_load_dwordx4 v[52:55], v233, s[4:7], s27 offen
    buffer_load_dwordx4 v[112:115], v234, s[8:11], s27 offen
    buffer_load_dwordx4 v[116:119], v235, s[8:11], s27 offen
    s_waitcnt vmcnt(28)
    v_mfma_f32_32x32x16_bf16 v[160:175], v[120:123], v[56:59], v[160:175]
    v_mfma_f32_32x32x16_bf16 v[176:191], v[124:127], v[56:59], v[176:191]
    v_mfma_f32_32x32x16_bf16 v[192:207], v[120:123], v[60:63], v[192:207]
    v_mfma_f32_32x32x16_bf16 v[208:223], v[124:127], v[60:63], v[208:223]
    s_mov_b32 s27, 27648
    buffer_load_dwordx4 v[56:59], v232, s[4:7], s27 offen
    buffer_load_dwordx4 v[60:63], v233, s[4:7], s27 offen
    buffer_load_dwordx4 v[120:123], v234, s[8:11], s27 offen
    buffer_load_dwordx4 v[124:127], v235, s[8:11], s27 offen
    s_waitcnt vmcnt(28)
    v_mfma_f32_32x32x16_bf16 v[160:175], v[128:131], v[64:67], v[160:175]
    v_mfma_f32_32x32x16_bf16 v[176:191], v[132:135], v[64:67], v[176:191]
    v_mfma_f32_32x32x16_bf16 v[192:207], v[128:131], v[68:71], v[192:207]
    v_mfma_f32_32x32x16_bf16 v[208:223], v[132:135], v[68:71], v[208:223]
    s_mov_b32 s27, 28672
    buffer_load_dwordx4 v[64:67], v232, s[4:7], s27 offen
    buffer_load_dwordx4 v[68:71], v233, s[4:7], s27 offen
    buffer_load_dwordx4 v[128:131], v234, s[8:11], s27 offen
    buffer_load_dwordx4 v[132:135], v235, s[8:11], s27 offen
    s_waitcnt vmcnt(28)
    v_mfma_f32_32x32x16_bf16 v[160:175], v[136:139], v[72:75], v[160:175]
    v_mfma_f32_32x32x16_bf16 v[176:191], v[140:143], v[72:75], v[176:191]
    v_mfma_f32_32x32x16_bf16 v[192:207], v[136:139], v[76:79], v[192:207]
    v_mfma_f32_32x32x16_bf16 v[208:223], v[140:143], v[76:79], v[208:223]
    s_mov_b32 s27, 29696
    buffer_load_dwordx4 v[72:75], v232, s[4:7], s27 offen
    buffer_load_dwordx4 v[76:79], v233, s[4:7], s27 offen
    buffer_load_dwordx4 v[136:139], v234, s[8:11], s27 offen
    buffer_load_dwordx4 v[140:143], v235, s[8:11], s27 offen
    s_waitcnt vmcnt(28)
    v_mfma_f32_32x32x16_bf16 v[160:175], v[144:147], v[80:83], v[160:175]
    v_mfma_f32_32x32x16_bf16 v[176:191], v[148:151], v[80:83], v[176:191]
    v_mfma_f32_32x32x16_bf16 v[192:207], v[144:147], v[84:87], v[192:207]
    v_mfma_f32_32x32x16_bf16 v[208:223], v[148:151], v[84:87], v[208:223]
    s_mov_b32 s27, 30720
    buffer_load_dwordx4 v[80:83], v232, s[4:7], s27 offen
    buffer_load_dwordx4 v[84:87], v233, s[4:7], s27 offen
    buffer_load_dwordx4 v[144:147], v234, s[8:11], s27 offen
    buffer_load_dwordx4 v[148:151], v235, s[8:11], s27 offen
    s_waitcnt vmcnt(28)
    v_mfma_f32_32x32x16_bf16 v[160:175], v[152:155], v[88:91], v[160:175]
    v_mfma_f32_32x32x16_bf16 v[176:191], v[156:159], v[88:91], v[176:191]
    v_mfma_f32_32x32x16_bf16 v[192:207], v[152:155], v[92:95], v[192:207]
    v_mfma_f32_32x32x16_bf16 v[208:223], v[156:159], v[92:95], v[208:223]
    s_mov_b32 s27, 31744
    buffer_load_dwordx4 v[88:91], v232, s[4:7], s27 offen
    buffer_load_dwordx4 v[92:95], v233, s[4:7], s27 offen
    buffer_load_dwordx4 v[152:155], v234, s[8:11], s27 offen
    buffer_load_dwordx4 v[156:159], v235, s[8:11], s27 offen
    s_waitcnt vmcnt(28)
    v_mfma_f32_32x32x16_bf16 v[160:175], v[96:99], v[32:35], v[160:175]
    v_mfma_f32_32x32x16_bf16 v[176:191], v[100:103], v[32:35], v[176:191]
    v_mfma_f32_32x32x16_bf16 v[192:207], v[96:99], v[36:39], v[192:207]
    v_mfma_f32_32x32x16_bf16 v[208:223], v[100:103], v[36:39], v[208:223]
    s_waitcnt vmcnt(24)
    v_mfma_f32_32x32x16_bf16 v[160:175], v[104:107], v[40:43], v[160:175]
    v_mfma_f32_32x32x16_bf16 v[176:191], v[108:111], v[40:43], v[176:191]
    v_mfma_f32_32x32x16_bf16 v[192:207], v[104:107], v[44:47], v[192:207]
    v_mfma_f32_32x32x16_bf16 v[208:223], v[108:111], v[44:47], v[208:223]
    s_waitcnt vmcnt(20)
    v_mfma_f32_32x32x16_bf16 v[160:175], v[112:115], v[48:51], v[160:175]
    v_mfma_f32_32x32x16_bf16 v[176:191], v[116:119], v[48:51], v[176:191]
    v_mfma_f32_32x32x16_bf16 v[192:207], v[112:115], v[52:55], v[192:207]
    v_mfma_f32_32x32x16_bf16 v[208:223], v[116:119], v[52:55], v[208:223]
    s_waitcnt vmcnt(16)
    v_mfma_f32_32x32x16_bf16 v[160:175], v[120:123], v[56:59], v[160:175]
    v_mfma_f32_32x32x16_bf16 v[176:191], v[124:127], v[56:59], v[176:191]
    v_mfma_f32_32x32x16_bf16 v[192:207], v[120:123], v[60:63], v[192:207]
    v_mfma_f32_32x32x16_bf16 v[208:223], v[124:127], v[60:63], v[208:223]
    s_waitcnt vmcnt(12)
    v_mfma_f32_32x32x16_bf16 v[160:175], v[128:131], v[64:67], v[160:175]
    v_mfma_f32_32x32x16_bf16 v[176:191], v[132:135], v[64:67], v[176:191]
    v_mfma_f32_32x32x16_bf16 v[192:207], v[128:131], v[68:71], v[192:207]
    v_mfma_f32_32x32x16_bf16 v[208:223], v[132:135], v[68:71], v[208:223]
    s_waitcnt vmcnt(8)
    v_mfma_f32_32x32x16_bf16 v[160:175], v[136:139], v[72:75], v[160:175]
    v_mfma_f32_32x32x16_bf16 v[176:191], v[140:143], v[72:75], v[176:191]
    v_mfma_f32_32x32x16_bf16 v[192:207], v[136:139], v[76:79], v[192:207]
    v_mfma_f32_32x32x16_bf16 v[208:223], v[140:143], v[76:79], v[208:223]
    s_waitcnt vmcnt(4)
    v_mfma_f32_32x32x16_bf16 v[160:175], v[144:147], v[80:83], v[160:175]
    v_mfma_f32_32x32x16_bf16 v[176:191], v[148:151], v[80:83], v[176:191]
    v_mfma_f32_32x32x16_bf16 v[192:207], v[144:147], v[84:87], v[192:207]
    v_mfma_f32_32x32x16_bf16 v[208:223], v[148:151], v[84:87], v[208:223]
    s_waitcnt vmcnt(0)
    v_mfma_f32_32x32x16_bf16 v[160:175], v[152:155], v[88:91], v[160:175]
    v_mfma_f32_32x32x16_bf16 v[176:191], v[156:159], v[88:91], v[176:191]
    v_mfma_f32_32x32x16_bf16 v[192:207], v[152:155], v[92:95], v[192:207]
    v_mfma_f32_32x32x16_bf16 v[208:223], v[156:159], v[92:95], v[208:223]
    s_nop 7
    s_nop 7
    s_lshl_b32 s23, s21, 6
    s_add_u32 s23, s23, 0
    s_lshl_b32 s24, s22, 6
    s_add_u32 s24, s24, 0
    s_cmp_ge_u32 s24, 1536
    s_cbranch_scc1 L_qkv_kernel_skip00
    v_add_u32 v4, s23, v2
    v_mov_b32 v16, v160
    v_mov_b32 v17, v161
    v_mov_b32 v18, v162
    v_mov_b32 v19, v163
    v_mov_b32 v20, v164
    v_mov_b32 v21, v165
    v_mov_b32 v22, v166
    v_mov_b32 v23, v167
    v_mov_b32 v24, v168
    v_mov_b32 v25, v169
    v_mov_b32 v26, v170
    v_mov_b32 v27, v171
    v_mov_b32 v28, v172
    v_mov_b32 v29, v173
    v_mov_b32 v30, v174
    v_mov_b32 v31, v175
    v_lshlrev_b32 v9, 2, v3
    v_add_u32 v9, s24, v9
    s_waitcnt lgkmcnt(0)
    s_add_u32 s12, s84, 0x800000
    s_addc_u32 s13, s85, 0
    s_mov_b32 s14, 0x800000
    s_mov_b32 s15, 0x00020000
    s_lshr_b32 s26, s24, 9
    s_cmp_eq_u32 s26, 2
    s_cbranch_scc1 L_qkv_kernel_v00
    s_cmp_eq_u32 s26, 0
    s_cselect_b32 s27, 0x3eb8aa3b, 1.0
    s_mul_i32 s26, s26, 2097152
    v_add_u32 v10, 0, v9
    v_lshrrev_b32 v11, 4, v10
    v_and_b32 v11, 31, v11
    v_lshlrev_b32 v11, 11, v11
    v_add_u32 v11, v11, v4
    v_lshlrev_b32 v11, 4, v11
    v_and_b32 v12, 15, v10
    v_add_u32 v11, v11, v12
    v_lshlrev_b32 v11, 1, v11
    v_cvt_pk_bf16_f32 v13, v16, v16
    v_lshlrev_b32 v16, 16, v13
    v_mul_f32 v16, s27, v16
    v_cvt_pk_bf16_f32 v13, v17, v17
    v_lshlrev_b32 v17, 16, v13
    v_mul_f32 v17, s27, v17
    v_cvt_pk_bf16_f32 v13, v18, v18
    v_lshlrev_b32 v18, 16, v13
    v_mul_f32 v18, s27, v18
    v_cvt_pk_bf16_f32 v13, v19, v19
    v_lshlrev_b32 v19, 16, v13
    v_mul_f32 v19, s27, v19
    v_cvt_pk_bf16_f32 v14, v16, v17
    v_cvt_pk_bf16_f32 v15, v18, v19
    buffer_store_dwordx2 v[14:15], v11, s[12:15], s26 offen
    v_add_u32 v10, 8, v9
    v_lshrrev_b32 v11, 4, v10
    v_and_b32 v11, 31, v11
    v_lshlrev_b32 v11, 11, v11
    v_add_u32 v11, v11, v4
    v_lshlrev_b32 v11, 4, v11
    v_and_b32 v12, 15, v10
    v_add_u32 v11, v11, v12
    v_lshlrev_b32 v11, 1, v11
    v_cvt_pk_bf16_f32 v13, v20, v20
    v_lshlrev_b32 v20, 16, v13
    v_mul_f32 v20, s27, v20
    v_cvt_pk_bf16_f32 v13, v21, v21
    v_lshlrev_b32 v21, 16, v13
    v_mul_f32 v21, s27, v21
    v_cvt_pk_bf16_f32 v13, v22, v22
    v_lshlrev_b32 v22, 16, v13
    v_mul_f32 v22, s27, v22
    v_cvt_pk_bf16_f32 v13, v23, v23
    v_lshlrev_b32 v23, 16, v13
    v_mul_f32 v23, s27, v23
    v_cvt_pk_bf16_f32 v14, v20, v21
    v_cvt_pk_bf16_f32 v15, v22, v23
    buffer_store_dwordx2 v[14:15], v11, s[12:15], s26 offen
    v_add_u32 v10, 16, v9
    v_lshrrev_b32 v11, 4, v10
    v_and_b32 v11, 31, v11
    v_lshlrev_b32 v11, 11, v11
    v_add_u32 v11, v11, v4
    v_lshlrev_b32 v11, 4, v11
    v_and_b32 v12, 15, v10
    v_add_u32 v11, v11, v12
    v_lshlrev_b32 v11, 1, v11
    v_cvt_pk_bf16_f32 v13, v24, v24
    v_lshlrev_b32 v24, 16, v13
    v_mul_f32 v24, s27, v24
    v_cvt_pk_bf16_f32 v13, v25, v25
    v_lshlrev_b32 v25, 16, v13
    v_mul_f32 v25, s27, v25
    v_cvt_pk_bf16_f32 v13, v26, v26
    v_lshlrev_b32 v26, 16, v13
    v_mul_f32 v26, s27, v26
    v_cvt_pk_bf16_f32 v13, v27, v27
    v_lshlrev_b32 v27, 16, v13
    v_mul_f32 v27, s27, v27
    v_cvt_pk_bf16_f32 v14, v24, v25
    v_cvt_pk_bf16_f32 v15, v26, v27
    buffer_store_dwordx2 v[14:15], v11, s[12:15], s26 offen
    v_add_u32 v10, 24, v9
    v_lshrrev_b32 v11, 4, v10
    v_and_b32 v11, 31, v11
    v_lshlrev_b32 v11, 11, v11
    v_add_u32 v11, v11, v4
    v_lshlrev_b32 v11, 4, v11
    v_and_b32 v12, 15, v10
    v_add_u32 v11, v11, v12
    v_lshlrev_b32 v11, 1, v11
    v_cvt_pk_bf16_f32 v13, v28, v28
    v_lshlrev_b32 v28, 16, v13
    v_mul_f32 v28, s27, v28
    v_cvt_pk_bf16_f32 v13, v29, v29
    v_lshlrev_b32 v29, 16, v13
    v_mul_f32 v29, s27, v29
    v_cvt_pk_bf16_f32 v13, v30, v30
    v_lshlrev_b32 v30, 16, v13
    v_mul_f32 v30, s27, v30
    v_cvt_pk_bf16_f32 v13, v31, v31
    v_lshlrev_b32 v31, 16, v13
    v_mul_f32 v31, s27, v31
    v_cvt_pk_bf16_f32 v14, v28, v29
    v_cvt_pk_bf16_f32 v15, v30, v31
    buffer_store_dwordx2 v[14:15], v11, s[12:15], s26 offen
    s_branch L_qkv_kernel_skip00
L_qkv_kernel_v00:
    s_mov_b32 s26, 4194304
    v_add_u32 v10, 0, v9
    v_lshrrev_b32 v11, 4, v10
    v_and_b32 v11, 31, v11
    v_lshlrev_b32 v11, 7, v11
    v_lshrrev_b32 v12, 4, v4
    v_add_u32 v11, v11, v12
    v_lshlrev_b32 v11, 10, v11
    v_and_b32 v10, 15, v10
    v_lshlrev_b32 v10, 4, v10
    v_add_u32 v11, v11, v10
    v_lshrrev_b32 v12, 2, v4
    v_and_b32 v12, 1, v12
    v_lshlrev_b32 v12, 9, v12
    v_add_u32 v11, v11, v12
    v_and_b32 v12, 3, v4
    v_lshlrev_b32 v12, 1, v12
    v_add_u32 v11, v11, v12
    v_lshrrev_b32 v12, 3, v4
    v_and_b32 v12, 1, v12
    v_lshlrev_b32 v12, 3, v12
    v_add_u32 v10, v11, v12
    v_cvt_pk_bf16_f32 v14, v16, v16
    buffer_store_short v14, v10, s[12:15], s26 offen
    v_add_u32 v10, 1, v9
    v_lshrrev_b32 v11, 4, v10
    v_and_b32 v11, 31, v11
    v_lshlrev_b32 v11, 7, v11
    v_lshrrev_b32 v12, 4, v4
    v_add_u32 v11, v11, v12
    v_lshlrev_b32 v11, 10, v11
    v_and_b32 v10, 15, v10
    v_lshlrev_b32 v10, 4, v10
    v_add_u32 v11, v11, v10
    v_lshrrev_b32 v12, 2, v4
    v_and_b32 v12, 1, v12
    v_lshlrev_b32 v12, 9, v12
    v_add_u32 v11, v11, v12
    v_and_b32 v12, 3, v4
    v_lshlrev_b32 v12, 1, v12
    v_add_u32 v11, v11, v12
    v_lshrrev_b32 v12, 3, v4
    v_and_b32 v12, 1, v12
    v_lshlrev_b32 v12, 3, v12
    v_add_u32 v10, v11, v12
    v_cvt_pk_bf16_f32 v14, v17, v17
    buffer_store_short v14, v10, s[12:15], s26 offen
    v_add_u32 v10, 2, v9
    v_lshrrev_b32 v11, 4, v10
    v_and_b32 v11, 31, v11
    v_lshlrev_b32 v11, 7, v11
    v_lshrrev_b32 v12, 4, v4
    v_add_u32 v11, v11, v12
    v_lshlrev_b32 v11, 10, v11
    v_and_b32 v10, 15, v10
    v_lshlrev_b32 v10, 4, v10
    v_add_u32 v11, v11, v10
    v_lshrrev_b32 v12, 2, v4
    v_and_b32 v12, 1, v12
    v_lshlrev_b32 v12, 9, v12
    v_add_u32 v11, v11, v12
    v_and_b32 v12, 3, v4
    v_lshlrev_b32 v12, 1, v12
    v_add_u32 v11, v11, v12
    v_lshrrev_b32 v12, 3, v4
    v_and_b32 v12, 1, v12
    v_lshlrev_b32 v12, 3, v12
    v_add_u32 v10, v11, v12
    v_cvt_pk_bf16_f32 v14, v18, v18
    buffer_store_short v14, v10, s[12:15], s26 offen
    v_add_u32 v10, 3, v9
    v_lshrrev_b32 v11, 4, v10
    v_and_b32 v11, 31, v11
    v_lshlrev_b32 v11, 7, v11
    v_lshrrev_b32 v12, 4, v4
    v_add_u32 v11, v11, v12
    v_lshlrev_b32 v11, 10, v11
    v_and_b32 v10, 15, v10
    v_lshlrev_b32 v10, 4, v10
    v_add_u32 v11, v11, v10
    v_lshrrev_b32 v12, 2, v4
    v_and_b32 v12, 1, v12
    v_lshlrev_b32 v12, 9, v12
    v_add_u32 v11, v11, v12
    v_and_b32 v12, 3, v4
    v_lshlrev_b32 v12, 1, v12
    v_add_u32 v11, v11, v12
    v_lshrrev_b32 v12, 3, v4
    v_and_b32 v12, 1, v12
    v_lshlrev_b32 v12, 3, v12
    v_add_u32 v10, v11, v12
    v_cvt_pk_bf16_f32 v14, v19, v19
    buffer_store_short v14, v10, s[12:15], s26 offen
    v_add_u32 v10, 8, v9
    v_lshrrev_b32 v11, 4, v10
    v_and_b32 v11, 31, v11
    v_lshlrev_b32 v11, 7, v11
    v_lshrrev_b32 v12, 4, v4
    v_add_u32 v11, v11, v12
    v_lshlrev_b32 v11, 10, v11
    v_and_b32 v10, 15, v10
    v_lshlrev_b32 v10, 4, v10
    v_add_u32 v11, v11, v10
    v_lshrrev_b32 v12, 2, v4
    v_and_b32 v12, 1, v12
    v_lshlrev_b32 v12, 9, v12
    v_add_u32 v11, v11, v12
    v_and_b32 v12, 3, v4
    v_lshlrev_b32 v12, 1, v12
    v_add_u32 v11, v11, v12
    v_lshrrev_b32 v12, 3, v4
    v_and_b32 v12, 1, v12
    v_lshlrev_b32 v12, 3, v12
    v_add_u32 v10, v11, v12
    v_cvt_pk_bf16_f32 v14, v20, v20
    buffer_store_short v14, v10, s[12:15], s26 offen
    v_add_u32 v10, 9, v9
    v_lshrrev_b32 v11, 4, v10
    v_and_b32 v11, 31, v11
    v_lshlrev_b32 v11, 7, v11
    v_lshrrev_b32 v12, 4, v4
    v_add_u32 v11, v11, v12
    v_lshlrev_b32 v11, 10, v11
    v_and_b32 v10, 15, v10
    v_lshlrev_b32 v10, 4, v10
    v_add_u32 v11, v11, v10
    v_lshrrev_b32 v12, 2, v4
    v_and_b32 v12, 1, v12
    v_lshlrev_b32 v12, 9, v12
    v_add_u32 v11, v11, v12
    v_and_b32 v12, 3, v4
    v_lshlrev_b32 v12, 1, v12
    v_add_u32 v11, v11, v12
    v_lshrrev_b32 v12, 3, v4
    v_and_b32 v12, 1, v12
    v_lshlrev_b32 v12, 3, v12
    v_add_u32 v10, v11, v12
    v_cvt_pk_bf16_f32 v14, v21, v21
    buffer_store_short v14, v10, s[12:15], s26 offen
    v_add_u32 v10, 10, v9
    v_lshrrev_b32 v11, 4, v10
    v_and_b32 v11, 31, v11
    v_lshlrev_b32 v11, 7, v11
    v_lshrrev_b32 v12, 4, v4
    v_add_u32 v11, v11, v12
    v_lshlrev_b32 v11, 10, v11
    v_and_b32 v10, 15, v10
    v_lshlrev_b32 v10, 4, v10
    v_add_u32 v11, v11, v10
    v_lshrrev_b32 v12, 2, v4
    v_and_b32 v12, 1, v12
    v_lshlrev_b32 v12, 9, v12
    v_add_u32 v11, v11, v12
    v_and_b32 v12, 3, v4
    v_lshlrev_b32 v12, 1, v12
    v_add_u32 v11, v11, v12
    v_lshrrev_b32 v12, 3, v4
    v_and_b32 v12, 1, v12
    v_lshlrev_b32 v12, 3, v12
    v_add_u32 v10, v11, v12
    v_cvt_pk_bf16_f32 v14, v22, v22
    buffer_store_short v14, v10, s[12:15], s26 offen
    v_add_u32 v10, 11, v9
    v_lshrrev_b32 v11, 4, v10
    v_and_b32 v11, 31, v11
    v_lshlrev_b32 v11, 7, v11
    v_lshrrev_b32 v12, 4, v4
    v_add_u32 v11, v11, v12
    v_lshlrev_b32 v11, 10, v11
    v_and_b32 v10, 15, v10
    v_lshlrev_b32 v10, 4, v10
    v_add_u32 v11, v11, v10
    v_lshrrev_b32 v12, 2, v4
    v_and_b32 v12, 1, v12
    v_lshlrev_b32 v12, 9, v12
    v_add_u32 v11, v11, v12
    v_and_b32 v12, 3, v4
    v_lshlrev_b32 v12, 1, v12
    v_add_u32 v11, v11, v12
    v_lshrrev_b32 v12, 3, v4
    v_and_b32 v12, 1, v12
    v_lshlrev_b32 v12, 3, v12
    v_add_u32 v10, v11, v12
    v_cvt_pk_bf16_f32 v14, v23, v23
    buffer_store_short v14, v10, s[12:15], s26 offen
    v_add_u32 v10, 16, v9
    v_lshrrev_b32 v11, 4, v10
    v_and_b32 v11, 31, v11
    v_lshlrev_b32 v11, 7, v11
    v_lshrrev_b32 v12, 4, v4
    v_add_u32 v11, v11, v12
    v_lshlrev_b32 v11, 10, v11
    v_and_b32 v10, 15, v10
    v_lshlrev_b32 v10, 4, v10
    v_add_u32 v11, v11, v10
    v_lshrrev_b32 v12, 2, v4
    v_and_b32 v12, 1, v12
    v_lshlrev_b32 v12, 9, v12
    v_add_u32 v11, v11, v12
    v_and_b32 v12, 3, v4
    v_lshlrev_b32 v12, 1, v12
    v_add_u32 v11, v11, v12
    v_lshrrev_b32 v12, 3, v4
    v_and_b32 v12, 1, v12
    v_lshlrev_b32 v12, 3, v12
    v_add_u32 v10, v11, v12
    v_cvt_pk_bf16_f32 v14, v24, v24
    buffer_store_short v14, v10, s[12:15], s26 offen
    v_add_u32 v10, 17, v9
    v_lshrrev_b32 v11, 4, v10
    v_and_b32 v11, 31, v11
    v_lshlrev_b32 v11, 7, v11
    v_lshrrev_b32 v12, 4, v4
    v_add_u32 v11, v11, v12
    v_lshlrev_b32 v11, 10, v11
    v_and_b32 v10, 15, v10
    v_lshlrev_b32 v10, 4, v10
    v_add_u32 v11, v11, v10
    v_lshrrev_b32 v12, 2, v4
    v_and_b32 v12, 1, v12
    v_lshlrev_b32 v12, 9, v12
    v_add_u32 v11, v11, v12
    v_and_b32 v12, 3, v4
    v_lshlrev_b32 v12, 1, v12
    v_add_u32 v11, v11, v12
    v_lshrrev_b32 v12, 3, v4
    v_and_b32 v12, 1, v12
    v_lshlrev_b32 v12, 3, v12
    v_add_u32 v10, v11, v12
    v_cvt_pk_bf16_f32 v14, v25, v25
    buffer_store_short v14, v10, s[12:15], s26 offen
    v_add_u32 v10, 18, v9
    v_lshrrev_b32 v11, 4, v10
    v_and_b32 v11, 31, v11
    v_lshlrev_b32 v11, 7, v11
    v_lshrrev_b32 v12, 4, v4
    v_add_u32 v11, v11, v12
    v_lshlrev_b32 v11, 10, v11
    v_and_b32 v10, 15, v10
    v_lshlrev_b32 v10, 4, v10
    v_add_u32 v11, v11, v10
    v_lshrrev_b32 v12, 2, v4
    v_and_b32 v12, 1, v12
    v_lshlrev_b32 v12, 9, v12
    v_add_u32 v11, v11, v12
    v_and_b32 v12, 3, v4
    v_lshlrev_b32 v12, 1, v12
    v_add_u32 v11, v11, v12
    v_lshrrev_b32 v12, 3, v4
    v_and_b32 v12, 1, v12
    v_lshlrev_b32 v12, 3, v12
    v_add_u32 v10, v11, v12
    v_cvt_pk_bf16_f32 v14, v26, v26
    buffer_store_short v14, v10, s[12:15], s26 offen
    v_add_u32 v10, 19, v9
    v_lshrrev_b32 v11, 4, v10
    v_and_b32 v11, 31, v11
    v_lshlrev_b32 v11, 7, v11
    v_lshrrev_b32 v12, 4, v4
    v_add_u32 v11, v11, v12
    v_lshlrev_b32 v11, 10, v11
    v_and_b32 v10, 15, v10
    v_lshlrev_b32 v10, 4, v10
    v_add_u32 v11, v11, v10
    v_lshrrev_b32 v12, 2, v4
    v_and_b32 v12, 1, v12
    v_lshlrev_b32 v12, 9, v12
    v_add_u32 v11, v11, v12
    v_and_b32 v12, 3, v4
    v_lshlrev_b32 v12, 1, v12
    v_add_u32 v11, v11, v12
    v_lshrrev_b32 v12, 3, v4
    v_and_b32 v12, 1, v12
    v_lshlrev_b32 v12, 3, v12
    v_add_u32 v10, v11, v12
    v_cvt_pk_bf16_f32 v14, v27, v27
    buffer_store_short v14, v10, s[12:15], s26 offen
    v_add_u32 v10, 24, v9
    v_lshrrev_b32 v11, 4, v10
    v_and_b32 v11, 31, v11
    v_lshlrev_b32 v11, 7, v11
    v_lshrrev_b32 v12, 4, v4
    v_add_u32 v11, v11, v12
    v_lshlrev_b32 v11, 10, v11
    v_and_b32 v10, 15, v10
    v_lshlrev_b32 v10, 4, v10
    v_add_u32 v11, v11, v10
    v_lshrrev_b32 v12, 2, v4
    v_and_b32 v12, 1, v12
    v_lshlrev_b32 v12, 9, v12
    v_add_u32 v11, v11, v12
    v_and_b32 v12, 3, v4
    v_lshlrev_b32 v12, 1, v12
    v_add_u32 v11, v11, v12
    v_lshrrev_b32 v12, 3, v4
    v_and_b32 v12, 1, v12
    v_lshlrev_b32 v12, 3, v12
    v_add_u32 v10, v11, v12
    v_cvt_pk_bf16_f32 v14, v28, v28
    buffer_store_short v14, v10, s[12:15], s26 offen
    v_add_u32 v10, 25, v9
    v_lshrrev_b32 v11, 4, v10
    v_and_b32 v11, 31, v11
    v_lshlrev_b32 v11, 7, v11
    v_lshrrev_b32 v12, 4, v4
    v_add_u32 v11, v11, v12
    v_lshlrev_b32 v11, 10, v11
    v_and_b32 v10, 15, v10
    v_lshlrev_b32 v10, 4, v10
    v_add_u32 v11, v11, v10
    v_lshrrev_b32 v12, 2, v4
    v_and_b32 v12, 1, v12
    v_lshlrev_b32 v12, 9, v12
    v_add_u32 v11, v11, v12
    v_and_b32 v12, 3, v4
    v_lshlrev_b32 v12, 1, v12
    v_add_u32 v11, v11, v12
    v_lshrrev_b32 v12, 3, v4
    v_and_b32 v12, 1, v12
    v_lshlrev_b32 v12, 3, v12
    v_add_u32 v10, v11, v12
    v_cvt_pk_bf16_f32 v14, v29, v29
    buffer_store_short v14, v10, s[12:15], s26 offen
    v_add_u32 v10, 26, v9
    v_lshrrev_b32 v11, 4, v10
    v_and_b32 v11, 31, v11
    v_lshlrev_b32 v11, 7, v11
    v_lshrrev_b32 v12, 4, v4
    v_add_u32 v11, v11, v12
    v_lshlrev_b32 v11, 10, v11
    v_and_b32 v10, 15, v10
    v_lshlrev_b32 v10, 4, v10
    v_add_u32 v11, v11, v10
    v_lshrrev_b32 v12, 2, v4
    v_and_b32 v12, 1, v12
    v_lshlrev_b32 v12, 9, v12
    v_add_u32 v11, v11, v12
    v_and_b32 v12, 3, v4
    v_lshlrev_b32 v12, 1, v12
    v_add_u32 v11, v11, v12
    v_lshrrev_b32 v12, 3, v4
    v_and_b32 v12, 1, v12
    v_lshlrev_b32 v12, 3, v12
    v_add_u32 v10, v11, v12
    v_cvt_pk_bf16_f32 v14, v30, v30
    buffer_store_short v14, v10, s[12:15], s26 offen
    v_add_u32 v10, 27, v9
    v_lshrrev_b32 v11, 4, v10
    v_and_b32 v11, 31, v11
    v_lshlrev_b32 v11, 7, v11
    v_lshrrev_b32 v12, 4, v4
    v_add_u32 v11, v11, v12
    v_lshlrev_b32 v11, 10, v11
    v_and_b32 v10, 15, v10
    v_lshlrev_b32 v10, 4, v10
    v_add_u32 v11, v11, v10
    v_lshrrev_b32 v12, 2, v4
    v_and_b32 v12, 1, v12
    v_lshlrev_b32 v12, 9, v12
    v_add_u32 v11, v11, v12
    v_and_b32 v12, 3, v4
    v_lshlrev_b32 v12, 1, v12
    v_add_u32 v11, v11, v12
    v_lshrrev_b32 v12, 3, v4
    v_and_b32 v12, 1, v12
    v_lshlrev_b32 v12, 3, v12
    v_add_u32 v10, v11, v12
    v_cvt_pk_bf16_f32 v14, v31, v31
    buffer_store_short v14, v10, s[12:15], s26 offen
L_qkv_kernel_skip00:
    s_lshl_b32 s23, s21, 6
    s_add_u32 s23, s23, 0
    s_lshl_b32 s24, s22, 6
    s_add_u32 s24, s24, 32
    s_cmp_ge_u32 s24, 1536
    s_cbranch_scc1 L_qkv_kernel_skip01
    v_add_u32 v4, s23, v2
    v_mov_b32 v16, v176
    v_mov_b32 v17, v177
    v_mov_b32 v18, v178
    v_mov_b32 v19, v179
    v_mov_b32 v20, v180
    v_mov_b32 v21, v181
    v_mov_b32 v22, v182
    v_mov_b32 v23, v183
    v_mov_b32 v24, v184
    v_mov_b32 v25, v185
    v_mov_b32 v26, v186
    v_mov_b32 v27, v187
    v_mov_b32 v28, v188
    v_mov_b32 v29, v189
    v_mov_b32 v30, v190
    v_mov_b32 v31, v191
    v_lshlrev_b32 v9, 2, v3
    v_add_u32 v9, s24, v9
    s_waitcnt lgkmcnt(0)
    s_add_u32 s12, s84, 0x800000
    s_addc_u32 s13, s85, 0
    s_mov_b32 s14, 0x800000
    s_mov_b32 s15, 0x00020000
    s_lshr_b32 s26, s24, 9
    s_cmp_eq_u32 s26, 2
    s_cbranch_scc1 L_qkv_kernel_v01
    s_cmp_eq_u32 s26, 0
    s_cselect_b32 s27, 0x3eb8aa3b, 1.0
    s_mul_i32 s26, s26, 2097152
    v_add_u32 v10, 0, v9
    v_lshrrev_b32 v11, 4, v10
    v_and_b32 v11, 31, v11
    v_lshlrev_b32 v11, 11, v11
    v_add_u32 v11, v11, v4
    v_lshlrev_b32 v11, 4, v11
    v_and_b32 v12, 15, v10
    v_add_u32 v11, v11, v12
    v_lshlrev_b32 v11, 1, v11
    v_cvt_pk_bf16_f32 v13, v16, v16
    v_lshlrev_b32 v16, 16, v13
    v_mul_f32 v16, s27, v16
    v_cvt_pk_bf16_f32 v13, v17, v17
    v_lshlrev_b32 v17, 16, v13
    v_mul_f32 v17, s27, v17
    v_cvt_pk_bf16_f32 v13, v18, v18
    v_lshlrev_b32 v18, 16, v13
    v_mul_f32 v18, s27, v18
    v_cvt_pk_bf16_f32 v13, v19, v19
    v_lshlrev_b32 v19, 16, v13
    v_mul_f32 v19, s27, v19
    v_cvt_pk_bf16_f32 v14, v16, v17
    v_cvt_pk_bf16_f32 v15, v18, v19
    buffer_store_dwordx2 v[14:15], v11, s[12:15], s26 offen
    v_add_u32 v10, 8, v9
    v_lshrrev_b32 v11, 4, v10
    v_and_b32 v11, 31, v11
    v_lshlrev_b32 v11, 11, v11
    v_add_u32 v11, v11, v4
    v_lshlrev_b32 v11, 4, v11
    v_and_b32 v12, 15, v10
    v_add_u32 v11, v11, v12
    v_lshlrev_b32 v11, 1, v11
    v_cvt_pk_bf16_f32 v13, v20, v20
    v_lshlrev_b32 v20, 16, v13
    v_mul_f32 v20, s27, v20
    v_cvt_pk_bf16_f32 v13, v21, v21
    v_lshlrev_b32 v21, 16, v13
    v_mul_f32 v21, s27, v21
    v_cvt_pk_bf16_f32 v13, v22, v22
    v_lshlrev_b32 v22, 16, v13
    v_mul_f32 v22, s27, v22
    v_cvt_pk_bf16_f32 v13, v23, v23
    v_lshlrev_b32 v23, 16, v13
    v_mul_f32 v23, s27, v23
    v_cvt_pk_bf16_f32 v14, v20, v21
    v_cvt_pk_bf16_f32 v15, v22, v23
    buffer_store_dwordx2 v[14:15], v11, s[12:15], s26 offen
    v_add_u32 v10, 16, v9
    v_lshrrev_b32 v11, 4, v10
    v_and_b32 v11, 31, v11
    v_lshlrev_b32 v11, 11, v11
    v_add_u32 v11, v11, v4
    v_lshlrev_b32 v11, 4, v11
    v_and_b32 v12, 15, v10
    v_add_u32 v11, v11, v12
    v_lshlrev_b32 v11, 1, v11
    v_cvt_pk_bf16_f32 v13, v24, v24
    v_lshlrev_b32 v24, 16, v13
    v_mul_f32 v24, s27, v24
    v_cvt_pk_bf16_f32 v13, v25, v25
    v_lshlrev_b32 v25, 16, v13
    v_mul_f32 v25, s27, v25
    v_cvt_pk_bf16_f32 v13, v26, v26
    v_lshlrev_b32 v26, 16, v13
    v_mul_f32 v26, s27, v26
    v_cvt_pk_bf16_f32 v13, v27, v27
    v_lshlrev_b32 v27, 16, v13
    v_mul_f32 v27, s27, v27
    v_cvt_pk_bf16_f32 v14, v24, v25
    v_cvt_pk_bf16_f32 v15, v26, v27
    buffer_store_dwordx2 v[14:15], v11, s[12:15], s26 offen
    v_add_u32 v10, 24, v9
    v_lshrrev_b32 v11, 4, v10
    v_and_b32 v11, 31, v11
    v_lshlrev_b32 v11, 11, v11
    v_add_u32 v11, v11, v4
    v_lshlrev_b32 v11, 4, v11
    v_and_b32 v12, 15, v10
    v_add_u32 v11, v11, v12
    v_lshlrev_b32 v11, 1, v11
    v_cvt_pk_bf16_f32 v13, v28, v28
    v_lshlrev_b32 v28, 16, v13
    v_mul_f32 v28, s27, v28
    v_cvt_pk_bf16_f32 v13, v29, v29
    v_lshlrev_b32 v29, 16, v13
    v_mul_f32 v29, s27, v29
    v_cvt_pk_bf16_f32 v13, v30, v30
    v_lshlrev_b32 v30, 16, v13
    v_mul_f32 v30, s27, v30
    v_cvt_pk_bf16_f32 v13, v31, v31
    v_lshlrev_b32 v31, 16, v13
    v_mul_f32 v31, s27, v31
    v_cvt_pk_bf16_f32 v14, v28, v29
    v_cvt_pk_bf16_f32 v15, v30, v31
    buffer_store_dwordx2 v[14:15], v11, s[12:15], s26 offen
    s_branch L_qkv_kernel_skip01
L_qkv_kernel_v01:
    s_mov_b32 s26, 4194304
    v_add_u32 v10, 0, v9
    v_lshrrev_b32 v11, 4, v10
    v_and_b32 v11, 31, v11
    v_lshlrev_b32 v11, 7, v11
    v_lshrrev_b32 v12, 4, v4
    v_add_u32 v11, v11, v12
    v_lshlrev_b32 v11, 10, v11
    v_and_b32 v10, 15, v10
    v_lshlrev_b32 v10, 4, v10
    v_add_u32 v11, v11, v10
    v_lshrrev_b32 v12, 2, v4
    v_and_b32 v12, 1, v12
    v_lshlrev_b32 v12, 9, v12
    v_add_u32 v11, v11, v12
    v_and_b32 v12, 3, v4
    v_lshlrev_b32 v12, 1, v12
    v_add_u32 v11, v11, v12
    v_lshrrev_b32 v12, 3, v4
    v_and_b32 v12, 1, v12
    v_lshlrev_b32 v12, 3, v12
    v_add_u32 v10, v11, v12
    v_cvt_pk_bf16_f32 v14, v16, v16
    buffer_store_short v14, v10, s[12:15], s26 offen
    v_add_u32 v10, 1, v9
    v_lshrrev_b32 v11, 4, v10
    v_and_b32 v11, 31, v11
    v_lshlrev_b32 v11, 7, v11
    v_lshrrev_b32 v12, 4, v4
    v_add_u32 v11, v11, v12
    v_lshlrev_b32 v11, 10, v11
    v_and_b32 v10, 15, v10
    v_lshlrev_b32 v10, 4, v10
    v_add_u32 v11, v11, v10
    v_lshrrev_b32 v12, 2, v4
    v_and_b32 v12, 1, v12
    v_lshlrev_b32 v12, 9, v12
    v_add_u32 v11, v11, v12
    v_and_b32 v12, 3, v4
    v_lshlrev_b32 v12, 1, v12
    v_add_u32 v11, v11, v12
    v_lshrrev_b32 v12, 3, v4
    v_and_b32 v12, 1, v12
    v_lshlrev_b32 v12, 3, v12
    v_add_u32 v10, v11, v12
    v_cvt_pk_bf16_f32 v14, v17, v17
    buffer_store_short v14, v10, s[12:15], s26 offen
    v_add_u32 v10, 2, v9
    v_lshrrev_b32 v11, 4, v10
    v_and_b32 v11, 31, v11
    v_lshlrev_b32 v11, 7, v11
    v_lshrrev_b32 v12, 4, v4
    v_add_u32 v11, v11, v12
    v_lshlrev_b32 v11, 10, v11
    v_and_b32 v10, 15, v10
    v_lshlrev_b32 v10, 4, v10
    v_add_u32 v11, v11, v10
    v_lshrrev_b32 v12, 2, v4
    v_and_b32 v12, 1, v12
    v_lshlrev_b32 v12, 9, v12
    v_add_u32 v11, v11, v12
    v_and_b32 v12, 3, v4
    v_lshlrev_b32 v12, 1, v12
    v_add_u32 v11, v11, v12
    v_lshrrev_b32 v12, 3, v4
    v_and_b32 v12, 1, v12
    v_lshlrev_b32 v12, 3, v12
    v_add_u32 v10, v11, v12
    v_cvt_pk_bf16_f32 v14, v18, v18
    buffer_store_short v14, v10, s[12:15], s26 offen
    v_add_u32 v10, 3, v9
    v_lshrrev_b32 v11, 4, v10
    v_and_b32 v11, 31, v11
    v_lshlrev_b32 v11, 7, v11
    v_lshrrev_b32 v12, 4, v4
    v_add_u32 v11, v11, v12
    v_lshlrev_b32 v11, 10, v11
    v_and_b32 v10, 15, v10
    v_lshlrev_b32 v10, 4, v10
    v_add_u32 v11, v11, v10
    v_lshrrev_b32 v12, 2, v4
    v_and_b32 v12, 1, v12
    v_lshlrev_b32 v12, 9, v12
    v_add_u32 v11, v11, v12
    v_and_b32 v12, 3, v4
    v_lshlrev_b32 v12, 1, v12
    v_add_u32 v11, v11, v12
    v_lshrrev_b32 v12, 3, v4
    v_and_b32 v12, 1, v12
    v_lshlrev_b32 v12, 3, v12
    v_add_u32 v10, v11, v12
    v_cvt_pk_bf16_f32 v14, v19, v19
    buffer_store_short v14, v10, s[12:15], s26 offen
    v_add_u32 v10, 8, v9
    v_lshrrev_b32 v11, 4, v10
    v_and_b32 v11, 31, v11
    v_lshlrev_b32 v11, 7, v11
    v_lshrrev_b32 v12, 4, v4
    v_add_u32 v11, v11, v12
    v_lshlrev_b32 v11, 10, v11
    v_and_b32 v10, 15, v10
    v_lshlrev_b32 v10, 4, v10
    v_add_u32 v11, v11, v10
    v_lshrrev_b32 v12, 2, v4
    v_and_b32 v12, 1, v12
    v_lshlrev_b32 v12, 9, v12
    v_add_u32 v11, v11, v12
    v_and_b32 v12, 3, v4
    v_lshlrev_b32 v12, 1, v12
    v_add_u32 v11, v11, v12
    v_lshrrev_b32 v12, 3, v4
    v_and_b32 v12, 1, v12
    v_lshlrev_b32 v12, 3, v12
    v_add_u32 v10, v11, v12
    v_cvt_pk_bf16_f32 v14, v20, v20
    buffer_store_short v14, v10, s[12:15], s26 offen
    v_add_u32 v10, 9, v9
    v_lshrrev_b32 v11, 4, v10
    v_and_b32 v11, 31, v11
    v_lshlrev_b32 v11, 7, v11
    v_lshrrev_b32 v12, 4, v4
    v_add_u32 v11, v11, v12
    v_lshlrev_b32 v11, 10, v11
    v_and_b32 v10, 15, v10
    v_lshlrev_b32 v10, 4, v10
    v_add_u32 v11, v11, v10
    v_lshrrev_b32 v12, 2, v4
    v_and_b32 v12, 1, v12
    v_lshlrev_b32 v12, 9, v12
    v_add_u32 v11, v11, v12
    v_and_b32 v12, 3, v4
    v_lshlrev_b32 v12, 1, v12
    v_add_u32 v11, v11, v12
    v_lshrrev_b32 v12, 3, v4
    v_and_b32 v12, 1, v12
    v_lshlrev_b32 v12, 3, v12
    v_add_u32 v10, v11, v12
    v_cvt_pk_bf16_f32 v14, v21, v21
    buffer_store_short v14, v10, s[12:15], s26 offen
    v_add_u32 v10, 10, v9
    v_lshrrev_b32 v11, 4, v10
    v_and_b32 v11, 31, v11
    v_lshlrev_b32 v11, 7, v11
    v_lshrrev_b32 v12, 4, v4
    v_add_u32 v11, v11, v12
    v_lshlrev_b32 v11, 10, v11
    v_and_b32 v10, 15, v10
    v_lshlrev_b32 v10, 4, v10
    v_add_u32 v11, v11, v10
    v_lshrrev_b32 v12, 2, v4
    v_and_b32 v12, 1, v12
    v_lshlrev_b32 v12, 9, v12
    v_add_u32 v11, v11, v12
    v_and_b32 v12, 3, v4
    v_lshlrev_b32 v12, 1, v12
    v_add_u32 v11, v11, v12
    v_lshrrev_b32 v12, 3, v4
    v_and_b32 v12, 1, v12
    v_lshlrev_b32 v12, 3, v12
    v_add_u32 v10, v11, v12
    v_cvt_pk_bf16_f32 v14, v22, v22
    buffer_store_short v14, v10, s[12:15], s26 offen
    v_add_u32 v10, 11, v9
    v_lshrrev_b32 v11, 4, v10
    v_and_b32 v11, 31, v11
    v_lshlrev_b32 v11, 7, v11
    v_lshrrev_b32 v12, 4, v4
    v_add_u32 v11, v11, v12
    v_lshlrev_b32 v11, 10, v11
    v_and_b32 v10, 15, v10
    v_lshlrev_b32 v10, 4, v10
    v_add_u32 v11, v11, v10
    v_lshrrev_b32 v12, 2, v4
    v_and_b32 v12, 1, v12
    v_lshlrev_b32 v12, 9, v12
    v_add_u32 v11, v11, v12
    v_and_b32 v12, 3, v4
    v_lshlrev_b32 v12, 1, v12
    v_add_u32 v11, v11, v12
    v_lshrrev_b32 v12, 3, v4
    v_and_b32 v12, 1, v12
    v_lshlrev_b32 v12, 3, v12
    v_add_u32 v10, v11, v12
    v_cvt_pk_bf16_f32 v14, v23, v23
    buffer_store_short v14, v10, s[12:15], s26 offen
    v_add_u32 v10, 16, v9
    v_lshrrev_b32 v11, 4, v10
    v_and_b32 v11, 31, v11
    v_lshlrev_b32 v11, 7, v11
    v_lshrrev_b32 v12, 4, v4
    v_add_u32 v11, v11, v12
    v_lshlrev_b32 v11, 10, v11
    v_and_b32 v10, 15, v10
    v_lshlrev_b32 v10, 4, v10
    v_add_u32 v11, v11, v10
    v_lshrrev_b32 v12, 2, v4
    v_and_b32 v12, 1, v12
    v_lshlrev_b32 v12, 9, v12
    v_add_u32 v11, v11, v12
    v_and_b32 v12, 3, v4
    v_lshlrev_b32 v12, 1, v12
    v_add_u32 v11, v11, v12
    v_lshrrev_b32 v12, 3, v4
    v_and_b32 v12, 1, v12
    v_lshlrev_b32 v12, 3, v12
    v_add_u32 v10, v11, v12
    v_cvt_pk_bf16_f32 v14, v24, v24
    buffer_store_short v14, v10, s[12:15], s26 offen
    v_add_u32 v10, 17, v9
    v_lshrrev_b32 v11, 4, v10
    v_and_b32 v11, 31, v11
    v_lshlrev_b32 v11, 7, v11
    v_lshrrev_b32 v12, 4, v4
    v_add_u32 v11, v11, v12
    v_lshlrev_b32 v11, 10, v11
    v_and_b32 v10, 15, v10
    v_lshlrev_b32 v10, 4, v10
    v_add_u32 v11, v11, v10
    v_lshrrev_b32 v12, 2, v4
    v_and_b32 v12, 1, v12
    v_lshlrev_b32 v12, 9, v12
    v_add_u32 v11, v11, v12
    v_and_b32 v12, 3, v4
    v_lshlrev_b32 v12, 1, v12
    v_add_u32 v11, v11, v12
    v_lshrrev_b32 v12, 3, v4
    v_and_b32 v12, 1, v12
    v_lshlrev_b32 v12, 3, v12
    v_add_u32 v10, v11, v12
    v_cvt_pk_bf16_f32 v14, v25, v25
    buffer_store_short v14, v10, s[12:15], s26 offen
    v_add_u32 v10, 18, v9
    v_lshrrev_b32 v11, 4, v10
    v_and_b32 v11, 31, v11
    v_lshlrev_b32 v11, 7, v11
    v_lshrrev_b32 v12, 4, v4
    v_add_u32 v11, v11, v12
    v_lshlrev_b32 v11, 10, v11
    v_and_b32 v10, 15, v10
    v_lshlrev_b32 v10, 4, v10
    v_add_u32 v11, v11, v10
    v_lshrrev_b32 v12, 2, v4
    v_and_b32 v12, 1, v12
    v_lshlrev_b32 v12, 9, v12
    v_add_u32 v11, v11, v12
    v_and_b32 v12, 3, v4
    v_lshlrev_b32 v12, 1, v12
    v_add_u32 v11, v11, v12
    v_lshrrev_b32 v12, 3, v4
    v_and_b32 v12, 1, v12
    v_lshlrev_b32 v12, 3, v12
    v_add_u32 v10, v11, v12
    v_cvt_pk_bf16_f32 v14, v26, v26
    buffer_store_short v14, v10, s[12:15], s26 offen
    v_add_u32 v10, 19, v9
    v_lshrrev_b32 v11, 4, v10
    v_and_b32 v11, 31, v11
    v_lshlrev_b32 v11, 7, v11
    v_lshrrev_b32 v12, 4, v4
    v_add_u32 v11, v11, v12
    v_lshlrev_b32 v11, 10, v11
    v_and_b32 v10, 15, v10
    v_lshlrev_b32 v10, 4, v10
    v_add_u32 v11, v11, v10
    v_lshrrev_b32 v12, 2, v4
    v_and_b32 v12, 1, v12
    v_lshlrev_b32 v12, 9, v12
    v_add_u32 v11, v11, v12
    v_and_b32 v12, 3, v4
    v_lshlrev_b32 v12, 1, v12
    v_add_u32 v11, v11, v12
    v_lshrrev_b32 v12, 3, v4
    v_and_b32 v12, 1, v12
    v_lshlrev_b32 v12, 3, v12
    v_add_u32 v10, v11, v12
    v_cvt_pk_bf16_f32 v14, v27, v27
    buffer_store_short v14, v10, s[12:15], s26 offen
    v_add_u32 v10, 24, v9
    v_lshrrev_b32 v11, 4, v10
    v_and_b32 v11, 31, v11
    v_lshlrev_b32 v11, 7, v11
    v_lshrrev_b32 v12, 4, v4
    v_add_u32 v11, v11, v12
    v_lshlrev_b32 v11, 10, v11
    v_and_b32 v10, 15, v10
    v_lshlrev_b32 v10, 4, v10
    v_add_u32 v11, v11, v10
    v_lshrrev_b32 v12, 2, v4
    v_and_b32 v12, 1, v12
    v_lshlrev_b32 v12, 9, v12
    v_add_u32 v11, v11, v12
    v_and_b32 v12, 3, v4
    v_lshlrev_b32 v12, 1, v12
    v_add_u32 v11, v11, v12
    v_lshrrev_b32 v12, 3, v4
    v_and_b32 v12, 1, v12
    v_lshlrev_b32 v12, 3, v12
    v_add_u32 v10, v11, v12
    v_cvt_pk_bf16_f32 v14, v28, v28
    buffer_store_short v14, v10, s[12:15], s26 offen
    v_add_u32 v10, 25, v9
    v_lshrrev_b32 v11, 4, v10
    v_and_b32 v11, 31, v11
    v_lshlrev_b32 v11, 7, v11
    v_lshrrev_b32 v12, 4, v4
    v_add_u32 v11, v11, v12
    v_lshlrev_b32 v11, 10, v11
    v_and_b32 v10, 15, v10
    v_lshlrev_b32 v10, 4, v10
    v_add_u32 v11, v11, v10
    v_lshrrev_b32 v12, 2, v4
    v_and_b32 v12, 1, v12
    v_lshlrev_b32 v12, 9, v12
    v_add_u32 v11, v11, v12
    v_and_b32 v12, 3, v4
    v_lshlrev_b32 v12, 1, v12
    v_add_u32 v11, v11, v12
    v_lshrrev_b32 v12, 3, v4
    v_and_b32 v12, 1, v12
    v_lshlrev_b32 v12, 3, v12
    v_add_u32 v10, v11, v12
    v_cvt_pk_bf16_f32 v14, v29, v29
    buffer_store_short v14, v10, s[12:15], s26 offen
    v_add_u32 v10, 26, v9
    v_lshrrev_b32 v11, 4, v10
    v_and_b32 v11, 31, v11
    v_lshlrev_b32 v11, 7, v11
    v_lshrrev_b32 v12, 4, v4
    v_add_u32 v11, v11, v12
    v_lshlrev_b32 v11, 10, v11
    v_and_b32 v10, 15, v10
    v_lshlrev_b32 v10, 4, v10
    v_add_u32 v11, v11, v10
    v_lshrrev_b32 v12, 2, v4
    v_and_b32 v12, 1, v12
    v_lshlrev_b32 v12, 9, v12
    v_add_u32 v11, v11, v12
    v_and_b32 v12, 3, v4
    v_lshlrev_b32 v12, 1, v12
    v_add_u32 v11, v11, v12
    v_lshrrev_b32 v12, 3, v4
    v_and_b32 v12, 1, v12
    v_lshlrev_b32 v12, 3, v12
    v_add_u32 v10, v11, v12
    v_cvt_pk_bf16_f32 v14, v30, v30
    buffer_store_short v14, v10, s[12:15], s26 offen
    v_add_u32 v10, 27, v9
    v_lshrrev_b32 v11, 4, v10
    v_and_b32 v11, 31, v11
    v_lshlrev_b32 v11, 7, v11
    v_lshrrev_b32 v12, 4, v4
    v_add_u32 v11, v11, v12
    v_lshlrev_b32 v11, 10, v11
    v_and_b32 v10, 15, v10
    v_lshlrev_b32 v10, 4, v10
    v_add_u32 v11, v11, v10
    v_lshrrev_b32 v12, 2, v4
    v_and_b32 v12, 1, v12
    v_lshlrev_b32 v12, 9, v12
    v_add_u32 v11, v11, v12
    v_and_b32 v12, 3, v4
    v_lshlrev_b32 v12, 1, v12
    v_add_u32 v11, v11, v12
    v_lshrrev_b32 v12, 3, v4
    v_and_b32 v12, 1, v12
    v_lshlrev_b32 v12, 3, v12
    v_add_u32 v10, v11, v12
    v_cvt_pk_bf16_f32 v14, v31, v31
    buffer_store_short v14, v10, s[12:15], s26 offen
L_qkv_kernel_skip01:
    s_lshl_b32 s23, s21, 6
    s_add_u32 s23, s23, 32
    s_lshl_b32 s24, s22, 6
    s_add_u32 s24, s24, 0
    s_cmp_ge_u32 s24, 1536
    s_cbranch_scc1 L_qkv_kernel_skip10
    v_add_u32 v4, s23, v2
    v_mov_b32 v16, v192
    v_mov_b32 v17, v193
    v_mov_b32 v18, v194
    v_mov_b32 v19, v195
    v_mov_b32 v20, v196
    v_mov_b32 v21, v197
    v_mov_b32 v22, v198
    v_mov_b32 v23, v199
    v_mov_b32 v24, v200
    v_mov_b32 v25, v201
    v_mov_b32 v26, v202
    v_mov_b32 v27, v203
    v_mov_b32 v28, v204
    v_mov_b32 v29, v205
    v_mov_b32 v30, v206
    v_mov_b32 v31, v207
    v_lshlrev_b32 v9, 2, v3
    v_add_u32 v9, s24, v9
    s_waitcnt lgkmcnt(0)
    s_add_u32 s12, s84, 0x800000
    s_addc_u32 s13, s85, 0
    s_mov_b32 s14, 0x800000
    s_mov_b32 s15, 0x00020000
    s_lshr_b32 s26, s24, 9
    s_cmp_eq_u32 s26, 2
    s_cbranch_scc1 L_qkv_kernel_v10
    s_cmp_eq_u32 s26, 0
    s_cselect_b32 s27, 0x3eb8aa3b, 1.0
    s_mul_i32 s26, s26, 2097152
    v_add_u32 v10, 0, v9
    v_lshrrev_b32 v11, 4, v10
    v_and_b32 v11, 31, v11
    v_lshlrev_b32 v11, 11, v11
    v_add_u32 v11, v11, v4
    v_lshlrev_b32 v11, 4, v11
    v_and_b32 v12, 15, v10
    v_add_u32 v11, v11, v12
    v_lshlrev_b32 v11, 1, v11
    v_cvt_pk_bf16_f32 v13, v16, v16
    v_lshlrev_b32 v16, 16, v13
    v_mul_f32 v16, s27, v16
    v_cvt_pk_bf16_f32 v13, v17, v17
    v_lshlrev_b32 v17, 16, v13
    v_mul_f32 v17, s27, v17
    v_cvt_pk_bf16_f32 v13, v18, v18
    v_lshlrev_b32 v18, 16, v13
    v_mul_f32 v18, s27, v18
    v_cvt_pk_bf16_f32 v13, v19, v19
    v_lshlrev_b32 v19, 16, v13
    v_mul_f32 v19, s27, v19
    v_cvt_pk_bf16_f32 v14, v16, v17
    v_cvt_pk_bf16_f32 v15, v18, v19
    buffer_store_dwordx2 v[14:15], v11, s[12:15], s26 offen
    v_add_u32 v10, 8, v9
    v_lshrrev_b32 v11, 4, v10
    v_and_b32 v11, 31, v11
    v_lshlrev_b32 v11, 11, v11
    v_add_u32 v11, v11, v4
    v_lshlrev_b32 v11, 4, v11
    v_and_b32 v12, 15, v10
    v_add_u32 v11, v11, v12
    v_lshlrev_b32 v11, 1, v11
    v_cvt_pk_bf16_f32 v13, v20, v20
    v_lshlrev_b32 v20, 16, v13
    v_mul_f32 v20, s27, v20
    v_cvt_pk_bf16_f32 v13, v21, v21
    v_lshlrev_b32 v21, 16, v13
    v_mul_f32 v21, s27, v21
    v_cvt_pk_bf16_f32 v13, v22, v22
    v_lshlrev_b32 v22, 16, v13
    v_mul_f32 v22, s27, v22
    v_cvt_pk_bf16_f32 v13, v23, v23
    v_lshlrev_b32 v23, 16, v13
    v_mul_f32 v23, s27, v23
    v_cvt_pk_bf16_f32 v14, v20, v21
    v_cvt_pk_bf16_f32 v15, v22, v23
    buffer_store_dwordx2 v[14:15], v11, s[12:15], s26 offen
    v_add_u32 v10, 16, v9
    v_lshrrev_b32 v11, 4, v10
    v_and_b32 v11, 31, v11
    v_lshlrev_b32 v11, 11, v11
    v_add_u32 v11, v11, v4
    v_lshlrev_b32 v11, 4, v11
    v_and_b32 v12, 15, v10
    v_add_u32 v11, v11, v12
    v_lshlrev_b32 v11, 1, v11
    v_cvt_pk_bf16_f32 v13, v24, v24
    v_lshlrev_b32 v24, 16, v13
    v_mul_f32 v24, s27, v24
    v_cvt_pk_bf16_f32 v13, v25, v25
    v_lshlrev_b32 v25, 16, v13
    v_mul_f32 v25, s27, v25
    v_cvt_pk_bf16_f32 v13, v26, v26
    v_lshlrev_b32 v26, 16, v13
    v_mul_f32 v26, s27, v26
    v_cvt_pk_bf16_f32 v13, v27, v27
    v_lshlrev_b32 v27, 16, v13
    v_mul_f32 v27, s27, v27
    v_cvt_pk_bf16_f32 v14, v24, v25
    v_cvt_pk_bf16_f32 v15, v26, v27
    buffer_store_dwordx2 v[14:15], v11, s[12:15], s26 offen
    v_add_u32 v10, 24, v9
    v_lshrrev_b32 v11, 4, v10
    v_and_b32 v11, 31, v11
    v_lshlrev_b32 v11, 11, v11
    v_add_u32 v11, v11, v4
    v_lshlrev_b32 v11, 4, v11
    v_and_b32 v12, 15, v10
    v_add_u32 v11, v11, v12
    v_lshlrev_b32 v11, 1, v11
    v_cvt_pk_bf16_f32 v13, v28, v28
    v_lshlrev_b32 v28, 16, v13
    v_mul_f32 v28, s27, v28
    v_cvt_pk_bf16_f32 v13, v29, v29
    v_lshlrev_b32 v29, 16, v13
    v_mul_f32 v29, s27, v29
    v_cvt_pk_bf16_f32 v13, v30, v30
    v_lshlrev_b32 v30, 16, v13
    v_mul_f32 v30, s27, v30
    v_cvt_pk_bf16_f32 v13, v31, v31
    v_lshlrev_b32 v31, 16, v13
    v_mul_f32 v31, s27, v31
    v_cvt_pk_bf16_f32 v14, v28, v29
    v_cvt_pk_bf16_f32 v15, v30, v31
    buffer_store_dwordx2 v[14:15], v11, s[12:15], s26 offen
    s_branch L_qkv_kernel_skip10
L_qkv_kernel_v10:
    s_mov_b32 s26, 4194304
    v_add_u32 v10, 0, v9
    v_lshrrev_b32 v11, 4, v10
    v_and_b32 v11, 31, v11
    v_lshlrev_b32 v11, 7, v11
    v_lshrrev_b32 v12, 4, v4
    v_add_u32 v11, v11, v12
    v_lshlrev_b32 v11, 10, v11
    v_and_b32 v10, 15, v10
    v_lshlrev_b32 v10, 4, v10
    v_add_u32 v11, v11, v10
    v_lshrrev_b32 v12, 2, v4
    v_and_b32 v12, 1, v12
    v_lshlrev_b32 v12, 9, v12
    v_add_u32 v11, v11, v12
    v_and_b32 v12, 3, v4
    v_lshlrev_b32 v12, 1, v12
    v_add_u32 v11, v11, v12
    v_lshrrev_b32 v12, 3, v4
    v_and_b32 v12, 1, v12
    v_lshlrev_b32 v12, 3, v12
    v_add_u32 v10, v11, v12
    v_cvt_pk_bf16_f32 v14, v16, v16
    buffer_store_short v14, v10, s[12:15], s26 offen
    v_add_u32 v10, 1, v9
    v_lshrrev_b32 v11, 4, v10
    v_and_b32 v11, 31, v11
    v_lshlrev_b32 v11, 7, v11
    v_lshrrev_b32 v12, 4, v4
    v_add_u32 v11, v11, v12
    v_lshlrev_b32 v11, 10, v11
    v_and_b32 v10, 15, v10
    v_lshlrev_b32 v10, 4, v10
    v_add_u32 v11, v11, v10
    v_lshrrev_b32 v12, 2, v4
    v_and_b32 v12, 1, v12
    v_lshlrev_b32 v12, 9, v12
    v_add_u32 v11, v11, v12
    v_and_b32 v12, 3, v4
    v_lshlrev_b32 v12, 1, v12
    v_add_u32 v11, v11, v12
    v_lshrrev_b32 v12, 3, v4
    v_and_b32 v12, 1, v12
    v_lshlrev_b32 v12, 3, v12
    v_add_u32 v10, v11, v12
    v_cvt_pk_bf16_f32 v14, v17, v17
    buffer_store_short v14, v10, s[12:15], s26 offen
    v_add_u32 v10, 2, v9
    v_lshrrev_b32 v11, 4, v10
    v_and_b32 v11, 31, v11
    v_lshlrev_b32 v11, 7, v11
    v_lshrrev_b32 v12, 4, v4
    v_add_u32 v11, v11, v12
    v_lshlrev_b32 v11, 10, v11
    v_and_b32 v10, 15, v10
    v_lshlrev_b32 v10, 4, v10
    v_add_u32 v11, v11, v10
    v_lshrrev_b32 v12, 2, v4
    v_and_b32 v12, 1, v12
    v_lshlrev_b32 v12, 9, v12
    v_add_u32 v11, v11, v12
    v_and_b32 v12, 3, v4
    v_lshlrev_b32 v12, 1, v12
    v_add_u32 v11, v11, v12
    v_lshrrev_b32 v12, 3, v4
    v_and_b32 v12, 1, v12
    v_lshlrev_b32 v12, 3, v12
    v_add_u32 v10, v11, v12
    v_cvt_pk_bf16_f32 v14, v18, v18
    buffer_store_short v14, v10, s[12:15], s26 offen
    v_add_u32 v10, 3, v9
    v_lshrrev_b32 v11, 4, v10
    v_and_b32 v11, 31, v11
    v_lshlrev_b32 v11, 7, v11
    v_lshrrev_b32 v12, 4, v4
    v_add_u32 v11, v11, v12
    v_lshlrev_b32 v11, 10, v11
    v_and_b32 v10, 15, v10
    v_lshlrev_b32 v10, 4, v10
    v_add_u32 v11, v11, v10
    v_lshrrev_b32 v12, 2, v4
    v_and_b32 v12, 1, v12
    v_lshlrev_b32 v12, 9, v12
    v_add_u32 v11, v11, v12
    v_and_b32 v12, 3, v4
    v_lshlrev_b32 v12, 1, v12
    v_add_u32 v11, v11, v12
    v_lshrrev_b32 v12, 3, v4
    v_and_b32 v12, 1, v12
    v_lshlrev_b32 v12, 3, v12
    v_add_u32 v10, v11, v12
    v_cvt_pk_bf16_f32 v14, v19, v19
    buffer_store_short v14, v10, s[12:15], s26 offen
    v_add_u32 v10, 8, v9
    v_lshrrev_b32 v11, 4, v10
    v_and_b32 v11, 31, v11
    v_lshlrev_b32 v11, 7, v11
    v_lshrrev_b32 v12, 4, v4
    v_add_u32 v11, v11, v12
    v_lshlrev_b32 v11, 10, v11
    v_and_b32 v10, 15, v10
    v_lshlrev_b32 v10, 4, v10
    v_add_u32 v11, v11, v10
    v_lshrrev_b32 v12, 2, v4
    v_and_b32 v12, 1, v12
    v_lshlrev_b32 v12, 9, v12
    v_add_u32 v11, v11, v12
    v_and_b32 v12, 3, v4
    v_lshlrev_b32 v12, 1, v12
    v_add_u32 v11, v11, v12
    v_lshrrev_b32 v12, 3, v4
    v_and_b32 v12, 1, v12
    v_lshlrev_b32 v12, 3, v12
    v_add_u32 v10, v11, v12
    v_cvt_pk_bf16_f32 v14, v20, v20
    buffer_store_short v14, v10, s[12:15], s26 offen
    v_add_u32 v10, 9, v9
    v_lshrrev_b32 v11, 4, v10
    v_and_b32 v11, 31, v11
    v_lshlrev_b32 v11, 7, v11
    v_lshrrev_b32 v12, 4, v4
    v_add_u32 v11, v11, v12
    v_lshlrev_b32 v11, 10, v11
    v_and_b32 v10, 15, v10
    v_lshlrev_b32 v10, 4, v10
    v_add_u32 v11, v11, v10
    v_lshrrev_b32 v12, 2, v4
    v_and_b32 v12, 1, v12
    v_lshlrev_b32 v12, 9, v12
    v_add_u32 v11, v11, v12
    v_and_b32 v12, 3, v4
    v_lshlrev_b32 v12, 1, v12
    v_add_u32 v11, v11, v12
    v_lshrrev_b32 v12, 3, v4
    v_and_b32 v12, 1, v12
    v_lshlrev_b32 v12, 3, v12
    v_add_u32 v10, v11, v12
    v_cvt_pk_bf16_f32 v14, v21, v21
    buffer_store_short v14, v10, s[12:15], s26 offen
    v_add_u32 v10, 10, v9
    v_lshrrev_b32 v11, 4, v10
    v_and_b32 v11, 31, v11
    v_lshlrev_b32 v11, 7, v11
    v_lshrrev_b32 v12, 4, v4
    v_add_u32 v11, v11, v12
    v_lshlrev_b32 v11, 10, v11
    v_and_b32 v10, 15, v10
    v_lshlrev_b32 v10, 4, v10
    v_add_u32 v11, v11, v10
    v_lshrrev_b32 v12, 2, v4
    v_and_b32 v12, 1, v12
    v_lshlrev_b32 v12, 9, v12
    v_add_u32 v11, v11, v12
    v_and_b32 v12, 3, v4
    v_lshlrev_b32 v12, 1, v12
    v_add_u32 v11, v11, v12
    v_lshrrev_b32 v12, 3, v4
    v_and_b32 v12, 1, v12
    v_lshlrev_b32 v12, 3, v12
    v_add_u32 v10, v11, v12
    v_cvt_pk_bf16_f32 v14, v22, v22
    buffer_store_short v14, v10, s[12:15], s26 offen
    v_add_u32 v10, 11, v9
    v_lshrrev_b32 v11, 4, v10
    v_and_b32 v11, 31, v11
    v_lshlrev_b32 v11, 7, v11
    v_lshrrev_b32 v12, 4, v4
    v_add_u32 v11, v11, v12
    v_lshlrev_b32 v11, 10, v11
    v_and_b32 v10, 15, v10
    v_lshlrev_b32 v10, 4, v10
    v_add_u32 v11, v11, v10
    v_lshrrev_b32 v12, 2, v4
    v_and_b32 v12, 1, v12
    v_lshlrev_b32 v12, 9, v12
    v_add_u32 v11, v11, v12
    v_and_b32 v12, 3, v4
    v_lshlrev_b32 v12, 1, v12
    v_add_u32 v11, v11, v12
    v_lshrrev_b32 v12, 3, v4
    v_and_b32 v12, 1, v12
    v_lshlrev_b32 v12, 3, v12
    v_add_u32 v10, v11, v12
    v_cvt_pk_bf16_f32 v14, v23, v23
    buffer_store_short v14, v10, s[12:15], s26 offen
    v_add_u32 v10, 16, v9
    v_lshrrev_b32 v11, 4, v10
    v_and_b32 v11, 31, v11
    v_lshlrev_b32 v11, 7, v11
    v_lshrrev_b32 v12, 4, v4
    v_add_u32 v11, v11, v12
    v_lshlrev_b32 v11, 10, v11
    v_and_b32 v10, 15, v10
    v_lshlrev_b32 v10, 4, v10
    v_add_u32 v11, v11, v10
    v_lshrrev_b32 v12, 2, v4
    v_and_b32 v12, 1, v12
    v_lshlrev_b32 v12, 9, v12
    v_add_u32 v11, v11, v12
    v_and_b32 v12, 3, v4
    v_lshlrev_b32 v12, 1, v12
    v_add_u32 v11, v11, v12
    v_lshrrev_b32 v12, 3, v4
    v_and_b32 v12, 1, v12
    v_lshlrev_b32 v12, 3, v12
    v_add_u32 v10, v11, v12
    v_cvt_pk_bf16_f32 v14, v24, v24
    buffer_store_short v14, v10, s[12:15], s26 offen
    v_add_u32 v10, 17, v9
    v_lshrrev_b32 v11, 4, v10
    v_and_b32 v11, 31, v11
    v_lshlrev_b32 v11, 7, v11
    v_lshrrev_b32 v12, 4, v4
    v_add_u32 v11, v11, v12
    v_lshlrev_b32 v11, 10, v11
    v_and_b32 v10, 15, v10
    v_lshlrev_b32 v10, 4, v10
    v_add_u32 v11, v11, v10
    v_lshrrev_b32 v12, 2, v4
    v_and_b32 v12, 1, v12
    v_lshlrev_b32 v12, 9, v12
    v_add_u32 v11, v11, v12
    v_and_b32 v12, 3, v4
    v_lshlrev_b32 v12, 1, v12
    v_add_u32 v11, v11, v12
    v_lshrrev_b32 v12, 3, v4
    v_and_b32 v12, 1, v12
    v_lshlrev_b32 v12, 3, v12
    v_add_u32 v10, v11, v12
    v_cvt_pk_bf16_f32 v14, v25, v25
    buffer_store_short v14, v10, s[12:15], s26 offen
    v_add_u32 v10, 18, v9
    v_lshrrev_b32 v11, 4, v10
    v_and_b32 v11, 31, v11
    v_lshlrev_b32 v11, 7, v11
    v_lshrrev_b32 v12, 4, v4
    v_add_u32 v11, v11, v12
    v_lshlrev_b32 v11, 10, v11
    v_and_b32 v10, 15, v10
    v_lshlrev_b32 v10, 4, v10
    v_add_u32 v11, v11, v10
    v_lshrrev_b32 v12, 2, v4
    v_and_b32 v12, 1, v12
    v_lshlrev_b32 v12, 9, v12
    v_add_u32 v11, v11, v12
    v_and_b32 v12, 3, v4
    v_lshlrev_b32 v12, 1, v12
    v_add_u32 v11, v11, v12
    v_lshrrev_b32 v12, 3, v4
    v_and_b32 v12, 1, v12
    v_lshlrev_b32 v12, 3, v12
    v_add_u32 v10, v11, v12
    v_cvt_pk_bf16_f32 v14, v26, v26
    buffer_store_short v14, v10, s[12:15], s26 offen
    v_add_u32 v10, 19, v9
    v_lshrrev_b32 v11, 4, v10
    v_and_b32 v11, 31, v11
    v_lshlrev_b32 v11, 7, v11
    v_lshrrev_b32 v12, 4, v4
    v_add_u32 v11, v11, v12
    v_lshlrev_b32 v11, 10, v11
    v_and_b32 v10, 15, v10
    v_lshlrev_b32 v10, 4, v10
    v_add_u32 v11, v11, v10
    v_lshrrev_b32 v12, 2, v4
    v_and_b32 v12, 1, v12
    v_lshlrev_b32 v12, 9, v12
    v_add_u32 v11, v11, v12
    v_and_b32 v12, 3, v4
    v_lshlrev_b32 v12, 1, v12
    v_add_u32 v11, v11, v12
    v_lshrrev_b32 v12, 3, v4
    v_and_b32 v12, 1, v12
    v_lshlrev_b32 v12, 3, v12
    v_add_u32 v10, v11, v12
    v_cvt_pk_bf16_f32 v14, v27, v27
    buffer_store_short v14, v10, s[12:15], s26 offen
    v_add_u32 v10, 24, v9
    v_lshrrev_b32 v11, 4, v10
    v_and_b32 v11, 31, v11
    v_lshlrev_b32 v11, 7, v11
    v_lshrrev_b32 v12, 4, v4
    v_add_u32 v11, v11, v12
    v_lshlrev_b32 v11, 10, v11
    v_and_b32 v10, 15, v10
    v_lshlrev_b32 v10, 4, v10
    v_add_u32 v11, v11, v10
    v_lshrrev_b32 v12, 2, v4
    v_and_b32 v12, 1, v12
    v_lshlrev_b32 v12, 9, v12
    v_add_u32 v11, v11, v12
    v_and_b32 v12, 3, v4
    v_lshlrev_b32 v12, 1, v12
    v_add_u32 v11, v11, v12
    v_lshrrev_b32 v12, 3, v4
    v_and_b32 v12, 1, v12
    v_lshlrev_b32 v12, 3, v12
    v_add_u32 v10, v11, v12
    v_cvt_pk_bf16_f32 v14, v28, v28
    buffer_store_short v14, v10, s[12:15], s26 offen
    v_add_u32 v10, 25, v9
    v_lshrrev_b32 v11, 4, v10
    v_and_b32 v11, 31, v11
    v_lshlrev_b32 v11, 7, v11
    v_lshrrev_b32 v12, 4, v4
    v_add_u32 v11, v11, v12
    v_lshlrev_b32 v11, 10, v11
    v_and_b32 v10, 15, v10
    v_lshlrev_b32 v10, 4, v10
    v_add_u32 v11, v11, v10
    v_lshrrev_b32 v12, 2, v4
    v_and_b32 v12, 1, v12
    v_lshlrev_b32 v12, 9, v12
    v_add_u32 v11, v11, v12
    v_and_b32 v12, 3, v4
    v_lshlrev_b32 v12, 1, v12
    v_add_u32 v11, v11, v12
    v_lshrrev_b32 v12, 3, v4
    v_and_b32 v12, 1, v12
    v_lshlrev_b32 v12, 3, v12
    v_add_u32 v10, v11, v12
    v_cvt_pk_bf16_f32 v14, v29, v29
    buffer_store_short v14, v10, s[12:15], s26 offen
    v_add_u32 v10, 26, v9
    v_lshrrev_b32 v11, 4, v10
    v_and_b32 v11, 31, v11
    v_lshlrev_b32 v11, 7, v11
    v_lshrrev_b32 v12, 4, v4
    v_add_u32 v11, v11, v12
    v_lshlrev_b32 v11, 10, v11
    v_and_b32 v10, 15, v10
    v_lshlrev_b32 v10, 4, v10
    v_add_u32 v11, v11, v10
    v_lshrrev_b32 v12, 2, v4
    v_and_b32 v12, 1, v12
    v_lshlrev_b32 v12, 9, v12
    v_add_u32 v11, v11, v12
    v_and_b32 v12, 3, v4
    v_lshlrev_b32 v12, 1, v12
    v_add_u32 v11, v11, v12
    v_lshrrev_b32 v12, 3, v4
    v_and_b32 v12, 1, v12
    v_lshlrev_b32 v12, 3, v12
    v_add_u32 v10, v11, v12
    v_cvt_pk_bf16_f32 v14, v30, v30
    buffer_store_short v14, v10, s[12:15], s26 offen
    v_add_u32 v10, 27, v9
    v_lshrrev_b32 v11, 4, v10
    v_and_b32 v11, 31, v11
    v_lshlrev_b32 v11, 7, v11
    v_lshrrev_b32 v12, 4, v4
    v_add_u32 v11, v11, v12
    v_lshlrev_b32 v11, 10, v11
    v_and_b32 v10, 15, v10
    v_lshlrev_b32 v10, 4, v10
    v_add_u32 v11, v11, v10
    v_lshrrev_b32 v12, 2, v4
    v_and_b32 v12, 1, v12
    v_lshlrev_b32 v12, 9, v12
    v_add_u32 v11, v11, v12
    v_and_b32 v12, 3, v4
    v_lshlrev_b32 v12, 1, v12
    v_add_u32 v11, v11, v12
    v_lshrrev_b32 v12, 3, v4
    v_and_b32 v12, 1, v12
    v_lshlrev_b32 v12, 3, v12
    v_add_u32 v10, v11, v12
    v_cvt_pk_bf16_f32 v14, v31, v31
    buffer_store_short v14, v10, s[12:15], s26 offen
L_qkv_kernel_skip10:
    s_lshl_b32 s23, s21, 6
    s_add_u32 s23, s23, 32
    s_lshl_b32 s24, s22, 6
    s_add_u32 s24, s24, 32
    s_cmp_ge_u32 s24, 1536
    s_cbranch_scc1 L_qkv_kernel_skip11
    v_add_u32 v4, s23, v2
    v_mov_b32 v16, v208
    v_mov_b32 v17, v209
    v_mov_b32 v18, v210
    v_mov_b32 v19, v211
    v_mov_b32 v20, v212
    v_mov_b32 v21, v213
    v_mov_b32 v22, v214
    v_mov_b32 v23, v215
    v_mov_b32 v24, v216
    v_mov_b32 v25, v217
    v_mov_b32 v26, v218
    v_mov_b32 v27, v219
    v_mov_b32 v28, v220
    v_mov_b32 v29, v221
    v_mov_b32 v30, v222
    v_mov_b32 v31, v223
    v_lshlrev_b32 v9, 2, v3
    v_add_u32 v9, s24, v9
    s_waitcnt lgkmcnt(0)
    s_add_u32 s12, s84, 0x800000
    s_addc_u32 s13, s85, 0
    s_mov_b32 s14, 0x800000
    s_mov_b32 s15, 0x00020000
    s_lshr_b32 s26, s24, 9
    s_cmp_eq_u32 s26, 2
    s_cbranch_scc1 L_qkv_kernel_v11
    s_cmp_eq_u32 s26, 0
    s_cselect_b32 s27, 0x3eb8aa3b, 1.0
    s_mul_i32 s26, s26, 2097152
    v_add_u32 v10, 0, v9
    v_lshrrev_b32 v11, 4, v10
    v_and_b32 v11, 31, v11
    v_lshlrev_b32 v11, 11, v11
    v_add_u32 v11, v11, v4
    v_lshlrev_b32 v11, 4, v11
    v_and_b32 v12, 15, v10
    v_add_u32 v11, v11, v12
    v_lshlrev_b32 v11, 1, v11
    v_cvt_pk_bf16_f32 v13, v16, v16
    v_lshlrev_b32 v16, 16, v13
    v_mul_f32 v16, s27, v16
    v_cvt_pk_bf16_f32 v13, v17, v17
    v_lshlrev_b32 v17, 16, v13
    v_mul_f32 v17, s27, v17
    v_cvt_pk_bf16_f32 v13, v18, v18
    v_lshlrev_b32 v18, 16, v13
    v_mul_f32 v18, s27, v18
    v_cvt_pk_bf16_f32 v13, v19, v19
    v_lshlrev_b32 v19, 16, v13
    v_mul_f32 v19, s27, v19
    v_cvt_pk_bf16_f32 v14, v16, v17
    v_cvt_pk_bf16_f32 v15, v18, v19
    buffer_store_dwordx2 v[14:15], v11, s[12:15], s26 offen
    v_add_u32 v10, 8, v9
    v_lshrrev_b32 v11, 4, v10
    v_and_b32 v11, 31, v11
    v_lshlrev_b32 v11, 11, v11
    v_add_u32 v11, v11, v4
    v_lshlrev_b32 v11, 4, v11
    v_and_b32 v12, 15, v10
    v_add_u32 v11, v11, v12
    v_lshlrev_b32 v11, 1, v11
    v_cvt_pk_bf16_f32 v13, v20, v20
    v_lshlrev_b32 v20, 16, v13
    v_mul_f32 v20, s27, v20
    v_cvt_pk_bf16_f32 v13, v21, v21
    v_lshlrev_b32 v21, 16, v13
    v_mul_f32 v21, s27, v21
    v_cvt_pk_bf16_f32 v13, v22, v22
    v_lshlrev_b32 v22, 16, v13
    v_mul_f32 v22, s27, v22
    v_cvt_pk_bf16_f32 v13, v23, v23
    v_lshlrev_b32 v23, 16, v13
    v_mul_f32 v23, s27, v23
    v_cvt_pk_bf16_f32 v14, v20, v21
    v_cvt_pk_bf16_f32 v15, v22, v23
    buffer_store_dwordx2 v[14:15], v11, s[12:15], s26 offen
    v_add_u32 v10, 16, v9
    v_lshrrev_b32 v11, 4, v10
    v_and_b32 v11, 31, v11
    v_lshlrev_b32 v11, 11, v11
    v_add_u32 v11, v11, v4
    v_lshlrev_b32 v11, 4, v11
    v_and_b32 v12, 15, v10
    v_add_u32 v11, v11, v12
    v_lshlrev_b32 v11, 1, v11
    v_cvt_pk_bf16_f32 v13, v24, v24
    v_lshlrev_b32 v24, 16, v13
    v_mul_f32 v24, s27, v24
    v_cvt_pk_bf16_f32 v13, v25, v25
    v_lshlrev_b32 v25, 16, v13
    v_mul_f32 v25, s27, v25
    v_cvt_pk_bf16_f32 v13, v26, v26
    v_lshlrev_b32 v26, 16, v13
    v_mul_f32 v26, s27, v26
    v_cvt_pk_bf16_f32 v13, v27, v27
    v_lshlrev_b32 v27, 16, v13
    v_mul_f32 v27, s27, v27
    v_cvt_pk_bf16_f32 v14, v24, v25
    v_cvt_pk_bf16_f32 v15, v26, v27
    buffer_store_dwordx2 v[14:15], v11, s[12:15], s26 offen
    v_add_u32 v10, 24, v9
    v_lshrrev_b32 v11, 4, v10
    v_and_b32 v11, 31, v11
    v_lshlrev_b32 v11, 11, v11
    v_add_u32 v11, v11, v4
    v_lshlrev_b32 v11, 4, v11
    v_and_b32 v12, 15, v10
    v_add_u32 v11, v11, v12
    v_lshlrev_b32 v11, 1, v11
    v_cvt_pk_bf16_f32 v13, v28, v28
    v_lshlrev_b32 v28, 16, v13
    v_mul_f32 v28, s27, v28
    v_cvt_pk_bf16_f32 v13, v29, v29
    v_lshlrev_b32 v29, 16, v13
    v_mul_f32 v29, s27, v29
    v_cvt_pk_bf16_f32 v13, v30, v30
    v_lshlrev_b32 v30, 16, v13
    v_mul_f32 v30, s27, v30
    v_cvt_pk_bf16_f32 v13, v31, v31
    v_lshlrev_b32 v31, 16, v13
    v_mul_f32 v31, s27, v31
    v_cvt_pk_bf16_f32 v14, v28, v29
    v_cvt_pk_bf16_f32 v15, v30, v31
    buffer_store_dwordx2 v[14:15], v11, s[12:15], s26 offen
    s_branch L_qkv_kernel_skip11
L_qkv_kernel_v11:
    s_mov_b32 s26, 4194304
    v_add_u32 v10, 0, v9
    v_lshrrev_b32 v11, 4, v10
    v_and_b32 v11, 31, v11
    v_lshlrev_b32 v11, 7, v11
    v_lshrrev_b32 v12, 4, v4
    v_add_u32 v11, v11, v12
    v_lshlrev_b32 v11, 10, v11
    v_and_b32 v10, 15, v10
    v_lshlrev_b32 v10, 4, v10
    v_add_u32 v11, v11, v10
    v_lshrrev_b32 v12, 2, v4
    v_and_b32 v12, 1, v12
    v_lshlrev_b32 v12, 9, v12
    v_add_u32 v11, v11, v12
    v_and_b32 v12, 3, v4
    v_lshlrev_b32 v12, 1, v12
    v_add_u32 v11, v11, v12
    v_lshrrev_b32 v12, 3, v4
    v_and_b32 v12, 1, v12
    v_lshlrev_b32 v12, 3, v12
    v_add_u32 v10, v11, v12
    v_cvt_pk_bf16_f32 v14, v16, v16
    buffer_store_short v14, v10, s[12:15], s26 offen
    v_add_u32 v10, 1, v9
    v_lshrrev_b32 v11, 4, v10
    v_and_b32 v11, 31, v11
    v_lshlrev_b32 v11, 7, v11
    v_lshrrev_b32 v12, 4, v4
    v_add_u32 v11, v11, v12
    v_lshlrev_b32 v11, 10, v11
    v_and_b32 v10, 15, v10
    v_lshlrev_b32 v10, 4, v10
    v_add_u32 v11, v11, v10
    v_lshrrev_b32 v12, 2, v4
    v_and_b32 v12, 1, v12
    v_lshlrev_b32 v12, 9, v12
    v_add_u32 v11, v11, v12
    v_and_b32 v12, 3, v4
    v_lshlrev_b32 v12, 1, v12
    v_add_u32 v11, v11, v12
    v_lshrrev_b32 v12, 3, v4
    v_and_b32 v12, 1, v12
    v_lshlrev_b32 v12, 3, v12
    v_add_u32 v10, v11, v12
    v_cvt_pk_bf16_f32 v14, v17, v17
    buffer_store_short v14, v10, s[12:15], s26 offen
    v_add_u32 v10, 2, v9
    v_lshrrev_b32 v11, 4, v10
    v_and_b32 v11, 31, v11
    v_lshlrev_b32 v11, 7, v11
    v_lshrrev_b32 v12, 4, v4
    v_add_u32 v11, v11, v12
    v_lshlrev_b32 v11, 10, v11
    v_and_b32 v10, 15, v10
    v_lshlrev_b32 v10, 4, v10
    v_add_u32 v11, v11, v10
    v_lshrrev_b32 v12, 2, v4
    v_and_b32 v12, 1, v12
    v_lshlrev_b32 v12, 9, v12
    v_add_u32 v11, v11, v12
    v_and_b32 v12, 3, v4
    v_lshlrev_b32 v12, 1, v12
    v_add_u32 v11, v11, v12
    v_lshrrev_b32 v12, 3, v4
    v_and_b32 v12, 1, v12
    v_lshlrev_b32 v12, 3, v12
    v_add_u32 v10, v11, v12
    v_cvt_pk_bf16_f32 v14, v18, v18
    buffer_store_short v14, v10, s[12:15], s26 offen
    v_add_u32 v10, 3, v9
    v_lshrrev_b32 v11, 4, v10
    v_and_b32 v11, 31, v11
    v_lshlrev_b32 v11, 7, v11
    v_lshrrev_b32 v12, 4, v4
    v_add_u32 v11, v11, v12
    v_lshlrev_b32 v11, 10, v11
    v_and_b32 v10, 15, v10
    v_lshlrev_b32 v10, 4, v10
    v_add_u32 v11, v11, v10
    v_lshrrev_b32 v12, 2, v4
    v_and_b32 v12, 1, v12
    v_lshlrev_b32 v12, 9, v12
    v_add_u32 v11, v11, v12
    v_and_b32 v12, 3, v4
    v_lshlrev_b32 v12, 1, v12
    v_add_u32 v11, v11, v12
    v_lshrrev_b32 v12, 3, v4
    v_and_b32 v12, 1, v12
    v_lshlrev_b32 v12, 3, v12
    v_add_u32 v10, v11, v12
    v_cvt_pk_bf16_f32 v14, v19, v19
    buffer_store_short v14, v10, s[12:15], s26 offen
    v_add_u32 v10, 8, v9
    v_lshrrev_b32 v11, 4, v10
    v_and_b32 v11, 31, v11
    v_lshlrev_b32 v11, 7, v11
    v_lshrrev_b32 v12, 4, v4
    v_add_u32 v11, v11, v12
    v_lshlrev_b32 v11, 10, v11
    v_and_b32 v10, 15, v10
    v_lshlrev_b32 v10, 4, v10
    v_add_u32 v11, v11, v10
    v_lshrrev_b32 v12, 2, v4
    v_and_b32 v12, 1, v12
    v_lshlrev_b32 v12, 9, v12
    v_add_u32 v11, v11, v12
    v_and_b32 v12, 3, v4
    v_lshlrev_b32 v12, 1, v12
    v_add_u32 v11, v11, v12
    v_lshrrev_b32 v12, 3, v4
    v_and_b32 v12, 1, v12
    v_lshlrev_b32 v12, 3, v12
    v_add_u32 v10, v11, v12
    v_cvt_pk_bf16_f32 v14, v20, v20
    buffer_store_short v14, v10, s[12:15], s26 offen
    v_add_u32 v10, 9, v9
    v_lshrrev_b32 v11, 4, v10
    v_and_b32 v11, 31, v11
    v_lshlrev_b32 v11, 7, v11
    v_lshrrev_b32 v12, 4, v4
    v_add_u32 v11, v11, v12
    v_lshlrev_b32 v11, 10, v11
    v_and_b32 v10, 15, v10
    v_lshlrev_b32 v10, 4, v10
    v_add_u32 v11, v11, v10
    v_lshrrev_b32 v12, 2, v4
    v_and_b32 v12, 1, v12
    v_lshlrev_b32 v12, 9, v12
    v_add_u32 v11, v11, v12
    v_and_b32 v12, 3, v4
    v_lshlrev_b32 v12, 1, v12
    v_add_u32 v11, v11, v12
    v_lshrrev_b32 v12, 3, v4
    v_and_b32 v12, 1, v12
    v_lshlrev_b32 v12, 3, v12
    v_add_u32 v10, v11, v12
    v_cvt_pk_bf16_f32 v14, v21, v21
    buffer_store_short v14, v10, s[12:15], s26 offen
    v_add_u32 v10, 10, v9
    v_lshrrev_b32 v11, 4, v10
    v_and_b32 v11, 31, v11
    v_lshlrev_b32 v11, 7, v11
    v_lshrrev_b32 v12, 4, v4
    v_add_u32 v11, v11, v12
    v_lshlrev_b32 v11, 10, v11
    v_and_b32 v10, 15, v10
    v_lshlrev_b32 v10, 4, v10
    v_add_u32 v11, v11, v10
    v_lshrrev_b32 v12, 2, v4
    v_and_b32 v12, 1, v12
    v_lshlrev_b32 v12, 9, v12
    v_add_u32 v11, v11, v12
    v_and_b32 v12, 3, v4
    v_lshlrev_b32 v12, 1, v12
    v_add_u32 v11, v11, v12
    v_lshrrev_b32 v12, 3, v4
    v_and_b32 v12, 1, v12
    v_lshlrev_b32 v12, 3, v12
    v_add_u32 v10, v11, v12
    v_cvt_pk_bf16_f32 v14, v22, v22
    buffer_store_short v14, v10, s[12:15], s26 offen
    v_add_u32 v10, 11, v9
    v_lshrrev_b32 v11, 4, v10
    v_and_b32 v11, 31, v11
    v_lshlrev_b32 v11, 7, v11
    v_lshrrev_b32 v12, 4, v4
    v_add_u32 v11, v11, v12
    v_lshlrev_b32 v11, 10, v11
    v_and_b32 v10, 15, v10
    v_lshlrev_b32 v10, 4, v10
    v_add_u32 v11, v11, v10
    v_lshrrev_b32 v12, 2, v4
    v_and_b32 v12, 1, v12
    v_lshlrev_b32 v12, 9, v12
    v_add_u32 v11, v11, v12
    v_and_b32 v12, 3, v4
    v_lshlrev_b32 v12, 1, v12
    v_add_u32 v11, v11, v12
    v_lshrrev_b32 v12, 3, v4
    v_and_b32 v12, 1, v12
    v_lshlrev_b32 v12, 3, v12
    v_add_u32 v10, v11, v12
    v_cvt_pk_bf16_f32 v14, v23, v23
    buffer_store_short v14, v10, s[12:15], s26 offen
    v_add_u32 v10, 16, v9
    v_lshrrev_b32 v11, 4, v10
    v_and_b32 v11, 31, v11
    v_lshlrev_b32 v11, 7, v11
    v_lshrrev_b32 v12, 4, v4
    v_add_u32 v11, v11, v12
    v_lshlrev_b32 v11, 10, v11
    v_and_b32 v10, 15, v10
    v_lshlrev_b32 v10, 4, v10
    v_add_u32 v11, v11, v10
    v_lshrrev_b32 v12, 2, v4
    v_and_b32 v12, 1, v12
    v_lshlrev_b32 v12, 9, v12
    v_add_u32 v11, v11, v12
    v_and_b32 v12, 3, v4
    v_lshlrev_b32 v12, 1, v12
    v_add_u32 v11, v11, v12
    v_lshrrev_b32 v12, 3, v4
    v_and_b32 v12, 1, v12
    v_lshlrev_b32 v12, 3, v12
    v_add_u32 v10, v11, v12
    v_cvt_pk_bf16_f32 v14, v24, v24
    buffer_store_short v14, v10, s[12:15], s26 offen
    v_add_u32 v10, 17, v9
    v_lshrrev_b32 v11, 4, v10
    v_and_b32 v11, 31, v11
    v_lshlrev_b32 v11, 7, v11
    v_lshrrev_b32 v12, 4, v4
    v_add_u32 v11, v11, v12
    v_lshlrev_b32 v11, 10, v11
    v_and_b32 v10, 15, v10
    v_lshlrev_b32 v10, 4, v10
    v_add_u32 v11, v11, v10
    v_lshrrev_b32 v12, 2, v4
    v_and_b32 v12, 1, v12
    v_lshlrev_b32 v12, 9, v12
    v_add_u32 v11, v11, v12
    v_and_b32 v12, 3, v4
    v_lshlrev_b32 v12, 1, v12
    v_add_u32 v11, v11, v12
    v_lshrrev_b32 v12, 3, v4
    v_and_b32 v12, 1, v12
    v_lshlrev_b32 v12, 3, v12
    v_add_u32 v10, v11, v12
    v_cvt_pk_bf16_f32 v14, v25, v25
    buffer_store_short v14, v10, s[12:15], s26 offen
    v_add_u32 v10, 18, v9
    v_lshrrev_b32 v11, 4, v10
    v_and_b32 v11, 31, v11
    v_lshlrev_b32 v11, 7, v11
    v_lshrrev_b32 v12, 4, v4
    v_add_u32 v11, v11, v12
    v_lshlrev_b32 v11, 10, v11
    v_and_b32 v10, 15, v10
    v_lshlrev_b32 v10, 4, v10
    v_add_u32 v11, v11, v10
    v_lshrrev_b32 v12, 2, v4
    v_and_b32 v12, 1, v12
    v_lshlrev_b32 v12, 9, v12
    v_add_u32 v11, v11, v12
    v_and_b32 v12, 3, v4
    v_lshlrev_b32 v12, 1, v12
    v_add_u32 v11, v11, v12
    v_lshrrev_b32 v12, 3, v4
    v_and_b32 v12, 1, v12
    v_lshlrev_b32 v12, 3, v12
    v_add_u32 v10, v11, v12
    v_cvt_pk_bf16_f32 v14, v26, v26
    buffer_store_short v14, v10, s[12:15], s26 offen
    v_add_u32 v10, 19, v9
    v_lshrrev_b32 v11, 4, v10
    v_and_b32 v11, 31, v11
    v_lshlrev_b32 v11, 7, v11
    v_lshrrev_b32 v12, 4, v4
    v_add_u32 v11, v11, v12
    v_lshlrev_b32 v11, 10, v11
    v_and_b32 v10, 15, v10
    v_lshlrev_b32 v10, 4, v10
    v_add_u32 v11, v11, v10
    v_lshrrev_b32 v12, 2, v4
    v_and_b32 v12, 1, v12
    v_lshlrev_b32 v12, 9, v12
    v_add_u32 v11, v11, v12
    v_and_b32 v12, 3, v4
    v_lshlrev_b32 v12, 1, v12
    v_add_u32 v11, v11, v12
    v_lshrrev_b32 v12, 3, v4
    v_and_b32 v12, 1, v12
    v_lshlrev_b32 v12, 3, v12
    v_add_u32 v10, v11, v12
    v_cvt_pk_bf16_f32 v14, v27, v27
    buffer_store_short v14, v10, s[12:15], s26 offen
    v_add_u32 v10, 24, v9
    v_lshrrev_b32 v11, 4, v10
    v_and_b32 v11, 31, v11
    v_lshlrev_b32 v11, 7, v11
    v_lshrrev_b32 v12, 4, v4
    v_add_u32 v11, v11, v12
    v_lshlrev_b32 v11, 10, v11
    v_and_b32 v10, 15, v10
    v_lshlrev_b32 v10, 4, v10
    v_add_u32 v11, v11, v10
    v_lshrrev_b32 v12, 2, v4
    v_and_b32 v12, 1, v12
    v_lshlrev_b32 v12, 9, v12
    v_add_u32 v11, v11, v12
    v_and_b32 v12, 3, v4
    v_lshlrev_b32 v12, 1, v12
    v_add_u32 v11, v11, v12
    v_lshrrev_b32 v12, 3, v4
    v_and_b32 v12, 1, v12
    v_lshlrev_b32 v12, 3, v12
    v_add_u32 v10, v11, v12
    v_cvt_pk_bf16_f32 v14, v28, v28
    buffer_store_short v14, v10, s[12:15], s26 offen
    v_add_u32 v10, 25, v9
    v_lshrrev_b32 v11, 4, v10
    v_and_b32 v11, 31, v11
    v_lshlrev_b32 v11, 7, v11
    v_lshrrev_b32 v12, 4, v4
    v_add_u32 v11, v11, v12
    v_lshlrev_b32 v11, 10, v11
    v_and_b32 v10, 15, v10
    v_lshlrev_b32 v10, 4, v10
    v_add_u32 v11, v11, v10
    v_lshrrev_b32 v12, 2, v4
    v_and_b32 v12, 1, v12
    v_lshlrev_b32 v12, 9, v12
    v_add_u32 v11, v11, v12
    v_and_b32 v12, 3, v4
    v_lshlrev_b32 v12, 1, v12
    v_add_u32 v11, v11, v12
    v_lshrrev_b32 v12, 3, v4
    v_and_b32 v12, 1, v12
    v_lshlrev_b32 v12, 3, v12
    v_add_u32 v10, v11, v12
    v_cvt_pk_bf16_f32 v14, v29, v29
    buffer_store_short v14, v10, s[12:15], s26 offen
    v_add_u32 v10, 26, v9
    v_lshrrev_b32 v11, 4, v10
    v_and_b32 v11, 31, v11
    v_lshlrev_b32 v11, 7, v11
    v_lshrrev_b32 v12, 4, v4
    v_add_u32 v11, v11, v12
    v_lshlrev_b32 v11, 10, v11
    v_and_b32 v10, 15, v10
    v_lshlrev_b32 v10, 4, v10
    v_add_u32 v11, v11, v10
    v_lshrrev_b32 v12, 2, v4
    v_and_b32 v12, 1, v12
    v_lshlrev_b32 v12, 9, v12
    v_add_u32 v11, v11, v12
    v_and_b32 v12, 3, v4
    v_lshlrev_b32 v12, 1, v12
    v_add_u32 v11, v11, v12
    v_lshrrev_b32 v12, 3, v4
    v_and_b32 v12, 1, v12
    v_lshlrev_b32 v12, 3, v12
    v_add_u32 v10, v11, v12
    v_cvt_pk_bf16_f32 v14, v30, v30
    buffer_store_short v14, v10, s[12:15], s26 offen
    v_add_u32 v10, 27, v9
    v_lshrrev_b32 v11, 4, v10
    v_and_b32 v11, 31, v11
    v_lshlrev_b32 v11, 7, v11
    v_lshrrev_b32 v12, 4, v4
    v_add_u32 v11, v11, v12
    v_lshlrev_b32 v11, 10, v11
    v_and_b32 v10, 15, v10
    v_lshlrev_b32 v10, 4, v10
    v_add_u32 v11, v11, v10
    v_lshrrev_b32 v12, 2, v4
    v_and_b32 v12, 1, v12
    v_lshlrev_b32 v12, 9, v12
    v_add_u32 v11, v11, v12
    v_and_b32 v12, 3, v4
    v_lshlrev_b32 v12, 1, v12
    v_add_u32 v11, v11, v12
    v_lshrrev_b32 v12, 3, v4
    v_and_b32 v12, 1, v12
    v_lshlrev_b32 v12, 3, v12
    v_add_u32 v10, v11, v12
    v_cvt_pk_bf16_f32 v14, v31, v31
    buffer_store_short v14, v10, s[12:15], s26 offen
L_qkv_kernel_skip11:
L_end_qkv_kernel:
    s_endpgm
.globl attn_kernel
.p2align 8
.type attn_kernel,@function
attn_kernel:
    s_load_dwordx16 s[64:79], s[0:1], 0
    s_load_dwordx4 s[80:83], s[0:1], 64
    s_load_dwordx2 s[84:85], s[0:1], 80
    v_lshrrev_b32 v1, 6, v0
    s_nop 1
    v_readfirstlane_b32 s20, v1
    s_lshl_b32 s3, s2, 2
    s_add_u32 s20, s20, s3
    s_cmp_ge_u32 s20, 2048
    s_cbranch_scc1 L_end_attn_kernel
    v_and_b32 v0, 63, v0
    s_lshr_b32 s21, s20, 6
    s_and_b32 s22, s20, 63
    s_waitcnt lgkmcnt(0)
    s_add_u32 s4, s84, 0x800000
    s_addc_u32 s5, s85, 0
    s_mov_b32 s6, 0x800000
    s_mov_b32 s7, 0x00020000
    s_waitcnt lgkmcnt(0)
    s_add_u32 s8, s84, 0x2000000
    s_addc_u32 s9, s85, 0
    s_mov_b32 s10, 0x200000
    s_mov_b32 s11, 0x00020000
    v_and_b32 v2, 31, v0
    v_lshrrev_b32 v3, 5, v0
    s_lshl_b32 s23, s21, 16
    s_lshl_b32 s24, s22, 5
    v_add_u32 v4, s24, v2
    v_lshlrev_b32 v5, 5, v4
    v_lshlrev_b32 v6, 4, v3
    v_add_u32 v5, v5, v6
    buffer_load_dwordx4 v[8:11], v5, s[4:7], s23 offen
    v_lshlrev_b32 v7, 5, v2
    v_add_u32 v7, v7, v6
    s_add_u32 s25, s23, 2097152
    v_lshlrev_b32 v12, 12, v2
    v_lshlrev_b32 v13, 3, v3
    v_add_u32 v12, v12, v13
    s_add_u32 s26, s23, 4194304
    v_mov_b32 v14, 0xff800000
    s_waitcnt vmcnt(0)
    s_mov_b32 s27, 0
    s_add_u32 s28, s27, 0
    s_lshl_b32 s28, s28, 10
    s_add_u32 s28, s28, s25
    buffer_load_dwordx4 v[16:19], v7, s[4:7], s28 offen
    s_add_u32 s28, s27, 1
    s_lshl_b32 s28, s28, 10
    s_add_u32 s28, s28, s25
    buffer_load_dwordx4 v[20:23], v7, s[4:7], s28 offen
L_attn_p1:
    s_add_u32 s27, s27, 2
    s_add_u32 s28, s27, 0
    s_lshl_b32 s28, s28, 10
    s_add_u32 s28, s28, s25
    buffer_load_dwordx4 v[24:27], v7, s[4:7], s28 offen
    s_add_u32 s28, s27, 1
    s_lshl_b32 s28, s28, 10
    s_add_u32 s28, s28, s25
    buffer_load_dwordx4 v[28:31], v7, s[4:7], s28 offen
    s_waitcnt vmcnt(2)
    v_mfma_f32_32x32x16_bf16 v[32:47], v[16:19], v[8:11], 0
    v_mfma_f32_32x32x16_bf16 v[96:111], v[20:23], v[8:11], 0
    s_nop 7
    s_nop 3
    v_max3_f32 v14, v14, v32, v33
    v_max3_f32 v14, v14, v34, v35
    v_max3_f32 v14, v14, v36, v37
    v_max3_f32 v14, v14, v38, v39
    v_max3_f32 v14, v14, v40, v41
    v_max3_f32 v14, v14, v42, v43
    v_max3_f32 v14, v14, v44, v45
    v_max3_f32 v14, v14, v46, v47
    s_nop 3
    v_max3_f32 v14, v14, v96, v97
    v_max3_f32 v14, v14, v98, v99
    v_max3_f32 v14, v14, v100, v101
    v_max3_f32 v14, v14, v102, v103
    v_max3_f32 v14, v14, v104, v105
    v_max3_f32 v14, v14, v106, v107
    v_max3_f32 v14, v14, v108, v109
    v_max3_f32 v14, v14, v110, v111
    s_add_u32 s27, s27, 2
    s_add_u32 s28, s27, 0
    s_lshl_b32 s28, s28, 10
    s_add_u32 s28, s28, s25
    buffer_load_dwordx4 v[16:19], v7, s[4:7], s28 offen
    s_add_u32 s28, s27, 1
    s_lshl_b32 s28, s28, 10
    s_add_u32 s28, s28, s25
    buffer_load_dwordx4 v[20:23], v7, s[4:7], s28 offen
    s_waitcnt vmcnt(2)
    v_mfma_f32_32x32x16_bf16 v[32:47], v[24:27], v[8:11], 0
    v_mfma_f32_32x32x16_bf16 v[96:111], v[28:31], v[8:11], 0
    s_nop 7
    s_nop 3
    v_max3_f32 v14, v14, v32, v33
    v_max3_f32 v14, v14, v34, v35
    v_max3_f32 v14, v14, v36, v37
    v_max3_f32 v14, v14, v38, v39
    v_max3_f32 v14, v14, v40, v41
    v_max3_f32 v14, v14, v42, v43
    v_max3_f32 v14, v14, v44, v45
    v_max3_f32 v14, v14, v46, v47
    s_nop 3
    v_max3_f32 v14, v14, v96, v97
    v_max3_f32 v14, v14, v98, v99
    v_max3_f32 v14, v14, v100, v101
    v_max3_f32 v14, v14, v102, v103
    v_max3_f32 v14, v14, v104, v105
    v_max3_f32 v14, v14, v106, v107
    v_max3_f32 v14, v14, v108, v109
    v_max3_f32 v14, v14, v110, v111
    s_cmp_lt_u32 s27, 64
    s_cbranch_scc1 L_attn_p1
    s_waitcnt vmcnt(0)
    v_xor_b32 v15, 32, v0
    v_lshlrev_b32 v15, 2, v15
    ds_bpermute_b32 v20, v15, v14
    s_waitcnt lgkmcnt(0)
    v_max_f32 v14, v14, v20
    v_sub_f32 v48, 0, v14
    v_sub_f32 v49, 0, v14
    v_sub_f32 v50, 0, v14
    v_sub_f32 v51, 0, v14
    v_sub_f32 v52, 0, v14
    v_sub_f32 v53, 0, v14
    v_sub_f32 v54, 0, v14
    v_sub_f32 v55, 0, v14
    v_sub_f32 v56, 0, v14
    v_sub_f32 v57, 0, v14
    v_sub_f32 v58, 0, v14
    v_sub_f32 v59, 0, v14
    v_sub_f32 v60, 0, v14
    v_sub_f32 v61, 0, v14
    v_sub_f32 v62, 0, v14
    v_sub_f32 v63, 0, v14
    v_mov_b32 v64, 0
    v_mov_b32 v65, 0
    v_mov_b32 v66, 0
    v_mov_b32 v67, 0
    v_mov_b32 v68, 0
    v_mov_b32 v69, 0
    v_mov_b32 v70, 0
    v_mov_b32 v71, 0
    v_mov_b32 v72, 0
    v_mov_b32 v73, 0
    v_mov_b32 v74, 0
    v_mov_b32 v75, 0
    v_mov_b32 v76, 0
    v_mov_b32 v77, 0
    v_mov_b32 v78, 0
    v_mov_b32 v79, 0
    v_cmp_eq_u32 vcc, 16, v2
    v_mov_b32 v20, 0
    v_mov_b32 v21, 0x3f803f80
    v_cndmask_b32 v20, v20, v21, vcc
    v_mov_b32 v128, v20
    v_mov_b32 v129, v20
    v_mov_b32 v130, v20
    v_mov_b32 v131, v20
    v_mov_b32 v132, v20
    v_mov_b32 v133, v20
    v_mov_b32 v134, v20
    v_mov_b32 v135, v20
    v_mov_b32 v136, v20
    v_mov_b32 v137, v20
    v_mov_b32 v138, v20
    v_mov_b32 v139, v20
    v_mov_b32 v140, v20
    v_mov_b32 v141, v20
    v_mov_b32 v142, v20
    v_mov_b32 v143, v20
    v_mov_b32 v160, v20
    v_mov_b32 v161, v20
    v_mov_b32 v162, v20
    v_mov_b32 v163, v20
    v_mov_b32 v164, v20
    v_mov_b32 v165, v20
    v_mov_b32 v166, v20
    v_mov_b32 v167, v20
    v_mov_b32 v168, v20
    v_mov_b32 v169, v20
    v_mov_b32 v170, v20
    v_mov_b32 v171, v20
    v_mov_b32 v172, v20
    v_mov_b32 v173, v20
    v_mov_b32 v174, v20
    v_mov_b32 v175, v20
    v_cmp_gt_u32 s[30:31], 16, v2
    v_lshlrev_b32 v12, 4, v0
    s_lshl_b32 s26, s21, 17
    s_add_u32 s26, s26, 4194304
    s_mov_b32 s27, 0
    s_add_u32 s28, s27, 0
    s_lshl_b32 s28, s28, 10
    s_add_u32 s28, s28, s25
    buffer_load_dwordx4 v[16:19], v7, s[4:7], s28 offen
    s_add_u32 s28, s27, 1
    s_lshl_b32 s28, s28, 10
    s_add_u32 s28, s28, s25
    buffer_load_dwordx4 v[20:23], v7, s[4:7], s28 offen
    s_lshl_b32 s29, s27, 11
    s_add_u32 s29, s29, s26
    s_mov_b64 s[32:33], exec
    s_mov_b64 exec, s[30:31]
    buffer_load_dwordx4 v[128:131], v12, s[4:7], s29 offen offset:0
    buffer_load_dwordx4 v[132:135], v12, s[4:7], s29 offen offset:1024
    buffer_load_dwordx4 v[136:139], v12, s[4:7], s29 offen offset:2048
    buffer_load_dwordx4 v[140:143], v12, s[4:7], s29 offen offset:3072
    s_mov_b64 exec, s[32:33]
L_attn_p2:
    s_add_u32 s27, s27, 2
    s_add_u32 s28, s27, 0
    s_lshl_b32 s28, s28, 10
    s_add_u32 s28, s28, s25
    buffer_load_dwordx4 v[24:27], v7, s[4:7], s28 offen
    s_add_u32 s28, s27, 1
    s_lshl_b32 s28, s28, 10
    s_add_u32 s28, s28, s25
    buffer_load_dwordx4 v[28:31], v7, s[4:7], s28 offen
    s_lshl_b32 s29, s27, 11
    s_add_u32 s29, s29, s26
    s_mov_b64 s[32:33], exec
    s_mov_b64 exec, s[30:31]
    buffer_load_dwordx4 v[160:163], v12, s[4:7], s29 offen offset:0
    buffer_load_dwordx4 v[164:167], v12, s[4:7], s29 offen offset:1024
    buffer_load_dwordx4 v[168:171], v12, s[4:7], s29 offen offset:2048
    buffer_load_dwordx4 v[172:175], v12, s[4:7], s29 offen offset:3072
    s_mov_b64 exec, s[32:33]
    s_waitcnt vmcnt(6)
    v_mfma_f32_32x32x16_bf16 v[32:47], v[16:19], v[8:11], v[48:63]
    v_mfma_f32_32x32x16_bf16 v[96:111], v[20:23], v[8:11], v[48:63]
    s_nop 7
    s_nop 3
    v_exp_f32 v32, v32
    v_exp_f32 v33, v33
    v_exp_f32 v34, v34
    v_exp_f32 v35, v35
    v_exp_f32 v36, v36
    v_exp_f32 v37, v37
    v_exp_f32 v38, v38
    v_exp_f32 v39, v39
    v_exp_f32 v40, v40
    v_exp_f32 v41, v41
    v_exp_f32 v42, v42
    v_exp_f32 v43, v43
    v_exp_f32 v44, v44
    v_exp_f32 v45, v45
    v_exp_f32 v46, v46
    v_exp_f32 v47, v47
    s_nop 0
    v_cvt_pk_bf16_f32 v112, v32, v33
    v_cvt_pk_bf16_f32 v113, v34, v35
    v_cvt_pk_bf16_f32 v114, v36, v37
    v_cvt_pk_bf16_f32 v115, v38, v39
    v_cvt_pk_bf16_f32 v116, v40, v41
    v_cvt_pk_bf16_f32 v117, v42, v43
    v_cvt_pk_bf16_f32 v118, v44, v45
    v_cvt_pk_bf16_f32 v119, v46, v47
    s_nop 1
    v_mfma_f32_32x32x16_bf16 v[64:79], v[128:131], v[112:115], v[64:79]
    v_mfma_f32_32x32x16_bf16 v[64:79], v[132:135], v[116:119], v[64:79]
    v_exp_f32 v96, v96
    v_exp_f32 v97, v97
    v_exp_f32 v98, v98
    v_exp_f32 v99, v99
    v_exp_f32 v100, v100
    v_exp_f32 v101, v101
    v_exp_f32 v102, v102
    v_exp_f32 v103, v103
    v_exp_f32 v104, v104
    v_exp_f32 v105, v105
    v_exp_f32 v106, v106
    v_exp_f32 v107, v107
    v_exp_f32 v108, v108
    v_exp_f32 v109, v109
    v_exp_f32 v110, v110
    v_exp_f32 v111, v111
    s_nop 0
    v_cvt_pk_bf16_f32 v120, v96, v97
    v_cvt_pk_bf16_f32 v121, v98, v99
    v_cvt_pk_bf16_f32 v122, v100, v101
    v_cvt_pk_bf16_f32 v123, v102, v103
    v_cvt_pk_bf16_f32 v124, v104, v105
    v_cvt_pk_bf16_f32 v125, v106, v107
    v_cvt_pk_bf16_f32 v126, v108, v109
    v_cvt_pk_bf16_f32 v127, v110, v111
    s_nop 1
    v_mfma_f32_32x32x16_bf16 v[64:79], v[136:139], v[120:123], v[64:79]
    v_mfma_f32_32x32x16_bf16 v[64:79], v[140:143], v[124:127], v[64:79]
    s_add_u32 s27, s27, 2
    s_add_u32 s28, s27, 0
    s_lshl_b32 s28, s28, 10
    s_add_u32 s28, s28, s25
    buffer_load_dwordx4 v[16:19], v7, s[4:7], s28 offen
    s_add_u32 s28, s27, 1
    s_lshl_b32 s28, s28, 10
    s_add_u32 s28, s28, s25
    buffer_load_dwordx4 v[20:23], v7, s[4:7], s28 offen
    s_lshl_b32 s29, s27, 11
    s_add_u32 s29, s29, s26
    s_mov_b64 s[32:33], exec
    s_mov_b64 exec, s[30:31]
    buffer_load_dwordx4 v[128:131], v12, s[4:7], s29 offen offset:0
    buffer_load_dwordx4 v[132:135], v12, s[4:7], s29 offen offset:1024
    buffer_load_dwordx4 v[136:139], v12, s[4:7], s29 offen offset:2048
    buffer_load_dwordx4 v[140:143], v12, s[4:7], s29 offen offset:3072
    s_mov_b64 exec, s[32:33]
    s_waitcnt vmcnt(6)
    v_mfma_f32_32x32x16_bf16 v[32:47], v[24:27], v[8:11], v[48:63]
    v_mfma_f32_32x32x16_bf16 v[96:111], v[28:31], v[8:11], v[48:63]
    s_nop 7
    s_nop 3
    v_exp_f32 v32, v32
    v_exp_f32 v33, v33
    v_exp_f32 v34, v34
    v_exp_f32 v35, v35
    v_exp_f32 v36, v36
    v_exp_f32 v37, v37
    v_exp_f32 v38, v38
    v_exp_f32 v39, v39
    v_exp_f32 v40, v40
    v_exp_f32 v41, v41
    v_exp_f32 v42, v42
    v_exp_f32 v43, v43
    v_exp_f32 v44, v44
    v_exp_f32 v45, v45
    v_exp_f32 v46, v46
    v_exp_f32 v47, v47
    s_nop 0
    v_cvt_pk_bf16_f32 v112, v32, v33
    v_cvt_pk_bf16_f32 v113, v34, v35
    v_cvt_pk_bf16_f32 v114, v36, v37
    v_cvt_pk_bf16_f32 v115, v38, v39
    v_cvt_pk_bf16_f32 v116, v40, v41
    v_cvt_pk_bf16_f32 v117, v42, v43
    v_cvt_pk_bf16_f32 v118, v44, v45
    v_cvt_pk_bf16_f32 v119, v46, v47
    s_nop 1
    v_mfma_f32_32x32x16_bf16 v[64:79], v[160:163], v[112:115], v[64:79]
    v_mfma_f32_32x32x16_bf16 v[64:79], v[164:167], v[116:119], v[64:79]
    v_exp_f32 v96, v96
    v_exp_f32 v97, v97
    v_exp_f32 v98, v98
    v_exp_f32 v99, v99
    v_exp_f32 v100, v100
    v_exp_f32 v101, v101
    v_exp_f32 v102, v102
    v_exp_f32 v103, v103
    v_exp_f32 v104, v104
    v_exp_f32 v105, v105
    v_exp_f32 v106, v106
    v_exp_f32 v107, v107
    v_exp_f32 v108, v108
    v_exp_f32 v109, v109
    v_exp_f32 v110, v110
    v_exp_f32 v111, v111
    s_nop 0
    v_cvt_pk_bf16_f32 v120, v96, v97
    v_cvt_pk_bf16_f32 v121, v98, v99
    v_cvt_pk_bf16_f32 v122, v100, v101
    v_cvt_pk_bf16_f32 v123, v102, v103
    v_cvt_pk_bf16_f32 v124, v104, v105
    v_cvt_pk_bf16_f32 v125, v106, v107
    v_cvt_pk_bf16_f32 v126, v108, v109
    v_cvt_pk_bf16_f32 v127, v110, v111
    s_nop 1
    v_mfma_f32_32x32x16_bf16 v[64:79], v[168:171], v[120:123], v[64:79]
    v_mfma_f32_32x32x16_bf16 v[64:79], v[172:175], v[124:127], v[64:79]
    s_cmp_lt_u32 s27, 64
    s_cbranch_scc1 L_attn_p2
    s_waitcnt vmcnt(0)
    s_nop 7
    s_nop 7
    v_lshlrev_b32 v15, 2, v2
    ds_bpermute_b32 v20, v15, v72
    s_waitcnt lgkmcnt(0)
    v_rcp_f32 v20, v20
    s_nop 0
    v_mul_f32 v64, v64, v20
    v_mul_f32 v65, v65, v20
    v_mul_f32 v66, v66, v20
    v_mul_f32 v67, v67, v20
    v_mul_f32 v68, v68, v20
    v_mul_f32 v69, v69, v20
    v_mul_f32 v70, v70, v20
    v_mul_f32 v71, v71, v20
    s_lshl_b32 s28, s21, 4
    v_lshlrev_b32 v24, 2, v3
    v_add_u32 v24, s28, v24
    v_add_u32 v24, 0, v24
    v_lshrrev_b32 v25, 5, v4
    s_mov_b32 s36, 32
    v_mul_lo_u32 v25, v25, s36
    v_lshrrev_b32 v26, 4, v24
    v_add_u32 v25, v25, v26
    v_lshlrev_b32 v21, 10, v25
    v_and_b32 v25, 31, v4
    v_lshlrev_b32 v25, 4, v25
    v_add_u32 v21, v21, v25
    v_lshrrev_b32 v25, 3, v24
    v_and_b32 v25, 1, v25
    v_lshlrev_b32 v25, 9, v25
    v_add_u32 v21, v21, v25
    v_and_b32 v25, 7, v24
    v_lshlrev_b32 v25, 1, v25
    v_add_u32 v21, v21, v25
    v_cvt_pk_bf16_f32 v22, v64, v65
    v_cvt_pk_bf16_f32 v23, v66, v67
    buffer_store_dwordx2 v[22:23], v21, s[8:11], 0 offen
    v_lshlrev_b32 v24, 2, v3
    v_add_u32 v24, s28, v24
    v_add_u32 v24, 8, v24
    v_lshrrev_b32 v25, 5, v4
    s_mov_b32 s36, 32
    v_mul_lo_u32 v25, v25, s36
    v_lshrrev_b32 v26, 4, v24
    v_add_u32 v25, v25, v26
    v_lshlrev_b32 v21, 10, v25
    v_and_b32 v25, 31, v4
    v_lshlrev_b32 v25, 4, v25
    v_add_u32 v21, v21, v25
    v_lshrrev_b32 v25, 3, v24
    v_and_b32 v25, 1, v25
    v_lshlrev_b32 v25, 9, v25
    v_add_u32 v21, v21, v25
    v_and_b32 v25, 7, v24
    v_lshlrev_b32 v25, 1, v25
    v_add_u32 v21, v21, v25
    v_cvt_pk_bf16_f32 v22, v68, v69
    v_cvt_pk_bf16_f32 v23, v70, v71
    buffer_store_dwordx2 v[22:23], v21, s[8:11], 0 offen
L_end_attn_kernel:
    s_endpgm
.globl wo_kernel
.p2align 8
.type wo_kernel,@function
wo_kernel:
    s_load_dwordx16 s[64:79], s[0:1], 0
    s_load_dwordx4 s[80:83], s[0:1], 64
    s_load_dwordx2 s[84:85], s[0:1], 80
    v_lshrrev_b32 v1, 6, v0
    s_nop 1
    v_readfirstlane_b32 s20, v1
    s_lshl_b32 s3, s2, 2
    s_add_u32 s20, s20, s3
    s_cmp_ge_u32 s20, 1024
    s_cbranch_scc1 L_end_wo_kernel
    v_and_b32 v0, 63, v0
    s_and_b32 s21, s20, 63
    s_lshr_b32 s22, s20, 6
    s_waitcnt lgkmcnt(0)
    s_add_u32 s4, s84, 0x2000000
    s_addc_u32 s5, s85, 0
    s_mov_b32 s6, 0x200000
    s_mov_b32 s7, 0x00020000
    s_waitcnt lgkmcnt(0)
    s_add_u32 s8, s84, 0x180000
    s_addc_u32 s9, s85, 0
    s_mov_b32 s10, 0x80000
    s_mov_b32 s11, 0x00020000
    v_and_b32 v2, 31, v0
    v_lshrrev_b32 v3, 5, v0
    v_lshlrev_b32 v8, 4, v0
    s_mul_i32 s25, s21, 32768
    s_add_u32 s25, s25, 0
    v_add_u32 v232, s25, v8
    s_mul_i32 s25, s22, 32768
    s_add_u32 s25, s25, 0
    v_add_u32 v234, s25, v8
    v_mov_b32 v160, 0
    v_mov_b32 v161, 0
    v_mov_b32 v162, 0
    v_mov_b32 v163, 0
    v_mov_b32 v164, 0
    v_mov_b32 v165, 0
    v_mov_b32 v166, 0
    v_mov_b32 v167, 0
    v_mov_b32 v168, 0
    v_mov_b32 v169, 0
    v_mov_b32 v170, 0
    v_mov_b32 v171, 0
    v_mov_b32 v172, 0
    v_mov_b32 v173, 0
    v_mov_b32 v174, 0
    v_mov_b32 v175, 0
    s_mov_b32 s27, 0
    buffer_load_dwordx4 v[32:35], v232, s[4:7], s27 offen
    buffer_load_dwordx4 v[96:99], v234, s[8:11], s27 offen
    s_mov_b32 s27, 1024
    buffer_load_dwordx4 v[40:43], v232, s[4:7], s27 offen
    buffer_load_dwordx4 v[104:107], v234, s[8:11], s27 offen
    s_mov_b32 s27, 2048
    buffer_load_dwordx4 v[48:51], v232, s[4:7], s27 offen
    buffer_load_dwordx4 v[112:115], v234, s[8:11], s27 offen
    s_mov_b32 s27, 3072
    buffer_load_dwordx4 v[56:59], v232, s[4:7], s27 offen
    buffer_load_dwordx4 v[120:123], v234, s[8:11], s27 offen
    s_mov_b32 s27, 4096
    buffer_load_dwordx4 v[64:67], v232, s[4:7], s27 offen
    buffer_load_dwordx4 v[128:131], v234, s[8:11], s27 offen
    s_mov_b32 s27, 5120
    buffer_load_dwordx4 v[72:75], v232, s[4:7], s27 offen
    buffer_load_dwordx4 v[136:139], v234, s[8:11], s27 offen
    s_mov_b32 s27, 6144
    buffer_load_dwordx4 v[80:83], v232, s[4:7], s27 offen
    buffer_load_dwordx4 v[144:147], v234, s[8:11], s27 offen
    s_mov_b32 s27, 7168
    buffer_load_dwordx4 v[88:91], v232, s[4:7], s27 offen
    buffer_load_dwordx4 v[152:155], v234, s[8:11], s27 offen
    s_waitcnt vmcnt(14)
    v_mfma_f32_32x32x16_bf16 v[160:175], v[96:99], v[32:35], v[160:175]
    s_mov_b32 s27, 8192
    buffer_load_dwordx4 v[32:35], v232, s[4:7], s27 offen
    buffer_load_dwordx4 v[96:99], v234, s[8:11], s27 offen
    s_waitcnt vmcnt(14)
    v_mfma_f32_32x32x16_bf16 v[160:175], v[104:107], v[40:43], v[160:175]
    s_mov_b32 s27, 9216
    buffer_load_dwordx4 v[40:43], v232, s[4:7], s27 offen
    buffer_load_dwordx4 v[104:107], v234, s[8:11], s27 offen
    s_waitcnt vmcnt(14)
    v_mfma_f32_32x32x16_bf16 v[160:175], v[112:115], v[48:51], v[160:175]
    s_mov_b32 s27, 10240
    buffer_load_dwordx4 v[48:51], v232, s[4:7], s27 offen
    buffer_load_dwordx4 v[112:115], v234, s[8:11], s27 offen
    s_waitcnt vmcnt(14)
    v_mfma_f32_32x32x16_bf16 v[160:175], v[120:123], v[56:59], v[160:175]
    s_mov_b32 s27, 11264
    buffer_load_dwordx4 v[56:59], v232, s[4:7], s27 offen
    buffer_load_dwordx4 v[120:123], v234, s[8:11], s27 offen
    s_waitcnt vmcnt(14)
    v_mfma_f32_32x32x16_bf16 v[160:175], v[128:131], v[64:67], v[160:175]
    s_mov_b32 s27, 12288
    buffer_load_dwordx4 v[64:67], v232, s[4:7], s27 offen
    buffer_load_dwordx4 v[128:131], v234, s[8:11], s27 offen
    s_waitcnt vmcnt(14)
    v_mfma_f32_32x32x16_bf16 v[160:175], v[136:139], v[72:75], v[160:175]
    s_mov_b32 s27, 13312
    buffer_load_dwordx4 v[72:75], v232, s[4:7], s27 offen
    buffer_load_dwordx4 v[136:139], v234, s[8:11], s27 offen
    s_waitcnt vmcnt(14)
    v_mfma_f32_32x32x16_bf16 v[160:175], v[144:147], v[80:83], v[160:175]
    s_mov_b32 s27, 14336
    buffer_load_dwordx4 v[80:83], v232, s[4:7], s27 offen
    buffer_load_dwordx4 v[144:147], v234, s[8:11], s27 offen
    s_waitcnt vmcnt(14)
    v_mfma_f32_32x32x16_bf16 v[160:175], v[152:155], v[88:91], v[160:175]
    s_mov_b32 s27, 15360
    buffer_load_dwordx4 v[88:91], v232, s[4:7], s27 offen
    buffer_load_dwordx4 v[152:155], v234, s[8:11], s27 offen
    s_waitcnt vmcnt(14)
    v_mfma_f32_32x32x16_bf16 v[160:175], v[96:99], v[32:35], v[160:175]
    s_mov_b32 s27, 16384
    buffer_load_dwordx4 v[32:35], v232, s[4:7], s27 offen
    buffer_load_dwordx4 v[96:99], v234, s[8:11], s27 offen
    s_waitcnt vmcnt(14)
    v_mfma_f32_32x32x16_bf16 v[160:175], v[104:107], v[40:43], v[160:175]
    s_mov_b32 s27, 17408
    buffer_load_dwordx4 v[40:43], v232, s[4:7], s27 offen
    buffer_load_dwordx4 v[104:107], v234, s[8:11], s27 offen
    s_waitcnt vmcnt(14)
    v_mfma_f32_32x32x16_bf16 v[160:175], v[112:115], v[48:51], v[160:175]
    s_mov_b32 s27, 18432
    buffer_load_dwordx4 v[48:51], v232, s[4:7], s27 offen
    buffer_load_dwordx4 v[112:115], v234, s[8:11], s27 offen
    s_waitcnt vmcnt(14)
    v_mfma_f32_32x32x16_bf16 v[160:175], v[120:123], v[56:59], v[160:175]
    s_mov_b32 s27, 19456
    buffer_load_dwordx4 v[56:59], v232, s[4:7], s27 offen
    buffer_load_dwordx4 v[120:123], v234, s[8:11], s27 offen
    s_waitcnt vmcnt(14)
    v_mfma_f32_32x32x16_bf16 v[160:175], v[128:131], v[64:67], v[160:175]
    s_mov_b32 s27, 20480
    buffer_load_dwordx4 v[64:67], v232, s[4:7], s27 offen
    buffer_load_dwordx4 v[128:131], v234, s[8:11], s27 offen
    s_waitcnt vmcnt(14)
    v_mfma_f32_32x32x16_bf16 v[160:175], v[136:139], v[72:75], v[160:175]
    s_mov_b32 s27, 21504
    buffer_load_dwordx4 v[72:75], v232, s[4:7], s27 offen
    buffer_load_dwordx4 v[136:139], v234, s[8:11], s27 offen
    s_waitcnt vmcnt(14)
    v_mfma_f32_32x32x16_bf16 v[160:175], v[144:147], v[80:83], v[160:175]
    s_mov_b32 s27, 22528
    buffer_load_dwordx4 v[80:83], v232, s[4:7], s27 offen
    buffer_load_dwordx4 v[144:147], v234, s[8:11], s27 offen
    s_waitcnt vmcnt(14)
    v_mfma_f32_32x32x16_bf16 v[160:175], v[152:155], v[88:91], v[160:175]
    s_mov_b32 s27, 23552
    buffer_load_dwordx4 v[88:91], v232, s[4:7], s27 offen
    buffer_load_dwordx4 v[152:155], v234, s[8:11], s27 offen
    s_waitcnt vmcnt(14)
    v_mfma_f32_32x32x16_bf16 v[160:175], v[96:99], v[32:35], v[160:175]
    s_mov_b32 s27, 24576
    buffer_load_dwordx4 v[32:35], v232, s[4:7], s27 offen
    buffer_load_dwordx4 v[96:99], v234, s[8:11], s27 offen
    s_waitcnt vmcnt(14)
    v_mfma_f32_32x32x16_bf16 v[160:175], v[104:107], v[40:43], v[160:175]
    s_mov_b32 s27, 25600
    buffer_load_dwordx4 v[40:43], v232, s[4:7], s27 offen
    buffer_load_dwordx4 v[104:107], v234, s[8:11], s27 offen
    s_waitcnt vmcnt(14)
    v_mfma_f32_32x32x16_bf16 v[160:175], v[112:115], v[48:51], v[160:175]
    s_mov_b32 s27, 26624
    buffer_load_dwordx4 v[48:51], v232, s[4:7], s27 offen
    buffer_load_dwordx4 v[112:115], v234, s[8:11], s27 offen
    s_waitcnt vmcnt(14)
    v_mfma_f32_32x32x16_bf16 v[160:175], v[120:123], v[56:59], v[160:175]
    s_mov_b32 s27, 27648
    buffer_load_dwordx4 v[56:59], v232, s[4:7], s27 offen
    buffer_load_dwordx4 v[120:123], v234, s[8:11], s27 offen
    s_waitcnt vmcnt(14)
    v_mfma_f32_32x32x16_bf16 v[160:175], v[128:131], v[64:67], v[160:175]
    s_mov_b32 s27, 28672
    buffer_load_dwordx4 v[64:67], v232, s[4:7], s27 offen
    buffer_load_dwordx4 v[128:131], v234, s[8:11], s27 offen
    s_waitcnt vmcnt(14)
    v_mfma_f32_32x32x16_bf16 v[160:175], v[136:139], v[72:75], v[160:175]
    s_mov_b32 s27, 29696
    buffer_load_dwordx4 v[72:75], v232, s[4:7], s27 offen
    buffer_load_dwordx4 v[136:139], v234, s[8:11], s27 offen
    s_waitcnt vmcnt(14)
    v_mfma_f32_32x32x16_bf16 v[160:175], v[144:147], v[80:83], v[160:175]
    s_mov_b32 s27, 30720
    buffer_load_dwordx4 v[80:83], v232, s[4:7], s27 offen
    buffer_load_dwordx4 v[144:147], v234, s[8:11], s27 offen
    s_waitcnt vmcnt(14)
    v_mfma_f32_32x32x16_bf16 v[160:175], v[152:155], v[88:91], v[160:175]
    s_mov_b32 s27, 31744
    buffer_load_dwordx4 v[88:91], v232, s[4:7], s27 offen
    buffer_load_dwordx4 v[152:155], v234, s[8:11], s27 offen
    s_waitcnt vmcnt(14)
    v_mfma_f32_32x32x16_bf16 v[160:175], v[96:99], v[32:35], v[160:175]
    s_waitcnt vmcnt(12)
    v_mfma_f32_32x32x16_bf16 v[160:175], v[104:107], v[40:43], v[160:175]
    s_waitcnt vmcnt(10)
    v_mfma_f32_32x32x16_bf16 v[160:175], v[112:115], v[48:51], v[160:175]
    s_waitcnt vmcnt(8)
    v_mfma_f32_32x32x16_bf16 v[160:175], v[120:123], v[56:59], v[160:175]
    s_waitcnt vmcnt(6)
    v_mfma_f32_32x32x16_bf16 v[160:175], v[128:131], v[64:67], v[160:175]
    s_waitcnt vmcnt(4)
    v_mfma_f32_32x32x16_bf16 v[160:175], v[136:139], v[72:75], v[160:175]
    s_waitcnt vmcnt(2)
    v_mfma_f32_32x32x16_bf16 v[160:175], v[144:147], v[80:83], v[160:175]
    s_waitcnt vmcnt(0)
    v_mfma_f32_32x32x16_bf16 v[160:175], v[152:155], v[88:91], v[160:175]
    s_nop 7
    s_nop 7
    s_lshl_b32 s23, s21, 5
    s_add_u32 s23, s23, 0
    s_lshl_b32 s24, s22, 5
    s_add_u32 s24, s24, 0
    s_cmp_ge_u32 s24, 512
    s_cbranch_scc1 L_wo_kernel_skip00
    v_add_u32 v4, s23, v2
    v_mov_b32 v16, v160
    v_mov_b32 v17, v161
    v_mov_b32 v18, v162
    v_mov_b32 v19, v163
    v_mov_b32 v20, v164
    v_mov_b32 v21, v165
    v_mov_b32 v22, v166
    v_mov_b32 v23, v167
    v_mov_b32 v24, v168
    v_mov_b32 v25, v169
    v_mov_b32 v26, v170
    v_mov_b32 v27, v171
    v_mov_b32 v28, v172
    v_mov_b32 v29, v173
    v_mov_b32 v30, v174
    v_mov_b32 v31, v175
    v_lshlrev_b32 v9, 2, v3
    v_add_u32 v9, s24, v9
    s_waitcnt lgkmcnt(0)
    s_add_u32 s12, s84, 0x1000000
    s_addc_u32 s13, s85, 0
    s_mov_b32 s14, 0x200000
    s_mov_b32 s15, 0x00020000
    s_waitcnt lgkmcnt(0)
    s_add_u32 s28, s64, 0x0
    s_addc_u32 s29, s65, 0
    s_mov_b32 s30, 0x200000
    s_mov_b32 s31, 0x00020000
    s_mov_b32 s25, 1024
    v_mul_lo_u32 v10, v4, s25
    v_lshlrev_b32 v11, 1, v9
    v_add_u32 v10, v10, v11
    v_add_u32 v11, 0, v9
    v_lshrrev_b32 v12, 5, v4
    s_mov_b32 s36, 32
    v_mul_lo_u32 v12, v12, s36
    v_lshrrev_b32 v13, 4, v11
    v_add_u32 v12, v12, v13
    v_lshlrev_b32 v60, 10, v12
    v_and_b32 v12, 31, v4
    v_lshlrev_b32 v12, 4, v12
    v_add_u32 v60, v60, v12
    v_lshrrev_b32 v12, 3, v11
    v_and_b32 v12, 1, v12
    v_lshlrev_b32 v12, 9, v12
    v_add_u32 v60, v60, v12
    v_and_b32 v12, 7, v11
    v_lshlrev_b32 v12, 1, v12
    v_add_u32 v60, v60, v12
    v_add_u32 v64, 0, v10
    v_add_u32 v11, 8, v9
    v_lshrrev_b32 v12, 5, v4
    s_mov_b32 s36, 32
    v_mul_lo_u32 v12, v12, s36
    v_lshrrev_b32 v13, 4, v11
    v_add_u32 v12, v12, v13
    v_lshlrev_b32 v61, 10, v12
    v_and_b32 v12, 31, v4
    v_lshlrev_b32 v12, 4, v12
    v_add_u32 v61, v61, v12
    v_lshrrev_b32 v12, 3, v11
    v_and_b32 v12, 1, v12
    v_lshlrev_b32 v12, 9, v12
    v_add_u32 v61, v61, v12
    v_and_b32 v12, 7, v11
    v_lshlrev_b32 v12, 1, v12
    v_add_u32 v61, v61, v12
    v_add_u32 v65, 16, v10
    v_add_u32 v11, 16, v9
    v_lshrrev_b32 v12, 5, v4
    s_mov_b32 s36, 32
    v_mul_lo_u32 v12, v12, s36
    v_lshrrev_b32 v13, 4, v11
    v_add_u32 v12, v12, v13
    v_lshlrev_b32 v62, 10, v12
    v_and_b32 v12, 31, v4
    v_lshlrev_b32 v12, 4, v12
    v_add_u32 v62, v62, v12
    v_lshrrev_b32 v12, 3, v11
    v_and_b32 v12, 1, v12
    v_lshlrev_b32 v12, 9, v12
    v_add_u32 v62, v62, v12
    v_and_b32 v12, 7, v11
    v_lshlrev_b32 v12, 1, v12
    v_add_u32 v62, v62, v12
    v_add_u32 v66, 32, v10
    v_add_u32 v11, 24, v9
    v_lshrrev_b32 v12, 5, v4
    s_mov_b32 s36, 32
    v_mul_lo_u32 v12, v12, s36
    v_lshrrev_b32 v13, 4, v11
    v_add_u32 v12, v12, v13
    v_lshlrev_b32 v63, 10, v12
    v_and_b32 v12, 31, v4
    v_lshlrev_b32 v12, 4, v12
    v_add_u32 v63, v63, v12
    v_lshrrev_b32 v12, 3, v11
    v_and_b32 v12, 1, v12
    v_lshlrev_b32 v12, 9, v12
    v_add_u32 v63, v63, v12
    v_and_b32 v12, 7, v11
    v_lshlrev_b32 v12, 1, v12
    v_add_u32 v63, v63, v12
    v_add_u32 v67, 48, v10
    buffer_load_dwordx2 v[40:41], v64, s[28:31], 0 offen
    buffer_load_dwordx2 v[42:43], v65, s[28:31], 0 offen
    buffer_load_dwordx2 v[44:45], v66, s[28:31], 0 offen
    buffer_load_dwordx2 v[46:47], v67, s[28:31], 0 offen
    s_waitcnt vmcnt(0)
    v_cvt_pk_bf16_f32 v13, v16, v16
    v_lshlrev_b32 v16, 16, v13
    v_lshlrev_b32 v13, 16, v40
    v_add_f32 v16, v16, v13
    v_cvt_pk_bf16_f32 v13, v17, v17
    v_lshlrev_b32 v17, 16, v13
    v_and_b32 v13, 0xffff0000, v40
    v_add_f32 v17, v17, v13
    v_cvt_pk_bf16_f32 v13, v18, v18
    v_lshlrev_b32 v18, 16, v13
    v_lshlrev_b32 v13, 16, v41
    v_add_f32 v18, v18, v13
    v_cvt_pk_bf16_f32 v13, v19, v19
    v_lshlrev_b32 v19, 16, v13
    v_and_b32 v13, 0xffff0000, v41
    v_add_f32 v19, v19, v13
    v_cvt_pk_bf16_f32 v14, v16, v17
    v_cvt_pk_bf16_f32 v15, v18, v19
    buffer_store_dwordx2 v[14:15], v60, s[12:15], 0 offen
    v_cvt_pk_bf16_f32 v13, v20, v20
    v_lshlrev_b32 v20, 16, v13
    v_lshlrev_b32 v13, 16, v42
    v_add_f32 v20, v20, v13
    v_cvt_pk_bf16_f32 v13, v21, v21
    v_lshlrev_b32 v21, 16, v13
    v_and_b32 v13, 0xffff0000, v42
    v_add_f32 v21, v21, v13
    v_cvt_pk_bf16_f32 v13, v22, v22
    v_lshlrev_b32 v22, 16, v13
    v_lshlrev_b32 v13, 16, v43
    v_add_f32 v22, v22, v13
    v_cvt_pk_bf16_f32 v13, v23, v23
    v_lshlrev_b32 v23, 16, v13
    v_and_b32 v13, 0xffff0000, v43
    v_add_f32 v23, v23, v13
    v_cvt_pk_bf16_f32 v14, v20, v21
    v_cvt_pk_bf16_f32 v15, v22, v23
    buffer_store_dwordx2 v[14:15], v61, s[12:15], 0 offen
    v_cvt_pk_bf16_f32 v13, v24, v24
    v_lshlrev_b32 v24, 16, v13
    v_lshlrev_b32 v13, 16, v44
    v_add_f32 v24, v24, v13
    v_cvt_pk_bf16_f32 v13, v25, v25
    v_lshlrev_b32 v25, 16, v13
    v_and_b32 v13, 0xffff0000, v44
    v_add_f32 v25, v25, v13
    v_cvt_pk_bf16_f32 v13, v26, v26
    v_lshlrev_b32 v26, 16, v13
    v_lshlrev_b32 v13, 16, v45
    v_add_f32 v26, v26, v13
    v_cvt_pk_bf16_f32 v13, v27, v27
    v_lshlrev_b32 v27, 16, v13
    v_and_b32 v13, 0xffff0000, v45
    v_add_f32 v27, v27, v13
    v_cvt_pk_bf16_f32 v14, v24, v25
    v_cvt_pk_bf16_f32 v15, v26, v27
    buffer_store_dwordx2 v[14:15], v62, s[12:15], 0 offen
    v_cvt_pk_bf16_f32 v13, v28, v28
    v_lshlrev_b32 v28, 16, v13
    v_lshlrev_b32 v13, 16, v46
    v_add_f32 v28, v28, v13
    v_cvt_pk_bf16_f32 v13, v29, v29
    v_lshlrev_b32 v29, 16, v13
    v_and_b32 v13, 0xffff0000, v46
    v_add_f32 v29, v29, v13
    v_cvt_pk_bf16_f32 v13, v30, v30
    v_lshlrev_b32 v30, 16, v13
    v_lshlrev_b32 v13, 16, v47
    v_add_f32 v30, v30, v13
    v_cvt_pk_bf16_f32 v13, v31, v31
    v_lshlrev_b32 v31, 16, v13
    v_and_b32 v13, 0xffff0000, v47
    v_add_f32 v31, v31, v13
    v_cvt_pk_bf16_f32 v14, v28, v29
    v_cvt_pk_bf16_f32 v15, v30, v31
    buffer_store_dwordx2 v[14:15], v63, s[12:15], 0 offen
L_wo_kernel_skip00:
L_end_wo_kernel:
    s_endpgm
.globl ln2_kernel
.p2align 8
.type ln2_kernel,@function
ln2_kernel:
    s_load_dwordx16 s[64:79], s[0:1], 0
    s_load_dwordx4 s[80:83], s[0:1], 64
    s_load_dwordx2 s[84:85], s[0:1], 80
    v_lshrrev_b32 v1, 6, v0
    s_nop 1
    v_readfirstlane_b32 s20, v1
    s_lshl_b32 s3, s2, 2
    s_add_u32 s20, s20, s3
    s_cmp_ge_u32 s20, 2048
    s_cbranch_scc1 L_end_ln2_kernel
    v_and_b32 v0, 63, v0
    s_waitcnt lgkmcnt(0)
    s_add_u32 s4, s84, 0x1000000
    s_addc_u32 s5, s85, 0
    s_mov_b32 s6, 0x200000
    s_mov_b32 s7, 0x00020000
    s_waitcnt lgkmcnt(0)
    s_add_u32 s8, s84, 0x1200000
    s_addc_u32 s9, s85, 0
    s_mov_b32 s10, 0x200000
    s_mov_b32 s11, 0x00020000
    s_waitcnt lgkmcnt(0)
    s_add_u32 s12, s84, 0x1400000
    s_addc_u32 s13, s85, 0
    s_mov_b32 s14, 0x200000
    s_mov_b32 s15, 0x00020000
    v_mov_b32 v5, s20
    v_lshlrev_b32 v6, 3, v0
    v_lshrrev_b32 v7, 5, v5
    s_mov_b32 s36, 32
    v_mul_lo_u32 v7, v7, s36
    v_lshrrev_b32 v8, 4, v6
    v_add_u32 v7, v7, v8
    v_lshlrev_b32 v2, 10, v7
    v_and_b32 v7, 31, v5
    v_lshlrev_b32 v7, 4, v7
    v_add_u32 v2, v2, v7
    v_lshrrev_b32 v7, 3, v6
    v_and_b32 v7, 1, v7
    v_lshlrev_b32 v7, 9, v7
    v_add_u32 v2, v2, v7
    v_and_b32 v7, 7, v6
    v_lshlrev_b32 v7, 1, v7
    v_add_u32 v2, v2, v7
    buffer_load_dwordx4 v[10:13], v2, s[4:7], 0 offen
    s_waitcnt vmcnt(0)
    v_lshlrev_b32 v30, 16, v10
    v_and_b32 v31, 0xffff0000, v10
    v_lshlrev_b32 v32, 16, v11
    v_and_b32 v33, 0xffff0000, v11
    v_lshlrev_b32 v34, 16, v12
    v_and_b32 v35, 0xffff0000, v12
    v_lshlrev_b32 v36, 16, v13
    v_and_b32 v37, 0xffff0000, v13
    v_add_f32 v40, v30, v31
    v_add_f32 v40, v40, v32
    v_add_f32 v40, v40, v33
    v_add_f32 v40, v40, v34
    v_add_f32 v40, v40, v35
    v_add_f32 v40, v40, v36
    v_add_f32 v40, v40, v37
    v_xor_b32 v42, 32, v0
    v_lshlrev_b32 v42, 2, v42
    ds_bpermute_b32 v41, v42, v40
    s_waitcnt lgkmcnt(0)
    v_add_f32 v40, v40, v41
    v_xor_b32 v42, 16, v0
    v_lshlrev_b32 v42, 2, v42
    ds_bpermute_b32 v41, v42, v40
    s_waitcnt lgkmcnt(0)
    v_add_f32 v40, v40, v41
    v_xor_b32 v42, 8, v0
    v_lshlrev_b32 v42, 2, v42
    ds_bpermute_b32 v41, v42, v40
    s_waitcnt lgkmcnt(0)
    v_add_f32 v40, v40, v41
    v_xor_b32 v42, 4, v0
    v_lshlrev_b32 v42, 2, v42
    ds_bpermute_b32 v41, v42, v40
    s_waitcnt lgkmcnt(0)
    v_add_f32 v40, v40, v41
    v_xor_b32 v42, 2, v0
    v_lshlrev_b32 v42, 2, v42
    ds_bpermute_b32 v41, v42, v40
    s_waitcnt lgkmcnt(0)
    v_add_f32 v40, v40, v41
    v_xor_b32 v42, 1, v0
    v_lshlrev_b32 v42, 2, v42
    ds_bpermute_b32 v41, v42, v40
    s_waitcnt lgkmcnt(0)
    v_add_f32 v40, v40, v41
    v_mul_f32 v40, 0x3b000000, v40
    v_sub_f32 v30, v30, v40
    v_sub_f32 v31, v31, v40
    v_sub_f32 v32, v32, v40
    v_sub_f32 v33, v33, v40
    v_sub_f32 v34, v34, v40
    v_sub_f32 v35, v35, v40
    v_sub_f32 v36, v36, v40
    v_sub_f32 v37, v37, v40
    v_mul_f32 v43, v30, v30
    v_fma_f32 v43, v31, v31, v43
    v_fma_f32 v43, v32, v32, v43
    v_fma_f32 v43, v33, v33, v43
    v_fma_f32 v43, v34, v34, v43
    v_fma_f32 v43, v35, v35, v43
    v_fma_f32 v43, v36, v36, v43
    v_fma_f32 v43, v37, v37, v43
    v_xor_b32 v42, 32, v0
    v_lshlrev_b32 v42, 2, v42
    ds_bpermute_b32 v41, v42, v43
    s_waitcnt lgkmcnt(0)
    v_add_f32 v43, v43, v41
    v_xor_b32 v42, 16, v0
    v_lshlrev_b32 v42, 2, v42
    ds_bpermute_b32 v41, v42, v43
    s_waitcnt lgkmcnt(0)
    v_add_f32 v43, v43, v41
    v_xor_b32 v42, 8, v0
    v_lshlrev_b32 v42, 2, v42
    ds_bpermute_b32 v41, v42, v43
    s_waitcnt lgkmcnt(0)
    v_add_f32 v43, v43, v41
    v_xor_b32 v42, 4, v0
    v_lshlrev_b32 v42, 2, v42
    ds_bpermute_b32 v41, v42, v43
    s_waitcnt lgkmcnt(0)
    v_add_f32 v43, v43, v41
    v_xor_b32 v42, 2, v0
    v_lshlrev_b32 v42, 2, v42
    ds_bpermute_b32 v41, v42, v43
    s_waitcnt lgkmcnt(0)
    v_add_f32 v43, v43, v41
    v_xor_b32 v42, 1, v0
    v_lshlrev_b32 v42, 2, v42
    ds_bpermute_b32 v41, v42, v43
    s_waitcnt lgkmcnt(0)
    v_add_f32 v43, v43, v41
    v_mov_b32 v44, 0x3727c5ac
    v_mul_f32 v43, 0x3b000000, v43
    v_add_f32 v43, v43, v44
    v_rsq_f32 v43, v43
    s_nop 1
    v_mul_f32 v30, v30, v43
    v_mul_f32 v31, v31, v43
    v_mul_f32 v32, v32, v43
    v_mul_f32 v33, v33, v43
    v_mul_f32 v34, v34, v43
    v_mul_f32 v35, v35, v43
    v_mul_f32 v36, v36, v43
    v_mul_f32 v37, v37, v43
    v_cvt_pk_bf16_f32 v20, v30, v31
    v_cvt_pk_bf16_f32 v21, v32, v33
    v_cvt_pk_bf16_f32 v22, v34, v35
    v_cvt_pk_bf16_f32 v23, v36, v37
    buffer_store_dwordx4 v[20:23], v2, s[8:11], 0 offen
    v_lshlrev_b32 v30, 16, v20
    v_and_b32 v31, 0xffff0000, v20
    v_lshlrev_b32 v32, 16, v21
    v_and_b32 v33, 0xffff0000, v21
    v_lshlrev_b32 v34, 16, v22
    v_and_b32 v35, 0xffff0000, v22
    v_lshlrev_b32 v36, 16, v23
    v_and_b32 v37, 0xffff0000, v23
    v_add_f32 v40, v30, v31
    v_add_f32 v40, v40, v32
    v_add_f32 v40, v40, v33
    v_add_f32 v40, v40, v34
    v_add_f32 v40, v40, v35
    v_add_f32 v40, v40, v36
    v_add_f32 v40, v40, v37
    v_xor_b32 v42, 32, v0
    v_lshlrev_b32 v42, 2, v42
    ds_bpermute_b32 v41, v42, v40
    s_waitcnt lgkmcnt(0)
    v_add_f32 v40, v40, v41
    v_xor_b32 v42, 16, v0
    v_lshlrev_b32 v42, 2, v42
    ds_bpermute_b32 v41, v42, v40
    s_waitcnt lgkmcnt(0)
    v_add_f32 v40, v40, v41
    v_xor_b32 v42, 8, v0
    v_lshlrev_b32 v42, 2, v42
    ds_bpermute_b32 v41, v42, v40
    s_waitcnt lgkmcnt(0)
    v_add_f32 v40, v40, v41
    v_xor_b32 v42, 4, v0
    v_lshlrev_b32 v42, 2, v42
    ds_bpermute_b32 v41, v42, v40
    s_waitcnt lgkmcnt(0)
    v_add_f32 v40, v40, v41
    v_xor_b32 v42, 2, v0
    v_lshlrev_b32 v42, 2, v42
    ds_bpermute_b32 v41, v42, v40
    s_waitcnt lgkmcnt(0)
    v_add_f32 v40, v40, v41
    v_xor_b32 v42, 1, v0
    v_lshlrev_b32 v42, 2, v42
    ds_bpermute_b32 v41, v42, v40
    s_waitcnt lgkmcnt(0)
    v_add_f32 v40, v40, v41
    v_mul_f32 v40, 0x3b000000, v40
    v_sub_f32 v30, v30, v40
    v_sub_f32 v31, v31, v40
    v_sub_f32 v32, v32, v40
    v_sub_f32 v33, v33, v40
    v_sub_f32 v34, v34, v40
    v_sub_f32 v35, v35, v40
    v_sub_f32 v36, v36, v40
    v_sub_f32 v37, v37, v40
    v_mul_f32 v43, v30, v30
    v_fma_f32 v43, v31, v31, v43
    v_fma_f32 v43, v32, v32, v43
    v_fma_f32 v43, v33, v33, v43
    v_fma_f32 v43, v34, v34, v43
    v_fma_f32 v43, v35, v35, v43
    v_fma_f32 v43, v36, v36, v43
    v_fma_f32 v43, v37, v37, v43
    v_xor_b32 v42, 32, v0
    v_lshlrev_b32 v42, 2, v42
    ds_bpermute_b32 v41, v42, v43
    s_waitcnt lgkmcnt(0)
    v_add_f32 v43, v43, v41
    v_xor_b32 v42, 16, v0
    v_lshlrev_b32 v42, 2, v42
    ds_bpermute_b32 v41, v42, v43
    s_waitcnt lgkmcnt(0)
    v_add_f32 v43, v43, v41
    v_xor_b32 v42, 8, v0
    v_lshlrev_b32 v42, 2, v42
    ds_bpermute_b32 v41, v42, v43
    s_waitcnt lgkmcnt(0)
    v_add_f32 v43, v43, v41
    v_xor_b32 v42, 4, v0
    v_lshlrev_b32 v42, 2, v42
    ds_bpermute_b32 v41, v42, v43
    s_waitcnt lgkmcnt(0)
    v_add_f32 v43, v43, v41
    v_xor_b32 v42, 2, v0
    v_lshlrev_b32 v42, 2, v42
    ds_bpermute_b32 v41, v42, v43
    s_waitcnt lgkmcnt(0)
    v_add_f32 v43, v43, v41
    v_xor_b32 v42, 1, v0
    v_lshlrev_b32 v42, 2, v42
    ds_bpermute_b32 v41, v42, v43
    s_waitcnt lgkmcnt(0)
    v_add_f32 v43, v43, v41
    v_mov_b32 v44, 0x3727c5ac
    v_mul_f32 v43, 0x3b000000, v43
    v_add_f32 v43, v43, v44
    v_rsq_f32 v43, v43
    s_nop 1
    v_mul_f32 v30, v30, v43
    v_mul_f32 v31, v31, v43
    v_mul_f32 v32, v32, v43
    v_mul_f32 v33, v33, v43
    v_mul_f32 v34, v34, v43
    v_mul_f32 v35, v35, v43
    v_mul_f32 v36, v36, v43
    v_mul_f32 v37, v37, v43
    v_cvt_pk_bf16_f32 v24, v30, v31
    v_cvt_pk_bf16_f32 v25, v32, v33
    v_cvt_pk_bf16_f32 v26, v34, v35
    v_cvt_pk_bf16_f32 v27, v36, v37
    buffer_store_dwordx4 v[24:27], v2, s[12:15], 0 offen
L_end_ln2_kernel:
    s_endpgm
.globl w1_kernel
.p2align 8
.type w1_kernel,@function
w1_kernel:
    s_load_dwordx16 s[64:79], s[0:1], 0
    s_load_dwordx4 s[80:83], s[0:1], 64
    s_load_dwordx2 s[84:85], s[0:1], 80
    v_lshrrev_b32 v1, 6, v0
    s_nop 1
    v_readfirstlane_b32 s20, v1
    s_lshl_b32 s3, s2, 2
    s_add_u32 s20, s20, s3
    s_cmp_ge_u32 s20, 1024
    s_cbranch_scc1 L_end_w1_kernel
    v_and_b32 v0, 63, v0
    s_and_b32 s21, s20, 63
    s_lshr_b32 s22, s20, 6
    s_waitcnt lgkmcnt(0)
    s_add_u32 s4, s84, 0x1400000
    s_addc_u32 s5, s85, 0
    s_mov_b32 s6, 0x200000
    s_mov_b32 s7, 0x00020000
    s_waitcnt lgkmcnt(0)
    s_add_u32 s8, s84, 0x200000
    s_addc_u32 s9, s85, 0
    s_mov_b32 s10, 0x80000
    s_mov_b32 s11, 0x00020000
    v_and_b32 v2, 31, v0
    v_lshrrev_b32 v3, 5, v0
    v_lshlrev_b32 v8, 4, v0
    s_mul_i32 s25, s21, 32768
    s_add_u32 s25, s25, 0
    v_add_u32 v232, s25, v8
    s_mul_i32 s25, s22, 32768
    s_add_u32 s25, s25, 0
    v_add_u32 v234, s25, v8
    v_mov_b32 v160, 0
    v_mov_b32 v161, 0
    v_mov_b32 v162, 0
    v_mov_b32 v163, 0
    v_mov_b32 v164, 0
    v_mov_b32 v165, 0
    v_mov_b32 v166, 0
    v_mov_b32 v167, 0
    v_mov_b32 v168, 0
    v_mov_b32 v169, 0
    v_mov_b32 v170, 0
    v_mov_b32 v171, 0
    v_mov_b32 v172, 0
    v_mov_b32 v173, 0
    v_mov_b32 v174, 0
    v_mov_b32 v175, 0
    s_mov_b32 s27, 0
    buffer_load_dwordx4 v[32:35], v232, s[4:7], s27 offen
    buffer_load_dwordx4 v[96:99], v234, s[8:11], s27 offen
    s_mov_b32 s27, 1024
    buffer_load_dwordx4 v[40:43], v232, s[4:7], s27 offen
    buffer_load_dwordx4 v[104:107], v234, s[8:11], s27 offen
    s_mov_b32 s27, 2048
    buffer_load_dwordx4 v[48:51], v232, s[4:7], s27 offen
    buffer_load_dwordx4 v[112:115], v234, s[8:11], s27 offen
    s_mov_b32 s27, 3072
    buffer_load_dwordx4 v[56:59], v232, s[4:7], s27 offen
    buffer_load_dwordx4 v[120:123], v234, s[8:11], s27 offen
    s_mov_b32 s27, 4096
    buffer_load_dwordx4 v[64:67], v232, s[4:7], s27 offen
    buffer_load_dwordx4 v[128:131], v234, s[8:11], s27 offen
    s_mov_b32 s27, 5120
    buffer_load_dwordx4 v[72:75], v232, s[4:7], s27 offen
    buffer_load_dwordx4 v[136:139], v234, s[8:11], s27 offen
    s_mov_b32 s27, 6144
    buffer_load_dwordx4 v[80:83], v232, s[4:7], s27 offen
    buffer_load_dwordx4 v[144:147], v234, s[8:11], s27 offen
    s_mov_b32 s27, 7168
    buffer_load_dwordx4 v[88:91], v232, s[4:7], s27 offen
    buffer_load_dwordx4 v[152:155], v234, s[8:11], s27 offen
    s_waitcnt vmcnt(14)
    v_mfma_f32_32x32x16_bf16 v[160:175], v[96:99], v[32:35], v[160:175]
    s_mov_b32 s27, 8192
    buffer_load_dwordx4 v[32:35], v232, s[4:7], s27 offen
    buffer_load_dwordx4 v[96:99], v234, s[8:11], s27 offen
    s_waitcnt vmcnt(14)
    v_mfma_f32_32x32x16_bf16 v[160:175], v[104:107], v[40:43], v[160:175]
    s_mov_b32 s27, 9216
    buffer_load_dwordx4 v[40:43], v232, s[4:7], s27 offen
    buffer_load_dwordx4 v[104:107], v234, s[8:11], s27 offen
    s_waitcnt vmcnt(14)
    v_mfma_f32_32x32x16_bf16 v[160:175], v[112:115], v[48:51], v[160:175]
    s_mov_b32 s27, 10240
    buffer_load_dwordx4 v[48:51], v232, s[4:7], s27 offen
    buffer_load_dwordx4 v[112:115], v234, s[8:11], s27 offen
    s_waitcnt vmcnt(14)
    v_mfma_f32_32x32x16_bf16 v[160:175], v[120:123], v[56:59], v[160:175]
    s_mov_b32 s27, 11264
    buffer_load_dwordx4 v[56:59], v232, s[4:7], s27 offen
    buffer_load_dwordx4 v[120:123], v234, s[8:11], s27 offen
    s_waitcnt vmcnt(14)
    v_mfma_f32_32x32x16_bf16 v[160:175], v[128:131], v[64:67], v[160:175]
    s_mov_b32 s27, 12288
    buffer_load_dwordx4 v[64:67], v232, s[4:7], s27 offen
    buffer_load_dwordx4 v[128:131], v234, s[8:11], s27 offen
    s_waitcnt vmcnt(14)
    v_mfma_f32_32x32x16_bf16 v[160:175], v[136:139], v[72:75], v[160:175]
    s_mov_b32 s27, 13312
    buffer_load_dwordx4 v[72:75], v232, s[4:7], s27 offen
    buffer_load_dwordx4 v[136:139], v234, s[8:11], s27 offen
    s_waitcnt vmcnt(14)
    v_mfma_f32_32x32x16_bf16 v[160:175], v[144:147], v[80:83], v[160:175]
    s_mov_b32 s27, 14336
    buffer_load_dwordx4 v[80:83], v232, s[4:7], s27 offen
    buffer_load_dwordx4 v[144:147], v234, s[8:11], s27 offen
    s_waitcnt vmcnt(14)
    v_mfma_f32_32x32x16_bf16 v[160:175], v[152:155], v[88:91], v[160:175]
    s_mov_b32 s27, 15360
    buffer_load_dwordx4 v[88:91], v232, s[4:7], s27 offen
    buffer_load_dwordx4 v[152:155], v234, s[8:11], s27 offen
    s_waitcnt vmcnt(14)
    v_mfma_f32_32x32x16_bf16 v[160:175], v[96:99], v[32:35], v[160:175]
    s_mov_b32 s27, 16384
    buffer_load_dwordx4 v[32:35], v232, s[4:7], s27 offen
    buffer_load_dwordx4 v[96:99], v234, s[8:11], s27 offen
    s_waitcnt vmcnt(14)
    v_mfma_f32_32x32x16_bf16 v[160:175], v[104:107], v[40:43], v[160:175]
    s_mov_b32 s27, 17408
    buffer_load_dwordx4 v[40:43], v232, s[4:7], s27 offen
    buffer_load_dwordx4 v[104:107], v234, s[8:11], s27 offen
    s_waitcnt vmcnt(14)
    v_mfma_f32_32x32x16_bf16 v[160:175], v[112:115], v[48:51], v[160:175]
    s_mov_b32 s27, 18432
    buffer_load_dwordx4 v[48:51], v232, s[4:7], s27 offen
    buffer_load_dwordx4 v[112:115], v234, s[8:11], s27 offen
    s_waitcnt vmcnt(14)
    v_mfma_f32_32x32x16_bf16 v[160:175], v[120:123], v[56:59], v[160:175]
    s_mov_b32 s27, 19456
    buffer_load_dwordx4 v[56:59], v232, s[4:7], s27 offen
    buffer_load_dwordx4 v[120:123], v234, s[8:11], s27 offen
    s_waitcnt vmcnt(14)
    v_mfma_f32_32x32x16_bf16 v[160:175], v[128:131], v[64:67], v[160:175]
    s_mov_b32 s27, 20480
    buffer_load_dwordx4 v[64:67], v232, s[4:7], s27 offen
    buffer_load_dwordx4 v[128:131], v234, s[8:11], s27 offen
    s_waitcnt vmcnt(14)
    v_mfma_f32_32x32x16_bf16 v[160:175], v[136:139], v[72:75], v[160:175]
    s_mov_b32 s27, 21504
    buffer_load_dwordx4 v[72:75], v232, s[4:7], s27 offen
    buffer_load_dwordx4 v[136:139], v234, s[8:11], s27 offen
    s_waitcnt vmcnt(14)
    v_mfma_f32_32x32x16_bf16 v[160:175], v[144:147], v[80:83], v[160:175]
    s_mov_b32 s27, 22528
    buffer_load_dwordx4 v[80:83], v232, s[4:7], s27 offen
    buffer_load_dwordx4 v[144:147], v234, s[8:11], s27 offen
    s_waitcnt vmcnt(14)
    v_mfma_f32_32x32x16_bf16 v[160:175], v[152:155], v[88:91], v[160:175]
    s_mov_b32 s27, 23552
    buffer_load_dwordx4 v[88:91], v232, s[4:7], s27 offen
    buffer_load_dwordx4 v[152:155], v234, s[8:11], s27 offen
    s_waitcnt vmcnt(14)
    v_mfma_f32_32x32x16_bf16 v[160:175], v[96:99], v[32:35], v[160:175]
    s_mov_b32 s27, 24576
    buffer_load_dwordx4 v[32:35], v232, s[4:7], s27 offen
    buffer_load_dwordx4 v[96:99], v234, s[8:11], s27 offen
    s_waitcnt vmcnt(14)
    v_mfma_f32_32x32x16_bf16 v[160:175], v[104:107], v[40:43], v[160:175]
    s_mov_b32 s27, 25600
    buffer_load_dwordx4 v[40:43], v232, s[4:7], s27 offen
    buffer_load_dwordx4 v[104:107], v234, s[8:11], s27 offen
    s_waitcnt vmcnt(14)
    v_mfma_f32_32x32x16_bf16 v[160:175], v[112:115], v[48:51], v[160:175]
    s_mov_b32 s27, 26624
    buffer_load_dwordx4 v[48:51], v232, s[4:7], s27 offen
    buffer_load_dwordx4 v[112:115], v234, s[8:11], s27 offen
    s_waitcnt vmcnt(14)
    v_mfma_f32_32x32x16_bf16 v[160:175], v[120:123], v[56:59], v[160:175]
    s_mov_b32 s27, 27648
    buffer_load_dwordx4 v[56:59], v232, s[4:7], s27 offen
    buffer_load_dwordx4 v[120:123], v234, s[8:11], s27 offen
    s_waitcnt vmcnt(14)
    v_mfma_f32_32x32x16_bf16 v[160:175], v[128:131], v[64:67], v[160:175]
    s_mov_b32 s27, 28672
    buffer_load_dwordx4 v[64:67], v232, s[4:7], s27 offen
    buffer_load_dwordx4 v[128:131], v234, s[8:11], s27 offen
    s_waitcnt vmcnt(14)
    v_mfma_f32_32x32x16_bf16 v[160:175], v[136:139], v[72:75], v[160:175]
    s_mov_b32 s27, 29696
    buffer_load_dwordx4 v[72:75], v232, s[4:7], s27 offen
    buffer_load_dwordx4 v[136:139], v234, s[8:11], s27 offen
    s_waitcnt vmcnt(14)
    v_mfma_f32_32x32x16_bf16 v[160:175], v[144:147], v[80:83], v[160:175]
    s_mov_b32 s27, 30720
    buffer_load_dwordx4 v[80:83], v232, s[4:7], s27 offen
    buffer_load_dwordx4 v[144:147], v234, s[8:11], s27 offen
    s_waitcnt vmcnt(14)
    v_mfma_f32_32x32x16_bf16 v[160:175], v[152:155], v[88:91], v[160:175]
    s_mov_b32 s27, 31744
    buffer_load_dwordx4 v[88:91], v232, s[4:7], s27 offen
    buffer_load_dwordx4 v[152:155], v234, s[8:11], s27 offen
    s_waitcnt vmcnt(14)
    v_mfma_f32_32x32x16_bf16 v[160:175], v[96:99], v[32:35], v[160:175]
    s_waitcnt vmcnt(12)
    v_mfma_f32_32x32x16_bf16 v[160:175], v[104:107], v[40:43], v[160:175]
    s_waitcnt vmcnt(10)
    v_mfma_f32_32x32x16_bf16 v[160:175], v[112:115], v[48:51], v[160:175]
    s_waitcnt vmcnt(8)
    v_mfma_f32_32x32x16_bf16 v[160:175], v[120:123], v[56:59], v[160:175]
    s_waitcnt vmcnt(6)
    v_mfma_f32_32x32x16_bf16 v[160:175], v[128:131], v[64:67], v[160:175]
    s_waitcnt vmcnt(4)
    v_mfma_f32_32x32x16_bf16 v[160:175], v[136:139], v[72:75], v[160:175]
    s_waitcnt vmcnt(2)
    v_mfma_f32_32x32x16_bf16 v[160:175], v[144:147], v[80:83], v[160:175]
    s_waitcnt vmcnt(0)
    v_mfma_f32_32x32x16_bf16 v[160:175], v[152:155], v[88:91], v[160:175]
    s_nop 7
    s_nop 7
    s_lshl_b32 s23, s21, 5
    s_add_u32 s23, s23, 0
    s_lshl_b32 s24, s22, 5
    s_add_u32 s24, s24, 0
    s_cmp_ge_u32 s24, 512
    s_cbranch_scc1 L_w1_kernel_skip00
    v_add_u32 v4, s23, v2
    v_mov_b32 v16, v160
    v_mov_b32 v17, v161
    v_mov_b32 v18, v162
    v_mov_b32 v19, v163
    v_mov_b32 v20, v164
    v_mov_b32 v21, v165
    v_mov_b32 v22, v166
    v_mov_b32 v23, v167
    v_mov_b32 v24, v168
    v_mov_b32 v25, v169
    v_mov_b32 v26, v170
    v_mov_b32 v27, v171
    v_mov_b32 v28, v172
    v_mov_b32 v29, v173
    v_mov_b32 v30, v174
    v_mov_b32 v31, v175
    v_lshlrev_b32 v9, 2, v3
    v_add_u32 v9, s24, v9
    s_waitcnt lgkmcnt(0)
    s_add_u32 s12, s84, 0x1600000
    s_addc_u32 s13, s85, 0
    s_mov_b32 s14, 0x200000
    s_mov_b32 s15, 0x00020000
    s_mov_b32 s25, 1024
    v_mul_lo_u32 v10, v4, s25
    v_lshlrev_b32 v11, 1, v9
    v_add_u32 v10, v10, v11
    v_add_u32 v11, 0, v9
    v_lshrrev_b32 v12, 5, v4
    s_mov_b32 s36, 32
    v_mul_lo_u32 v12, v12, s36
    v_lshrrev_b32 v13, 4, v11
    v_add_u32 v12, v12, v13
    v_lshlrev_b32 v60, 10, v12
    v_and_b32 v12, 31, v4
    v_lshlrev_b32 v12, 4, v12
    v_add_u32 v60, v60, v12
    v_lshrrev_b32 v12, 3, v11
    v_and_b32 v12, 1, v12
    v_lshlrev_b32 v12, 9, v12
    v_add_u32 v60, v60, v12
    v_and_b32 v12, 7, v11
    v_lshlrev_b32 v12, 1, v12
    v_add_u32 v60, v60, v12
    v_add_u32 v64, 0, v10
    v_add_u32 v11, 8, v9
    v_lshrrev_b32 v12, 5, v4
    s_mov_b32 s36, 32
    v_mul_lo_u32 v12, v12, s36
    v_lshrrev_b32 v13, 4, v11
    v_add_u32 v12, v12, v13
    v_lshlrev_b32 v61, 10, v12
    v_and_b32 v12, 31, v4
    v_lshlrev_b32 v12, 4, v12
    v_add_u32 v61, v61, v12
    v_lshrrev_b32 v12, 3, v11
    v_and_b32 v12, 1, v12
    v_lshlrev_b32 v12, 9, v12
    v_add_u32 v61, v61, v12
    v_and_b32 v12, 7, v11
    v_lshlrev_b32 v12, 1, v12
    v_add_u32 v61, v61, v12
    v_add_u32 v65, 16, v10
    v_add_u32 v11, 16, v9
    v_lshrrev_b32 v12, 5, v4
    s_mov_b32 s36, 32
    v_mul_lo_u32 v12, v12, s36
    v_lshrrev_b32 v13, 4, v11
    v_add_u32 v12, v12, v13
    v_lshlrev_b32 v62, 10, v12
    v_and_b32 v12, 31, v4
    v_lshlrev_b32 v12, 4, v12
    v_add_u32 v62, v62, v12
    v_lshrrev_b32 v12, 3, v11
    v_and_b32 v12, 1, v12
    v_lshlrev_b32 v12, 9, v12
    v_add_u32 v62, v62, v12
    v_and_b32 v12, 7, v11
    v_lshlrev_b32 v12, 1, v12
    v_add_u32 v62, v62, v12
    v_add_u32 v66, 32, v10
    v_add_u32 v11, 24, v9
    v_lshrrev_b32 v12, 5, v4
    s_mov_b32 s36, 32
    v_mul_lo_u32 v12, v12, s36
    v_lshrrev_b32 v13, 4, v11
    v_add_u32 v12, v12, v13
    v_lshlrev_b32 v63, 10, v12
    v_and_b32 v12, 31, v4
    v_lshlrev_b32 v12, 4, v12
    v_add_u32 v63, v63, v12
    v_lshrrev_b32 v12, 3, v11
    v_and_b32 v12, 1, v12
    v_lshlrev_b32 v12, 9, v12
    v_add_u32 v63, v63, v12
    v_and_b32 v12, 7, v11
    v_lshlrev_b32 v12, 1, v12
    v_add_u32 v63, v63, v12
    v_add_u32 v67, 48, v10
    s_waitcnt vmcnt(0)
    v_cvt_pk_bf16_f32 v13, v16, v16
    v_lshlrev_b32 v16, 16, v13
    v_mul_f32 v13, v16, v16
    v_mov_b32 v14, 0x3d372713
    v_fma_f32 v13, v13, v14, 1.0
    v_mul_f32 v13, v13, v16
    v_mul_f32 v13, 0xc0135761, v13
    v_exp_f32 v13, v13
    s_nop 0
    v_add_f32 v13, 1.0, v13
    v_rcp_f32 v13, v13
    s_nop 0
    v_mul_f32 v16, v16, v13
    v_cvt_pk_bf16_f32 v13, v17, v17
    v_lshlrev_b32 v17, 16, v13
    v_mul_f32 v13, v17, v17
    v_mov_b32 v14, 0x3d372713
    v_fma_f32 v13, v13, v14, 1.0
    v_mul_f32 v13, v13, v17
    v_mul_f32 v13, 0xc0135761, v13
    v_exp_f32 v13, v13
    s_nop 0
    v_add_f32 v13, 1.0, v13
    v_rcp_f32 v13, v13
    s_nop 0
    v_mul_f32 v17, v17, v13
    v_cvt_pk_bf16_f32 v13, v18, v18
    v_lshlrev_b32 v18, 16, v13
    v_mul_f32 v13, v18, v18
    v_mov_b32 v14, 0x3d372713
    v_fma_f32 v13, v13, v14, 1.0
    v_mul_f32 v13, v13, v18
    v_mul_f32 v13, 0xc0135761, v13
    v_exp_f32 v13, v13
    s_nop 0
    v_add_f32 v13, 1.0, v13
    v_rcp_f32 v13, v13
    s_nop 0
    v_mul_f32 v18, v18, v13
    v_cvt_pk_bf16_f32 v13, v19, v19
    v_lshlrev_b32 v19, 16, v13
    v_mul_f32 v13, v19, v19
    v_mov_b32 v14, 0x3d372713
    v_fma_f32 v13, v13, v14, 1.0
    v_mul_f32 v13, v13, v19
    v_mul_f32 v13, 0xc0135761, v13
    v_exp_f32 v13, v13
    s_nop 0
    v_add_f32 v13, 1.0, v13
    v_rcp_f32 v13, v13
    s_nop 0
    v_mul_f32 v19, v19, v13
    v_cvt_pk_bf16_f32 v14, v16, v17
    v_cvt_pk_bf16_f32 v15, v18, v19
    buffer_store_dwordx2 v[14:15], v60, s[12:15], 0 offen
    v_cvt_pk_bf16_f32 v13, v20, v20
    v_lshlrev_b32 v20, 16, v13
    v_mul_f32 v13, v20, v20
    v_mov_b32 v14, 0x3d372713
    v_fma_f32 v13, v13, v14, 1.0
    v_mul_f32 v13, v13, v20
    v_mul_f32 v13, 0xc0135761, v13
    v_exp_f32 v13, v13
    s_nop 0
    v_add_f32 v13, 1.0, v13
    v_rcp_f32 v13, v13
    s_nop 0
    v_mul_f32 v20, v20, v13
    v_cvt_pk_bf16_f32 v13, v21, v21
    v_lshlrev_b32 v21, 16, v13
    v_mul_f32 v13, v21, v21
    v_mov_b32 v14, 0x3d372713
    v_fma_f32 v13, v13, v14, 1.0
    v_mul_f32 v13, v13, v21
    v_mul_f32 v13, 0xc0135761, v13
    v_exp_f32 v13, v13
    s_nop 0
    v_add_f32 v13, 1.0, v13
    v_rcp_f32 v13, v13
    s_nop 0
    v_mul_f32 v21, v21, v13
    v_cvt_pk_bf16_f32 v13, v22, v22
    v_lshlrev_b32 v22, 16, v13
    v_mul_f32 v13, v22, v22
    v_mov_b32 v14, 0x3d372713
    v_fma_f32 v13, v13, v14, 1.0
    v_mul_f32 v13, v13, v22
    v_mul_f32 v13, 0xc0135761, v13
    v_exp_f32 v13, v13
    s_nop 0
    v_add_f32 v13, 1.0, v13
    v_rcp_f32 v13, v13
    s_nop 0
    v_mul_f32 v22, v22, v13
    v_cvt_pk_bf16_f32 v13, v23, v23
    v_lshlrev_b32 v23, 16, v13
    v_mul_f32 v13, v23, v23
    v_mov_b32 v14, 0x3d372713
    v_fma_f32 v13, v13, v14, 1.0
    v_mul_f32 v13, v13, v23
    v_mul_f32 v13, 0xc0135761, v13
    v_exp_f32 v13, v13
    s_nop 0
    v_add_f32 v13, 1.0, v13
    v_rcp_f32 v13, v13
    s_nop 0
    v_mul_f32 v23, v23, v13
    v_cvt_pk_bf16_f32 v14, v20, v21
    v_cvt_pk_bf16_f32 v15, v22, v23
    buffer_store_dwordx2 v[14:15], v61, s[12:15], 0 offen
    v_cvt_pk_bf16_f32 v13, v24, v24
    v_lshlrev_b32 v24, 16, v13
    v_mul_f32 v13, v24, v24
    v_mov_b32 v14, 0x3d372713
    v_fma_f32 v13, v13, v14, 1.0
    v_mul_f32 v13, v13, v24
    v_mul_f32 v13, 0xc0135761, v13
    v_exp_f32 v13, v13
    s_nop 0
    v_add_f32 v13, 1.0, v13
    v_rcp_f32 v13, v13
    s_nop 0
    v_mul_f32 v24, v24, v13
    v_cvt_pk_bf16_f32 v13, v25, v25
    v_lshlrev_b32 v25, 16, v13
    v_mul_f32 v13, v25, v25
    v_mov_b32 v14, 0x3d372713
    v_fma_f32 v13, v13, v14, 1.0
    v_mul_f32 v13, v13, v25
    v_mul_f32 v13, 0xc0135761, v13
    v_exp_f32 v13, v13
    s_nop 0
    v_add_f32 v13, 1.0, v13
    v_rcp_f32 v13, v13
    s_nop 0
    v_mul_f32 v25, v25, v13
    v_cvt_pk_bf16_f32 v13, v26, v26
    v_lshlrev_b32 v26, 16, v13
    v_mul_f32 v13, v26, v26
    v_mov_b32 v14, 0x3d372713
    v_fma_f32 v13, v13, v14, 1.0
    v_mul_f32 v13, v13, v26
    v_mul_f32 v13, 0xc0135761, v13
    v_exp_f32 v13, v13
    s_nop 0
    v_add_f32 v13, 1.0, v13
    v_rcp_f32 v13, v13
    s_nop 0
    v_mul_f32 v26, v26, v13
    v_cvt_pk_bf16_f32 v13, v27, v27
    v_lshlrev_b32 v27, 16, v13
    v_mul_f32 v13, v27, v27
    v_mov_b32 v14, 0x3d372713
    v_fma_f32 v13, v13, v14, 1.0
    v_mul_f32 v13, v13, v27
    v_mul_f32 v13, 0xc0135761, v13
    v_exp_f32 v13, v13
    s_nop 0
    v_add_f32 v13, 1.0, v13
    v_rcp_f32 v13, v13
    s_nop 0
    v_mul_f32 v27, v27, v13
    v_cvt_pk_bf16_f32 v14, v24, v25
    v_cvt_pk_bf16_f32 v15, v26, v27
    buffer_store_dwordx2 v[14:15], v62, s[12:15], 0 offen
    v_cvt_pk_bf16_f32 v13, v28, v28
    v_lshlrev_b32 v28, 16, v13
    v_mul_f32 v13, v28, v28
    v_mov_b32 v14, 0x3d372713
    v_fma_f32 v13, v13, v14, 1.0
    v_mul_f32 v13, v13, v28
    v_mul_f32 v13, 0xc0135761, v13
    v_exp_f32 v13, v13
    s_nop 0
    v_add_f32 v13, 1.0, v13
    v_rcp_f32 v13, v13
    s_nop 0
    v_mul_f32 v28, v28, v13
    v_cvt_pk_bf16_f32 v13, v29, v29
    v_lshlrev_b32 v29, 16, v13
    v_mul_f32 v13, v29, v29
    v_mov_b32 v14, 0x3d372713
    v_fma_f32 v13, v13, v14, 1.0
    v_mul_f32 v13, v13, v29
    v_mul_f32 v13, 0xc0135761, v13
    v_exp_f32 v13, v13
    s_nop 0
    v_add_f32 v13, 1.0, v13
    v_rcp_f32 v13, v13
    s_nop 0
    v_mul_f32 v29, v29, v13
    v_cvt_pk_bf16_f32 v13, v30, v30
    v_lshlrev_b32 v30, 16, v13
    v_mul_f32 v13, v30, v30
    v_mov_b32 v14, 0x3d372713
    v_fma_f32 v13, v13, v14, 1.0
    v_mul_f32 v13, v13, v30
    v_mul_f32 v13, 0xc0135761, v13
    v_exp_f32 v13, v13
    s_nop 0
    v_add_f32 v13, 1.0, v13
    v_rcp_f32 v13, v13
    s_nop 0
    v_mul_f32 v30, v30, v13
    v_cvt_pk_bf16_f32 v13, v31, v31
    v_lshlrev_b32 v31, 16, v13
    v_mul_f32 v13, v31, v31
    v_mov_b32 v14, 0x3d372713
    v_fma_f32 v13, v13, v14, 1.0
    v_mul_f32 v13, v13, v31
    v_mul_f32 v13, 0xc0135761, v13
    v_exp_f32 v13, v13
    s_nop 0
    v_add_f32 v13, 1.0, v13
    v_rcp_f32 v13, v13
    s_nop 0
    v_mul_f32 v31, v31, v13
    v_cvt_pk_bf16_f32 v14, v28, v29
    v_cvt_pk_bf16_f32 v15, v30, v31
    buffer_store_dwordx2 v[14:15], v63, s[12:15], 0 offen
L_w1_kernel_skip00:
L_end_w1_kernel:
    s_endpgm
.globl w2_kernel
.p2align 8
.type w2_kernel,@function
w2_kernel:
    s_load_dwordx16 s[64:79], s[0:1], 0
    s_load_dwordx4 s[80:83], s[0:1], 64
    s_load_dwordx2 s[84:85], s[0:1], 80
    v_lshrrev_b32 v1, 6, v0
    s_nop 1
    v_readfirstlane_b32 s20, v1
    s_lshl_b32 s3, s2, 2
    s_add_u32 s20, s20, s3
    s_cmp_ge_u32 s20, 1024
    s_cbranch_scc1 L_end_w2_kernel
    v_and_b32 v0, 63, v0
    s_and_b32 s21, s20, 63
    s_lshr_b32 s22, s20, 6
    s_waitcnt lgkmcnt(0)
    s_add_u32 s4, s84, 0x1600000
    s_addc_u32 s5, s85, 0
    s_mov_b32 s6, 0x200000
    s_mov_b32 s7, 0x00020000
    s_waitcnt lgkmcnt(0)
    s_add_u32 s8, s84, 0x280000
    s_addc_u32 s9, s85, 0
    s_mov_b32 s10, 0x80000
    s_mov_b32 s11, 0x00020000
    v_and_b32 v2, 31, v0
    v_lshrrev_b32 v3, 5, v0
    v_lshlrev_b32 v8, 4, v0
    s_mul_i32 s25, s21, 32768
    s_add_u32 s25, s25, 0
    v_add_u32 v232, s25, v8
    s_mul_i32 s25, s22, 32768
    s_add_u32 s25, s25, 0
    v_add_u32 v234, s25, v8
    v_lshlrev_b32 v9, 3, v3
    s_lshl_b32 s23, s21, 5
    v_add_u32 v4, s23, v2
    v_add_u32 v10, -1, v4
    v_lshrrev_b32 v11, 5, v10
    s_mov_b32 s36, 32
    v_mul_lo_u32 v11, v11, s36
    v_lshrrev_b32 v12, 4, v9
    v_add_u32 v11, v11, v12
    v_lshlrev_b32 v240, 10, v11
    v_and_b32 v11, 31, v10
    v_lshlrev_b32 v11, 4, v11
    v_add_u32 v240, v240, v11
    v_lshrrev_b32 v11, 3, v9
    v_and_b32 v11, 1, v11
    v_lshlrev_b32 v11, 9, v11
    v_add_u32 v240, v240, v11
    v_and_b32 v11, 7, v9
    v_lshlrev_b32 v11, 1, v11
    v_add_u32 v240, v240, v11
    v_cmp_gt_u32 vcc, 2048, v10
    v_mov_b32 v11, -1
    v_cndmask_b32 v240, v11, v240, vcc
    v_add_u32 v10, 1, v4
    v_lshrrev_b32 v11, 5, v10
    s_mov_b32 s36, 32
    v_mul_lo_u32 v11, v11, s36
    v_lshrrev_b32 v12, 4, v9
    v_add_u32 v11, v11, v12
    v_lshlrev_b32 v241, 10, v11
    v_and_b32 v11, 31, v10
    v_lshlrev_b32 v11, 4, v11
    v_add_u32 v241, v241, v11
    v_lshrrev_b32 v11, 3, v9
    v_and_b32 v11, 1, v11
    v_lshlrev_b32 v11, 9, v11
    v_add_u32 v241, v241, v11
    v_and_b32 v11, 7, v9
    v_lshlrev_b32 v11, 1, v11
    v_add_u32 v241, v241, v11
    v_cmp_gt_u32 vcc, 2048, v10
    v_mov_b32 v11, -1
    v_cndmask_b32 v241, v11, v241, vcc
    v_add_u32 v10, -2, v4
    v_lshrrev_b32 v11, 5, v10
    s_mov_b32 s36, 32
    v_mul_lo_u32 v11, v11, s36
    v_lshrrev_b32 v12, 4, v9
    v_add_u32 v11, v11, v12
    v_lshlrev_b32 v242, 10, v11
    v_and_b32 v11, 31, v10
    v_lshlrev_b32 v11, 4, v11
    v_add_u32 v242, v242, v11
    v_lshrrev_b32 v11, 3, v9
    v_and_b32 v11, 1, v11
    v_lshlrev_b32 v11, 9, v11
    v_add_u32 v242, v242, v11
    v_and_b32 v11, 7, v9
    v_lshlrev_b32 v11, 1, v11
    v_add_u32 v242, v242, v11
    v_cmp_gt_u32 vcc, 2048, v10
    v_mov_b32 v11, -1
    v_cndmask_b32 v242, v11, v242, vcc
    v_add_u32 v10, 2, v4
    v_lshrrev_b32 v11, 5, v10
    s_mov_b32 s36, 32
    v_mul_lo_u32 v11, v11, s36
    v_lshrrev_b32 v12, 4, v9
    v_add_u32 v11, v11, v12
    v_lshlrev_b32 v243, 10, v11
    v_and_b32 v11, 31, v10
    v_lshlrev_b32 v11, 4, v11
    v_add_u32 v243, v243, v11
    v_lshrrev_b32 v11, 3, v9
    v_and_b32 v11, 1, v11
    v_lshlrev_b32 v11, 9, v11
    v_add_u32 v243, v243, v11
    v_and_b32 v11, 7, v9
    v_lshlrev_b32 v11, 1, v11
    v_add_u32 v243, v243, v11
    v_cmp_gt_u32 vcc, 2048, v10
    v_mov_b32 v11, -1
    v_cndmask_b32 v243, v11, v243, vcc
    v_mov_b32 v160, 0
    v_mov_b32 v161, 0
    v_mov_b32 v162, 0
    v_mov_b32 v163, 0
    v_mov_b32 v164, 0
    v_mov_b32 v165, 0
    v_mov_b32 v166, 0
    v_mov_b32 v167, 0
    v_mov_b32 v168, 0
    v_mov_b32 v169, 0
    v_mov_b32 v170, 0
    v_mov_b32 v171, 0
    v_mov_b32 v172, 0
    v_mov_b32 v173, 0
    v_mov_b32 v174, 0
    v_mov_b32 v175, 0
    s_mov_b32 s27, 0
    buffer_load_dwordx4 v[32:35], v240, s[4:7], s27 offen
    buffer_load_dwordx4 v[96:99], v234, s[8:11], s27 offen
    s_mov_b32 s27, 1024
    buffer_load_dwordx4 v[40:43], v240, s[4:7], s27 offen
    buffer_load_dwordx4 v[104:107], v234, s[8:11], s27 offen
    s_mov_b32 s27, 2048
    buffer_load_dwordx4 v[48:51], v240, s[4:7], s27 offen
    buffer_load_dwordx4 v[112:115], v234, s[8:11], s27 offen
    s_mov_b32 s27, 3072
    buffer_load_dwordx4 v[56:59], v240, s[4:7], s27 offen
    buffer_load_dwordx4 v[120:123], v234, s[8:11], s27 offen
    s_mov_b32 s27, 4096
    buffer_load_dwordx4 v[64:67], v240, s[4:7], s27 offen
    buffer_load_dwordx4 v[128:131], v234, s[8:11], s27 offen
    s_mov_b32 s27, 5120
    buffer_load_dwordx4 v[72:75], v240, s[4:7], s27 offen
    buffer_load_dwordx4 v[136:139], v234, s[8:11], s27 offen
    s_mov_b32 s27, 6144
    buffer_load_dwordx4 v[80:83], v240, s[4:7], s27 offen
    buffer_load_dwordx4 v[144:147], v234, s[8:11], s27 offen
    s_mov_b32 s27, 7168
    buffer_load_dwordx4 v[88:91], v240, s[4:7], s27 offen
    buffer_load_dwordx4 v[152:155], v234, s[8:11], s27 offen
    s_waitcnt vmcnt(14)
    v_mfma_f32_32x32x16_bf16 v[160:175], v[96:99], v[32:35], v[160:175]
    s_mov_b32 s27, 8192
    buffer_load_dwordx4 v[32:35], v241, s[4:7], s27 offen
    buffer_load_dwordx4 v[96:99], v234, s[8:11], s27 offen
    s_waitcnt vmcnt(14)
    v_mfma_f32_32x32x16_bf16 v[160:175], v[104:107], v[40:43], v[160:175]
    s_mov_b32 s27, 9216
    buffer_load_dwordx4 v[40:43], v241, s[4:7], s27 offen
    buffer_load_dwordx4 v[104:107], v234, s[8:11], s27 offen
    s_waitcnt vmcnt(14)
    v_mfma_f32_32x32x16_bf16 v[160:175], v[112:115], v[48:51], v[160:175]
    s_mov_b32 s27, 10240
    buffer_load_dwordx4 v[48:51], v241, s[4:7], s27 offen
    buffer_load_dwordx4 v[112:115], v234, s[8:11], s27 offen
    s_waitcnt vmcnt(14)
    v_mfma_f32_32x32x16_bf16 v[160:175], v[120:123], v[56:59], v[160:175]
    s_mov_b32 s27, 11264
    buffer_load_dwordx4 v[56:59], v241, s[4:7], s27 offen
    buffer_load_dwordx4 v[120:123], v234, s[8:11], s27 offen
    s_waitcnt vmcnt(14)
    v_mfma_f32_32x32x16_bf16 v[160:175], v[128:131], v[64:67], v[160:175]
    s_mov_b32 s27, 12288
    buffer_load_dwordx4 v[64:67], v241, s[4:7], s27 offen
    buffer_load_dwordx4 v[128:131], v234, s[8:11], s27 offen
    s_waitcnt vmcnt(14)
    v_mfma_f32_32x32x16_bf16 v[160:175], v[136:139], v[72:75], v[160:175]
    s_mov_b32 s27, 13312
    buffer_load_dwordx4 v[72:75], v241, s[4:7], s27 offen
    buffer_load_dwordx4 v[136:139], v234, s[8:11], s27 offen
    s_waitcnt vmcnt(14)
    v_mfma_f32_32x32x16_bf16 v[160:175], v[144:147], v[80:83], v[160:175]
    s_mov_b32 s27, 14336
    buffer_load_dwordx4 v[80:83], v241, s[4:7], s27 offen
    buffer_load_dwordx4 v[144:147], v234, s[8:11], s27 offen
    s_waitcnt vmcnt(14)
    v_mfma_f32_32x32x16_bf16 v[160:175], v[152:155], v[88:91], v[160:175]
    s_mov_b32 s27, 15360
    buffer_load_dwordx4 v[88:91], v241, s[4:7], s27 offen
    buffer_load_dwordx4 v[152:155], v234, s[8:11], s27 offen
    s_waitcnt vmcnt(14)
    v_mfma_f32_32x32x16_bf16 v[160:175], v[96:99], v[32:35], v[160:175]
    s_mov_b32 s27, 16384
    buffer_load_dwordx4 v[32:35], v242, s[4:7], s27 offen
    buffer_load_dwordx4 v[96:99], v234, s[8:11], s27 offen
    s_waitcnt vmcnt(14)
    v_mfma_f32_32x32x16_bf16 v[160:175], v[104:107], v[40:43], v[160:175]
    s_mov_b32 s27, 17408
    buffer_load_dwordx4 v[40:43], v242, s[4:7], s27 offen
    buffer_load_dwordx4 v[104:107], v234, s[8:11], s27 offen
    s_waitcnt vmcnt(14)
    v_mfma_f32_32x32x16_bf16 v[160:175], v[112:115], v[48:51], v[160:175]
    s_mov_b32 s27, 18432
    buffer_load_dwordx4 v[48:51], v242, s[4:7], s27 offen
    buffer_load_dwordx4 v[112:115], v234, s[8:11], s27 offen
    s_waitcnt vmcnt(14)
    v_mfma_f32_32x32x16_bf16 v[160:175], v[120:123], v[56:59], v[160:175]
    s_mov_b32 s27, 19456
    buffer_load_dwordx4 v[56:59], v242, s[4:7], s27 offen
    buffer_load_dwordx4 v[120:123], v234, s[8:11], s27 offen
    s_waitcnt vmcnt(14)
    v_mfma_f32_32x32x16_bf16 v[160:175], v[128:131], v[64:67], v[160:175]
    s_mov_b32 s27, 20480
    buffer_load_dwordx4 v[64:67], v242, s[4:7], s27 offen
    buffer_load_dwordx4 v[128:131], v234, s[8:11], s27 offen
    s_waitcnt vmcnt(14)
    v_mfma_f32_32x32x16_bf16 v[160:175], v[136:139], v[72:75], v[160:175]
    s_mov_b32 s27, 21504
    buffer_load_dwordx4 v[72:75], v242, s[4:7], s27 offen
    buffer_load_dwordx4 v[136:139], v234, s[8:11], s27 offen
    s_waitcnt vmcnt(14)
    v_mfma_f32_32x32x16_bf16 v[160:175], v[144:147], v[80:83], v[160:175]
    s_mov_b32 s27, 22528
    buffer_load_dwordx4 v[80:83], v242, s[4:7], s27 offen
    buffer_load_dwordx4 v[144:147], v234, s[8:11], s27 offen
    s_waitcnt vmcnt(14)
    v_mfma_f32_32x32x16_bf16 v[160:175], v[152:155], v[88:91], v[160:175]
    s_mov_b32 s27, 23552
    buffer_load_dwordx4 v[88:91], v242, s[4:7], s27 offen
    buffer_load_dwordx4 v[152:155], v234, s[8:11], s27 offen
    s_waitcnt vmcnt(14)
    v_mfma_f32_32x32x16_bf16 v[160:175], v[96:99], v[32:35], v[160:175]
    s_mov_b32 s27, 24576
    buffer_load_dwordx4 v[32:35], v243, s[4:7], s27 offen
    buffer_load_dwordx4 v[96:99], v234, s[8:11], s27 offen
    s_waitcnt vmcnt(14)
    v_mfma_f32_32x32x16_bf16 v[160:175], v[104:107], v[40:43], v[160:175]
    s_mov_b32 s27, 25600
    buffer_load_dwordx4 v[40:43], v243, s[4:7], s27 offen
    buffer_load_dwordx4 v[104:107], v234, s[8:11], s27 offen
    s_waitcnt vmcnt(14)
    v_mfma_f32_32x32x16_bf16 v[160:175], v[112:115], v[48:51], v[160:175]
    s_mov_b32 s27, 26624
    buffer_load_dwordx4 v[48:51], v243, s[4:7], s27 offen
    buffer_load_dwordx4 v[112:115], v234, s[8:11], s27 offen
    s_waitcnt vmcnt(14)
    v_mfma_f32_32x32x16_bf16 v[160:175], v[120:123], v[56:59], v[160:175]
    s_mov_b32 s27, 27648
    buffer_load_dwordx4 v[56:59], v243, s[4:7], s27 offen
    buffer_load_dwordx4 v[120:123], v234, s[8:11], s27 offen
    s_waitcnt vmcnt(14)
    v_mfma_f32_32x32x16_bf16 v[160:175], v[128:131], v[64:67], v[160:175]
    s_mov_b32 s27, 28672
    buffer_load_dwordx4 v[64:67], v243, s[4:7], s27 offen
    buffer_load_dwordx4 v[128:131], v234, s[8:11], s27 offen
    s_waitcnt vmcnt(14)
    v_mfma_f32_32x32x16_bf16 v[160:175], v[136:139], v[72:75], v[160:175]
    s_mov_b32 s27, 29696
    buffer_load_dwordx4 v[72:75], v243, s[4:7], s27 offen
    buffer_load_dwordx4 v[136:139], v234, s[8:11], s27 offen
    s_waitcnt vmcnt(14)
    v_mfma_f32_32x32x16_bf16 v[160:175], v[144:147], v[80:83], v[160:175]
    s_mov_b32 s27, 30720
    buffer_load_dwordx4 v[80:83], v243, s[4:7], s27 offen
    buffer_load_dwordx4 v[144:147], v234, s[8:11], s27 offen
    s_waitcnt vmcnt(14)
    v_mfma_f32_32x32x16_bf16 v[160:175], v[152:155], v[88:91], v[160:175]
    s_mov_b32 s27, 31744
    buffer_load_dwordx4 v[88:91], v243, s[4:7], s27 offen
    buffer_load_dwordx4 v[152:155], v234, s[8:11], s27 offen
    s_waitcnt vmcnt(14)
    v_mfma_f32_32x32x16_bf16 v[160:175], v[96:99], v[32:35], v[160:175]
    s_waitcnt vmcnt(12)
    v_mfma_f32_32x32x16_bf16 v[160:175], v[104:107], v[40:43], v[160:175]
    s_waitcnt vmcnt(10)
    v_mfma_f32_32x32x16_bf16 v[160:175], v[112:115], v[48:51], v[160:175]
    s_waitcnt vmcnt(8)
    v_mfma_f32_32x32x16_bf16 v[160:175], v[120:123], v[56:59], v[160:175]
    s_waitcnt vmcnt(6)
    v_mfma_f32_32x32x16_bf16 v[160:175], v[128:131], v[64:67], v[160:175]
    s_waitcnt vmcnt(4)
    v_mfma_f32_32x32x16_bf16 v[160:175], v[136:139], v[72:75], v[160:175]
    s_waitcnt vmcnt(2)
    v_mfma_f32_32x32x16_bf16 v[160:175], v[144:147], v[80:83], v[160:175]
    s_waitcnt vmcnt(0)
    v_mfma_f32_32x32x16_bf16 v[160:175], v[152:155], v[88:91], v[160:175]
    s_nop 7
    s_nop 7
    s_lshl_b32 s23, s21, 5
    s_add_u32 s23, s23, 0
    s_lshl_b32 s24, s22, 5
    s_add_u32 s24, s24, 0
    s_cmp_ge_u32 s24, 512
    s_cbranch_scc1 L_w2_kernel_skip00
    v_add_u32 v4, s23, v2
    v_mov_b32 v16, v160
    v_mov_b32 v17, v161
    v_mov_b32 v18, v162
    v_mov_b32 v19, v163
    v_mov_b32 v20, v164
    v_mov_b32 v21, v165
    v_mov_b32 v22, v166
    v_mov_b32 v23, v167
    v_mov_b32 v24, v168
    v_mov_b32 v25, v169
    v_mov_b32 v26, v170
    v_mov_b32 v27, v171
    v_mov_b32 v28, v172
    v_mov_b32 v29, v173
    v_mov_b32 v30, v174
    v_mov_b32 v31, v175
    v_lshlrev_b32 v9, 2, v3
    v_add_u32 v9, s24, v9
    s_waitcnt lgkmcnt(0)
    s_add_u32 s12, s84, 0x1800000
    s_addc_u32 s13, s85, 0
    s_mov_b32 s14, 0x200000
    s_mov_b32 s15, 0x00020000
    s_waitcnt lgkmcnt(0)
    s_add_u32 s28, s84, 0x1200000
    s_addc_u32 s29, s85, 0
    s_mov_b32 s30, 0x200000
    s_mov_b32 s31, 0x00020000
    s_mov_b32 s25, 1024
    v_mul_lo_u32 v10, v4, s25
    v_lshlrev_b32 v11, 1, v9
    v_add_u32 v10, v10, v11
    v_add_u32 v11, 0, v9
    v_lshrrev_b32 v12, 5, v4
    s_mov_b32 s36, 32
    v_mul_lo_u32 v12, v12, s36
    v_lshrrev_b32 v13, 4, v11
    v_add_u32 v12, v12, v13
    v_lshlrev_b32 v60, 10, v12
    v_and_b32 v12, 31, v4
    v_lshlrev_b32 v12, 4, v12
    v_add_u32 v60, v60, v12
    v_lshrrev_b32 v12, 3, v11
    v_and_b32 v12, 1, v12
    v_lshlrev_b32 v12, 9, v12
    v_add_u32 v60, v60, v12
    v_and_b32 v12, 7, v11
    v_lshlrev_b32 v12, 1, v12
    v_add_u32 v60, v60, v12
    v_add_u32 v64, 0, v10
    v_add_u32 v11, 8, v9
    v_lshrrev_b32 v12, 5, v4
    s_mov_b32 s36, 32
    v_mul_lo_u32 v12, v12, s36
    v_lshrrev_b32 v13, 4, v11
    v_add_u32 v12, v12, v13
    v_lshlrev_b32 v61, 10, v12
    v_and_b32 v12, 31, v4
    v_lshlrev_b32 v12, 4, v12
    v_add_u32 v61, v61, v12
    v_lshrrev_b32 v12, 3, v11
    v_and_b32 v12, 1, v12
    v_lshlrev_b32 v12, 9, v12
    v_add_u32 v61, v61, v12
    v_and_b32 v12, 7, v11
    v_lshlrev_b32 v12, 1, v12
    v_add_u32 v61, v61, v12
    v_add_u32 v65, 16, v10
    v_add_u32 v11, 16, v9
    v_lshrrev_b32 v12, 5, v4
    s_mov_b32 s36, 32
    v_mul_lo_u32 v12, v12, s36
    v_lshrrev_b32 v13, 4, v11
    v_add_u32 v12, v12, v13
    v_lshlrev_b32 v62, 10, v12
    v_and_b32 v12, 31, v4
    v_lshlrev_b32 v12, 4, v12
    v_add_u32 v62, v62, v12
    v_lshrrev_b32 v12, 3, v11
    v_and_b32 v12, 1, v12
    v_lshlrev_b32 v12, 9, v12
    v_add_u32 v62, v62, v12
    v_and_b32 v12, 7, v11
    v_lshlrev_b32 v12, 1, v12
    v_add_u32 v62, v62, v12
    v_add_u32 v66, 32, v10
    v_add_u32 v11, 24, v9
    v_lshrrev_b32 v12, 5, v4
    s_mov_b32 s36, 32
    v_mul_lo_u32 v12, v12, s36
    v_lshrrev_b32 v13, 4, v11
    v_add_u32 v12, v12, v13
    v_lshlrev_b32 v63, 10, v12
    v_and_b32 v12, 31, v4
    v_lshlrev_b32 v12, 4, v12
    v_add_u32 v63, v63, v12
    v_lshrrev_b32 v12, 3, v11
    v_and_b32 v12, 1, v12
    v_lshlrev_b32 v12, 9, v12
    v_add_u32 v63, v63, v12
    v_and_b32 v12, 7, v11
    v_lshlrev_b32 v12, 1, v12
    v_add_u32 v63, v63, v12
    v_add_u32 v67, 48, v10
    buffer_load_dwordx2 v[40:41], v60, s[28:31], 0 offen
    buffer_load_dwordx2 v[42:43], v61, s[28:31], 0 offen
    buffer_load_dwordx2 v[44:45], v62, s[28:31], 0 offen
    buffer_load_dwordx2 v[46:47], v63, s[28:31], 0 offen
    s_waitcnt vmcnt(0)
    v_cvt_pk_bf16_f32 v13, v16, v16
    v_lshlrev_b32 v16, 16, v13
    v_lshlrev_b32 v13, 16, v40
    v_add_f32 v16, v16, v13
    v_cvt_pk_bf16_f32 v13, v17, v17
    v_lshlrev_b32 v17, 16, v13
    v_and_b32 v13, 0xffff0000, v40
    v_add_f32 v17, v17, v13
    v_cvt_pk_bf16_f32 v13, v18, v18
    v_lshlrev_b32 v18, 16, v13
    v_lshlrev_b32 v13, 16, v41
    v_add_f32 v18, v18, v13
    v_cvt_pk_bf16_f32 v13, v19, v19
    v_lshlrev_b32 v19, 16, v13
    v_and_b32 v13, 0xffff0000, v41
    v_add_f32 v19, v19, v13
    v_cvt_pk_bf16_f32 v14, v16, v17
    v_cvt_pk_bf16_f32 v15, v18, v19
    buffer_store_dwordx2 v[14:15], v60, s[12:15], 0 offen
    v_cvt_pk_bf16_f32 v13, v20, v20
    v_lshlrev_b32 v20, 16, v13
    v_lshlrev_b32 v13, 16, v42
    v_add_f32 v20, v20, v13
    v_cvt_pk_bf16_f32 v13, v21, v21
    v_lshlrev_b32 v21, 16, v13
    v_and_b32 v13, 0xffff0000, v42
    v_add_f32 v21, v21, v13
    v_cvt_pk_bf16_f32 v13, v22, v22
    v_lshlrev_b32 v22, 16, v13
    v_lshlrev_b32 v13, 16, v43
    v_add_f32 v22, v22, v13
    v_cvt_pk_bf16_f32 v13, v23, v23
    v_lshlrev_b32 v23, 16, v13
    v_and_b32 v13, 0xffff0000, v43
    v_add_f32 v23, v23, v13
    v_cvt_pk_bf16_f32 v14, v20, v21
    v_cvt_pk_bf16_f32 v15, v22, v23
    buffer_store_dwordx2 v[14:15], v61, s[12:15], 0 offen
    v_cvt_pk_bf16_f32 v13, v24, v24
    v_lshlrev_b32 v24, 16, v13
    v_lshlrev_b32 v13, 16, v44
    v_add_f32 v24, v24, v13
    v_cvt_pk_bf16_f32 v13, v25, v25
    v_lshlrev_b32 v25, 16, v13
    v_and_b32 v13, 0xffff0000, v44
    v_add_f32 v25, v25, v13
    v_cvt_pk_bf16_f32 v13, v26, v26
    v_lshlrev_b32 v26, 16, v13
    v_lshlrev_b32 v13, 16, v45
    v_add_f32 v26, v26, v13
    v_cvt_pk_bf16_f32 v13, v27, v27
    v_lshlrev_b32 v27, 16, v13
    v_and_b32 v13, 0xffff0000, v45
    v_add_f32 v27, v27, v13
    v_cvt_pk_bf16_f32 v14, v24, v25
    v_cvt_pk_bf16_f32 v15, v26, v27
    buffer_store_dwordx2 v[14:15], v62, s[12:15], 0 offen
    v_cvt_pk_bf16_f32 v13, v28, v28
    v_lshlrev_b32 v28, 16, v13
    v_lshlrev_b32 v13, 16, v46
    v_add_f32 v28, v28, v13
    v_cvt_pk_bf16_f32 v13, v29, v29
    v_lshlrev_b32 v29, 16, v13
    v_and_b32 v13, 0xffff0000, v46
    v_add_f32 v29, v29, v13
    v_cvt_pk_bf16_f32 v13, v30, v30
    v_lshlrev_b32 v30, 16, v13
    v_lshlrev_b32 v13, 16, v47
    v_add_f32 v30, v30, v13
    v_cvt_pk_bf16_f32 v13, v31, v31
    v_lshlrev_b32 v31, 16, v13
    v_and_b32 v13, 0xffff0000, v47
    v_add_f32 v31, v31, v13
    v_cvt_pk_bf16_f32 v14, v28, v29
    v_cvt_pk_bf16_f32 v15, v30, v31
    buffer_store_dwordx2 v[14:15], v63, s[12:15], 0 offen
L_w2_kernel_skip00:
L_end_w2_kernel:
    s_endpgm
.globl ln3_kernel
.p2align 8
.type ln3_kernel,@function
ln3_kernel:
    s_load_dwordx16 s[64:79], s[0:1], 0
    s_load_dwordx4 s[80:83], s[0:1], 64
    s_load_dwordx2 s[84:85], s[0:1], 80
    v_lshrrev_b32 v1, 6, v0
    s_nop 1
    v_readfirstlane_b32 s20, v1
    s_lshl_b32 s3, s2, 2
    s_add_u32 s20, s20, s3
    s_cmp_ge_u32 s20, 2048
    s_cbranch_scc1 L_end_ln3_kernel
    v_and_b32 v0, 63, v0
    s_waitcnt lgkmcnt(0)
    s_add_u32 s4, s84, 0x1800000
    s_addc_u32 s5, s85, 0
    s_mov_b32 s6, 0x200000
    s_mov_b32 s7, 0x00020000
    s_waitcnt lgkmcnt(0)
    s_add_u32 s8, s84, 0x1400000
    s_addc_u32 s9, s85, 0
    s_mov_b32 s10, 0x200000
    s_mov_b32 s11, 0x00020000
    v_mov_b32 v5, s20
    v_lshlrev_b32 v6, 3, v0
    v_lshrrev_b32 v7, 5, v5
    s_mov_b32 s36, 32
    v_mul_lo_u32 v7, v7, s36
    v_lshrrev_b32 v8, 4, v6
    v_add_u32 v7, v7, v8
    v_lshlrev_b32 v2, 10, v7
    v_and_b32 v7, 31, v5
    v_lshlrev_b32 v7, 4, v7
    v_add_u32 v2, v2, v7
    v_lshrrev_b32 v7, 3, v6
    v_and_b32 v7, 1, v7
    v_lshlrev_b32 v7, 9, v7
    v_add_u32 v2, v2, v7
    v_and_b32 v7, 7, v6
    v_lshlrev_b32 v7, 1, v7
    v_add_u32 v2, v2, v7
    buffer_load_dwordx4 v[10:13], v2, s[4:7], 0 offen
    s_waitcnt vmcnt(0)
    v_lshlrev_b32 v30, 16, v10
    v_and_b32 v31, 0xffff0000, v10
    v_lshlrev_b32 v32, 16, v11
    v_and_b32 v33, 0xffff0000, v11
    v_lshlrev_b32 v34, 16, v12
    v_and_b32 v35, 0xffff0000, v12
    v_lshlrev_b32 v36, 16, v13
    v_and_b32 v37, 0xffff0000, v13
    v_add_f32 v40, v30, v31
    v_add_f32 v40, v40, v32
    v_add_f32 v40, v40, v33
    v_add_f32 v40, v40, v34
    v_add_f32 v40, v40, v35
    v_add_f32 v40, v40, v36
    v_add_f32 v40, v40, v37
    v_xor_b32 v42, 32, v0
    v_lshlrev_b32 v42, 2, v42
    ds_bpermute_b32 v41, v42, v40
    s_waitcnt lgkmcnt(0)
    v_add_f32 v40, v40, v41
    v_xor_b32 v42, 16, v0
    v_lshlrev_b32 v42, 2, v42
    ds_bpermute_b32 v41, v42, v40
    s_waitcnt lgkmcnt(0)
    v_add_f32 v40, v40, v41
    v_xor_b32 v42, 8, v0
    v_lshlrev_b32 v42, 2, v42
    ds_bpermute_b32 v41, v42, v40
    s_waitcnt lgkmcnt(0)
    v_add_f32 v40, v40, v41
    v_xor_b32 v42, 4, v0
    v_lshlrev_b32 v42, 2, v42
    ds_bpermute_b32 v41, v42, v40
    s_waitcnt lgkmcnt(0)
    v_add_f32 v40, v40, v41
    v_xor_b32 v42, 2, v0
    v_lshlrev_b32 v42, 2, v42
    ds_bpermute_b32 v41, v42, v40
    s_waitcnt lgkmcnt(0)
    v_add_f32 v40, v40, v41
    v_xor_b32 v42, 1, v0
    v_lshlrev_b32 v42, 2, v42
    ds_bpermute_b32 v41, v42, v40
    s_waitcnt lgkmcnt(0)
    v_add_f32 v40, v40, v41
    v_mul_f32 v40, 0x3b000000, v40
    v_sub_f32 v30, v30, v40
    v_sub_f32 v31, v31, v40
    v_sub_f32 v32, v32, v40
    v_sub_f32 v33, v33, v40
    v_sub_f32 v34, v34, v40
    v_sub_f32 v35, v35, v40
    v_sub_f32 v36, v36, v40
    v_sub_f32 v37, v37, v40
    v_mul_f32 v43, v30, v30
    v_fma_f32 v43, v31, v31, v43
    v_fma_f32 v43, v32, v32, v43
    v_fma_f32 v43, v33, v33, v43
    v_fma_f32 v43, v34, v34, v43
    v_fma_f32 v43, v35, v35, v43
    v_fma_f32 v43, v36, v36, v43
    v_fma_f32 v43, v37, v37, v43
    v_xor_b32 v42, 32, v0
    v_lshlrev_b32 v42, 2, v42
    ds_bpermute_b32 v41, v42, v43
    s_waitcnt lgkmcnt(0)
    v_add_f32 v43, v43, v41
    v_xor_b32 v42, 16, v0
    v_lshlrev_b32 v42, 2, v42
    ds_bpermute_b32 v41, v42, v43
    s_waitcnt lgkmcnt(0)
    v_add_f32 v43, v43, v41
    v_xor_b32 v42, 8, v0
    v_lshlrev_b32 v42, 2, v42
    ds_bpermute_b32 v41, v42, v43
    s_waitcnt lgkmcnt(0)
    v_add_f32 v43, v43, v41
    v_xor_b32 v42, 4, v0
    v_lshlrev_b32 v42, 2, v42
    ds_bpermute_b32 v41, v42, v43
    s_waitcnt lgkmcnt(0)
    v_add_f32 v43, v43, v41
    v_xor_b32 v42, 2, v0
    v_lshlrev_b32 v42, 2, v42
    ds_bpermute_b32 v41, v42, v43
    s_waitcnt lgkmcnt(0)
    v_add_f32 v43, v43, v41
    v_xor_b32 v42, 1, v0
    v_lshlrev_b32 v42, 2, v42
    ds_bpermute_b32 v41, v42, v43
    s_waitcnt lgkmcnt(0)
    v_add_f32 v43, v43, v41
    v_mov_b32 v44, 0x3727c5ac
    v_mul_f32 v43, 0x3b000000, v43
    v_add_f32 v43, v43, v44
    v_rsq_f32 v43, v43
    s_nop 1
    v_mul_f32 v30, v30, v43
    v_mul_f32 v31, v31, v43
    v_mul_f32 v32, v32, v43
    v_mul_f32 v33, v33, v43
    v_mul_f32 v34, v34, v43
    v_mul_f32 v35, v35, v43
    v_mul_f32 v36, v36, v43
    v_mul_f32 v37, v37, v43
    v_cvt_pk_bf16_f32 v20, v30, v31
    v_cvt_pk_bf16_f32 v21, v32, v33
    v_cvt_pk_bf16_f32 v22, v34, v35
    v_cvt_pk_bf16_f32 v23, v36, v37
    buffer_store_dwordx4 v[20:23], v2, s[8:11], 0 offen
L_end_ln3_kernel:
    s_endpgm
.globl w3_kernel
.p2align 8
.type w3_kernel,@function
w3_kernel:
    s_load_dwordx16 s[64:79], s[0:1], 0
    s_load_dwordx4 s[80:83], s[0:1], 64
    s_load_dwordx2 s[84:85], s[0:1], 80
    v_lshrrev_b32 v1, 6, v0
    s_nop 1
    v_readfirstlane_b32 s20, v1
    s_lshl_b32 s3, s2, 2
    s_add_u32 s20, s20, s3
    s_cmp_ge_u32 s20, 704
    s_cbranch_scc1 L_end_w3_kernel
    v_and_b32 v0, 63, v0
    s_and_b32 s21, s20, 31
    s_lshr_b32 s22, s20, 5
    s_waitcnt lgkmcnt(0)
    s_add_u32 s4, s84, 0x1400000
    s_addc_u32 s5, s85, 0
    s_mov_b32 s6, 0x200000
    s_mov_b32 s7, 0x00020000
    s_waitcnt lgkmcnt(0)
    s_add_u32 s8, s84, 0x300000
    s_addc_u32 s9, s85, 0
    s_mov_b32 s10, 0x158000
    s_mov_b32 s11, 0x00020000
    v_and_b32 v2, 31, v0
    v_lshrrev_b32 v3, 5, v0
    v_lshlrev_b32 v8, 4, v0
    s_mul_i32 s25, s21, 65536
    s_add_u32 s25, s25, 0
    v_add_u32 v232, s25, v8
    s_mul_i32 s25, s21, 65536
    s_add_u32 s25, s25, 32768
    v_add_u32 v233, s25, v8
    s_mul_i32 s25, s22, 65536
    s_add_u32 s25, s25, 0
    v_add_u32 v234, s25, v8
    s_mul_i32 s25, s22, 65536
    s_add_u32 s25, s25, 32768
    v_add_u32 v235, s25, v8
    v_mov_b32 v160, 0
    v_mov_b32 v161, 0
    v_mov_b32 v162, 0
    v_mov_b32 v163, 0
    v_mov_b32 v164, 0
    v_mov_b32 v165, 0
    v_mov_b32 v166, 0
    v_mov_b32 v167, 0
    v_mov_b32 v168, 0
    v_mov_b32 v169, 0
    v_mov_b32 v170, 0
    v_mov_b32 v171, 0
    v_mov_b32 v172, 0
    v_mov_b32 v173, 0
    v_mov_b32 v174, 0
    v_mov_b32 v175, 0
    v_mov_b32 v176, 0
    v_mov_b32 v177, 0
    v_mov_b32 v178, 0
    v_mov_b32 v179, 0
    v_mov_b32 v180, 0
    v_mov_b32 v181, 0
    v_mov_b32 v182, 0
    v_mov_b32 v183, 0
    v_mov_b32 v184, 0
    v_mov_b32 v185, 0
    v_mov_b32 v186, 0
    v_mov_b32 v187, 0
    v_mov_b32 v188, 0
    v_mov_b32 v189, 0
    v_mov_b32 v190, 0
    v_mov_b32 v191, 0
    v_mov_b32 v192, 0
    v_mov_b32 v193, 0
    v_mov_b32 v194, 0
    v_mov_b32 v195, 0
    v_mov_b32 v196, 0
    v_mov_b32 v197, 0
    v_mov_b32 v198, 0
    v_mov_b32 v199, 0
    v_mov_b32 v200, 0
    v_mov_b32 v201, 0
    v_mov_b32 v202, 0
    v_mov_b32 v203, 0
    v_mov_b32 v204, 0
    v_mov_b32 v205, 0
    v_mov_b32 v206, 0
    v_mov_b32 v207, 0
    v_mov_b32 v208, 0
    v_mov_b32 v209, 0
    v_mov_b32 v210, 0
    v_mov_b32 v211, 0
    v_mov_b32 v212, 0
    v_mov_b32 v213, 0
    v_mov_b32 v214, 0
    v_mov_b32 v215, 0
    v_mov_b32 v216, 0
    v_mov_b32 v217, 0
    v_mov_b32 v218, 0
    v_mov_b32 v219, 0
    v_mov_b32 v220, 0
    v_mov_b32 v221, 0
    v_mov_b32 v222, 0
    v_mov_b32 v223, 0
    s_mov_b32 s27, 0
    buffer_load_dwordx4 v[32:35], v232, s[4:7], s27 offen
    buffer_load_dwordx4 v[36:39], v233, s[4:7], s27 offen
    buffer_load_dwordx4 v[96:99], v234, s[8:11], s27 offen
    buffer_load_dwordx4 v[100:103], v235, s[8:11], s27 offen
    s_mov_b32 s27, 1024
    buffer_load_dwordx4 v[40:43], v232, s[4:7], s27 offen
    buffer_load_dwordx4 v[44:47], v233, s[4:7], s27 offen
    buffer_load_dwordx4 v[104:107], v234, s[8:11], s27 offen
    buffer_load_dwordx4 v[108:111], v235, s[8:11], s27 offen
    s_mov_b32 s27, 2048
    buffer_load_dwordx4 v[48:51], v232, s[4:7], s27 offen
    buffer_load_dwordx4 v[52:55], v233, s[4:7], s27 offen
    buffer_load_dwordx4 v[112:115], v234, s[8:11], s27 offen
    buffer_load_dwordx4 v[116:119], v235, s[8:11], s27 offen
    s_mov_b32 s27, 3072
    buffer_load_dwordx4 v[56:59], v232, s[4:7], s27 offen
    buffer_load_dwordx4 v[60:63], v233, s[4:7], s27 offen
    buffer_load_dwordx4 v[120:123], v234, s[8:11], s27 offen
    buffer_load_dwordx4 v[124:127], v235, s[8:11], s27 offen
    s_mov_b32 s27, 4096
    buffer_load_dwordx4 v[64:67], v232, s[4:7], s27 offen
    buffer_load_dwordx4 v[68:71], v233, s[4:7], s27 offen
    buffer_load_dwordx4 v[128:131], v234, s[8:11], s27 offen
    buffer_load_dwordx4 v[132:135], v235, s[8:11], s27 offen
    s_mov_b32 s27, 5120
    buffer_load_dwordx4 v[72:75], v232, s[4:7], s27 offen
    buffer_load_dwordx4 v[76:79], v233, s[4:7], s27 offen
    buffer_load_dwordx4 v[136:139], v234, s[8:11], s27 offen
    buffer_load_dwordx4 v[140:143], v235, s[8:11], s27 offen
    s_mov_b32 s27, 6144
    buffer_load_dwordx4 v[80:83], v232, s[4:7], s27 offen
    buffer_load_dwordx4 v[84:87], v233, s[4:7], s27 offen
    buffer_load_dwordx4 v[144:147], v234, s[8:11], s27 offen
    buffer_load_dwordx4 v[148:151], v235, s[8:11], s27 offen
    s_mov_b32 s27, 7168
    buffer_load_dwordx4 v[88:91], v232, s[4:7], s27 offen
    buffer_load_dwordx4 v[92:95], v233, s[4:7], s27 offen
    buffer_load_dwordx4 v[152:155], v234, s[8:11], s27 offen
    buffer_load_dwordx4 v[156:159], v235, s[8:11], s27 offen
    s_waitcnt vmcnt(28)
    v_mfma_f32_32x32x16_bf16 v[160:175], v[96:99], v[32:35], v[160:175]
    v_mfma_f32_32x32x16_bf16 v[176:191], v[100:103], v[32:35], v[176:191]
    v_mfma_f32_32x32x16_bf16 v[192:207], v[96:99], v[36:39], v[192:207]
    v_mfma_f32_32x32x16_bf16 v[208:223], v[100:103], v[36:39], v[208:223]
    s_mov_b32 s27, 8192
    buffer_load_dwordx4 v[32:35], v232, s[4:7], s27 offen
    buffer_load_dwordx4 v[36:39], v233, s[4:7], s27 offen
    buffer_load_dwordx4 v[96:99], v234, s[8:11], s27 offen
    buffer_load_dwordx4 v[100:103], v235, s[8:11], s27 offen
    s_waitcnt vmcnt(28)
    v_mfma_f32_32x32x16_bf16 v[160:175], v[104:107], v[40:43], v[160:175]
    v_mfma_f32_32x32x16_bf16 v[176:191], v[108:111], v[40:43], v[176:191]
    v_mfma_f32_32x32x16_bf16 v[192:207], v[104:107], v[44:47], v[192:207]
    v_mfma_f32_32x32x16_bf16 v[208:223], v[108:111], v[44:47], v[208:223]
    s_mov_b32 s27, 9216
    buffer_load_dwordx4 v[40:43], v232, s[4:7], s27 offen
    buffer_load_dwordx4 v[44:47], v233, s[4:7], s27 offen
    buffer_load_dwordx4 v[104:107], v234, s[8:11], s27 offen
    buffer_load_dwordx4 v[108:111], v235, s[8:11], s27 offen
    s_waitcnt vmcnt(28)
    v_mfma_f32_32x32x16_bf16 v[160:175], v[112:115], v[48:51], v[160:175]
    v_mfma_f32_32x32x16_bf16 v[176:191], v[116:119], v[48:51], v[176:191]
    v_mfma_f32_32x32x16_bf16 v[192:207], v[112:115], v[52:55], v[192:207]
    v_mfma_f32_32x32x16_bf16 v[208:223], v[116:119], v[52:55], v[208:223]
    s_mov_b32 s27, 10240
    buffer_load_dwordx4 v[48:51], v232, s[4:7], s27 offen
    buffer_load_dwordx4 v[52:55], v233, s[4:7], s27 offen
    buffer_load_dwordx4 v[112:115], v234, s[8:11], s27 offen
    buffer_load_dwordx4 v[116:119], v235, s[8:11], s27 offen
    s_waitcnt vmcnt(28)
    v_mfma_f32_32x32x16_bf16 v[160:175], v[120:123], v[56:59], v[160:175]
    v_mfma_f32_32x32x16_bf16 v[176:191], v[124:127], v[56:59], v[176:191]
    v_mfma_f32_32x32x16_bf16 v[192:207], v[120:123], v[60:63], v[192:207]
    v_mfma_f32_32x32x16_bf16 v[208:223], v[124:127], v[60:63], v[208:223]
    s_mov_b32 s27, 11264
    buffer_load_dwordx4 v[56:59], v232, s[4:7], s27 offen
    buffer_load_dwordx4 v[60:63], v233, s[4:7], s27 offen
    buffer_load_dwordx4 v[120:123], v234, s[8:11], s27 offen
    buffer_load_dwordx4 v[124:127], v235, s[8:11], s27 offen
    s_waitcnt vmcnt(28)
    v_mfma_f32_32x32x16_bf16 v[160:175], v[128:131], v[64:67], v[160:175]
    v_mfma_f32_32x32x16_bf16 v[176:191], v[132:135], v[64:67], v[176:191]
    v_mfma_f32_32x32x16_bf16 v[192:207], v[128:131], v[68:71], v[192:207]
    v_mfma_f32_32x32x16_bf16 v[208:223], v[132:135], v[68:71], v[208:223]
    s_mov_b32 s27, 12288
    buffer_load_dwordx4 v[64:67], v232, s[4:7], s27 offen
    buffer_load_dwordx4 v[68:71], v233, s[4:7], s27 offen
    buffer_load_dwordx4 v[128:131], v234, s[8:11], s27 offen
    buffer_load_dwordx4 v[132:135], v235, s[8:11], s27 offen
    s_waitcnt vmcnt(28)
    v_mfma_f32_32x32x16_bf16 v[160:175], v[136:139], v[72:75], v[160:175]
    v_mfma_f32_32x32x16_bf16 v[176:191], v[140:143], v[72:75], v[176:191]
    v_mfma_f32_32x32x16_bf16 v[192:207], v[136:139], v[76:79], v[192:207]
    v_mfma_f32_32x32x16_bf16 v[208:223], v[140:143], v[76:79], v[208:223]
    s_mov_b32 s27, 13312
    buffer_load_dwordx4 v[72:75], v232, s[4:7], s27 offen
    buffer_load_dwordx4 v[76:79], v233, s[4:7], s27 offen
    buffer_load_dwordx4 v[136:139], v234, s[8:11], s27 offen
    buffer_load_dwordx4 v[140:143], v235, s[8:11], s27 offen
    s_waitcnt vmcnt(28)
    v_mfma_f32_32x32x16_bf16 v[160:175], v[144:147], v[80:83], v[160:175]
    v_mfma_f32_32x32x16_bf16 v[176:191], v[148:151], v[80:83], v[176:191]
    v_mfma_f32_32x32x16_bf16 v[192:207], v[144:147], v[84:87], v[192:207]
    v_mfma_f32_32x32x16_bf16 v[208:223], v[148:151], v[84:87], v[208:223]
    s_mov_b32 s27, 14336
    buffer_load_dwordx4 v[80:83], v232, s[4:7], s27 offen
    buffer_load_dwordx4 v[84:87], v233, s[4:7], s27 offen
    buffer_load_dwordx4 v[144:147], v234, s[8:11], s27 offen
    buffer_load_dwordx4 v[148:151], v235, s[8:11], s27 offen
    s_waitcnt vmcnt(28)
    v_mfma_f32_32x32x16_bf16 v[160:175], v[152:155], v[88:91], v[160:175]
    v_mfma_f32_32x32x16_bf16 v[176:191], v[156:159], v[88:91], v[176:191]
    v_mfma_f32_32x32x16_bf16 v[192:207], v[152:155], v[92:95], v[192:207]
    v_mfma_f32_32x32x16_bf16 v[208:223], v[156:159], v[92:95], v[208:223]
    s_mov_b32 s27, 15360
    buffer_load_dwordx4 v[88:91], v232, s[4:7], s27 offen
    buffer_load_dwordx4 v[92:95], v233, s[4:7], s27 offen
    buffer_load_dwordx4 v[152:155], v234, s[8:11], s27 offen
    buffer_load_dwordx4 v[156:159], v235, s[8:11], s27 offen
    s_waitcnt vmcnt(28)
    v_mfma_f32_32x32x16_bf16 v[160:175], v[96:99], v[32:35], v[160:175]
    v_mfma_f32_32x32x16_bf16 v[176:191], v[100:103], v[32:35], v[176:191]
    v_mfma_f32_32x32x16_bf16 v[192:207], v[96:99], v[36:39], v[192:207]
    v_mfma_f32_32x32x16_bf16 v[208:223], v[100:103], v[36:39], v[208:223]
    s_mov_b32 s27, 16384
    buffer_load_dwordx4 v[32:35], v232, s[4:7], s27 offen
    buffer_load_dwordx4 v[36:39], v233, s[4:7], s27 offen
    buffer_load_dwordx4 v[96:99], v234, s[8:11], s27 offen
    buffer_load_dwordx4 v[100:103], v235, s[8:11], s27 offen
    s_waitcnt vmcnt(28)
    v_mfma_f32_32x32x16_bf16 v[160:175], v[104:107], v[40:43], v[160:175]
    v_mfma_f32_32x32x16_bf16 v[176:191], v[108:111], v[40:43], v[176:191]
    v_mfma_f32_32x32x16_bf16 v[192:207], v[104:107], v[44:47], v[192:207]
    v_mfma_f32_32x32x16_bf16 v[208:223], v[108:111], v[44:47], v[208:223]
    s_mov_b32 s27, 17408
    buffer_load_dwordx4 v[40:43], v232, s[4:7], s27 offen
    buffer_load_dwordx4 v[44:47], v233, s[4:7], s27 offen
    buffer_load_dwordx4 v[104:107], v234, s[8:11], s27 offen
    buffer_load_dwordx4 v[108:111], v235, s[8:11], s27 offen
    s_waitcnt vmcnt(28)
    v_mfma_f32_32x32x16_bf16 v[160:175], v[112:115], v[48:51], v[160:175]
    v_mfma_f32_32x32x16_bf16 v[176:191], v[116:119], v[48:51], v[176:191]
    v_mfma_f32_32x32x16_bf16 v[192:207], v[112:115], v[52:55], v[192:207]
    v_mfma_f32_32x32x16_bf16 v[208:223], v[116:119], v[52:55], v[208:223]
    s_mov_b32 s27, 18432
    buffer_load_dwordx4 v[48:51], v232, s[4:7], s27 offen
    buffer_load_dwordx4 v[52:55], v233, s[4:7], s27 offen
    buffer_load_dwordx4 v[112:115], v234, s[8:11], s27 offen
    buffer_load_dwordx4 v[116:119], v235, s[8:11], s27 offen
    s_waitcnt vmcnt(28)
    v_mfma_f32_32x32x16_bf16 v[160:175], v[120:123], v[56:59], v[160:175]
    v_mfma_f32_32x32x16_bf16 v[176:191], v[124:127], v[56:59], v[176:191]
    v_mfma_f32_32x32x16_bf16 v[192:207], v[120:123], v[60:63], v[192:207]
    v_mfma_f32_32x32x16_bf16 v[208:223], v[124:127], v[60:63], v[208:223]
    s_mov_b32 s27, 19456
    buffer_load_dwordx4 v[56:59], v232, s[4:7], s27 offen
    buffer_load_dwordx4 v[60:63], v233, s[4:7], s27 offen
    buffer_load_dwordx4 v[120:123], v234, s[8:11], s27 offen
    buffer_load_dwordx4 v[124:127], v235, s[8:11], s27 offen
    s_waitcnt vmcnt(28)
    v_mfma_f32_32x32x16_bf16 v[160:175], v[128:131], v[64:67], v[160:175]
    v_mfma_f32_32x32x16_bf16 v[176:191], v[132:135], v[64:67], v[176:191]
    v_mfma_f32_32x32x16_bf16 v[192:207], v[128:131], v[68:71], v[192:207]
    v_mfma_f32_32x32x16_bf16 v[208:223], v[132:135], v[68:71], v[208:223]
    s_mov_b32 s27, 20480
    buffer_load_dwordx4 v[64:67], v232, s[4:7], s27 offen
    buffer_load_dwordx4 v[68:71], v233, s[4:7], s27 offen
    buffer_load_dwordx4 v[128:131], v234, s[8:11], s27 offen
    buffer_load_dwordx4 v[132:135], v235, s[8:11], s27 offen
    s_waitcnt vmcnt(28)
    v_mfma_f32_32x32x16_bf16 v[160:175], v[136:139], v[72:75], v[160:175]
    v_mfma_f32_32x32x16_bf16 v[176:191], v[140:143], v[72:75], v[176:191]
    v_mfma_f32_32x32x16_bf16 v[192:207], v[136:139], v[76:79], v[192:207]
    v_mfma_f32_32x32x16_bf16 v[208:223], v[140:143], v[76:79], v[208:223]
    s_mov_b32 s27, 21504
    buffer_load_dwordx4 v[72:75], v232, s[4:7], s27 offen
    buffer_load_dwordx4 v[76:79], v233, s[4:7], s27 offen
    buffer_load_dwordx4 v[136:139], v234, s[8:11], s27 offen
    buffer_load_dwordx4 v[140:143], v235, s[8:11], s27 offen
    s_waitcnt vmcnt(28)
    v_mfma_f32_32x32x16_bf16 v[160:175], v[144:147], v[80:83], v[160:175]
    v_mfma_f32_32x32x16_bf16 v[176:191], v[148:151], v[80:83], v[176:191]
    v_mfma_f32_32x32x16_bf16 v[192:207], v[144:147], v[84:87], v[192:207]
    v_mfma_f32_32x32x16_bf16 v[208:223], v[148:151], v[84:87], v[208:223]
    s_mov_b32 s27, 22528
    buffer_load_dwordx4 v[80:83], v232, s[4:7], s27 offen
    buffer_load_dwordx4 v[84:87], v233, s[4:7], s27 offen
    buffer_load_dwordx4 v[144:147], v234, s[8:11], s27 offen
    buffer_load_dwordx4 v[148:151], v235, s[8:11], s27 offen
    s_waitcnt vmcnt(28)
    v_mfma_f32_32x32x16_bf16 v[160:175], v[152:155], v[88:91], v[160:175]
    v_mfma_f32_32x32x16_bf16 v[176:191], v[156:159], v[88:91], v[176:191]
    v_mfma_f32_32x32x16_bf16 v[192:207], v[152:155], v[92:95], v[192:207]
    v_mfma_f32_32x32x16_bf16 v[208:223], v[156:159], v[92:95], v[208:223]
    s_mov_b32 s27, 23552
    buffer_load_dwordx4 v[88:91], v232, s[4:7], s27 offen
    buffer_load_dwordx4 v[92:95], v233, s[4:7], s27 offen
    buffer_load_dwordx4 v[152:155], v234, s[8:11], s27 offen
    buffer_load_dwordx4 v[156:159], v235, s[8:11], s27 offen
    s_waitcnt vmcnt(28)
    v_mfma_f32_32x32x16_bf16 v[160:175], v[96:99], v[32:35], v[160:175]
    v_mfma_f32_32x32x16_bf16 v[176:191], v[100:103], v[32:35], v[176:191]
    v_mfma_f32_32x32x16_bf16 v[192:207], v[96:99], v[36:39], v[192:207]
    v_mfma_f32_32x32x16_bf16 v[208:223], v[100:103], v[36:39], v[208:223]
    s_mov_b32 s27, 24576
    buffer_load_dwordx4 v[32:35], v232, s[4:7], s27 offen
    buffer_load_dwordx4 v[36:39], v233, s[4:7], s27 offen
    buffer_load_dwordx4 v[96:99], v234, s[8:11], s27 offen
    buffer_load_dwordx4 v[100:103], v235, s[8:11], s27 offen
    s_waitcnt vmcnt(28)
    v_mfma_f32_32x32x16_bf16 v[160:175], v[104:107], v[40:43], v[160:175]
    v_mfma_f32_32x32x16_bf16 v[176:191], v[108:111], v[40:43], v[176:191]
    v_mfma_f32_32x32x16_bf16 v[192:207], v[104:107], v[44:47], v[192:207]
    v_mfma_f32_32x32x16_bf16 v[208:223], v[108:111], v[44:47], v[208:223]
    s_mov_b32 s27, 25600
    buffer_load_dwordx4 v[40:43], v232, s[4:7], s27 offen
    buffer_load_dwordx4 v[44:47], v233, s[4:7], s27 offen
    buffer_load_dwordx4 v[104:107], v234, s[8:11], s27 offen
    buffer_load_dwordx4 v[108:111], v235, s[8:11], s27 offen
    s_waitcnt vmcnt(28)
    v_mfma_f32_32x32x16_bf16 v[160:175], v[112:115], v[48:51], v[160:175]
    v_mfma_f32_32x32x16_bf16 v[176:191], v[116:119], v[48:51], v[176:191]
    v_mfma_f32_32x32x16_bf16 v[192:207], v[112:115], v[52:55], v[192:207]
    v_mfma_f32_32x32x16_bf16 v[208:223], v[116:119], v[52:55], v[208:223]
    s_mov_b32 s27, 26624
    buffer_load_dwordx4 v[48:51], v232, s[4:7], s27 offen
    buffer_load_dwordx4 v[52:55], v233, s[4:7], s27 offen
    buffer_load_dwordx4 v[112:115], v234, s[8:11], s27 offen
    buffer_load_dwordx4 v[116:119], v235, s[8:11], s27 offen
    s_waitcnt vmcnt(28)
    v_mfma_f32_32x32x16_bf16 v[160:175], v[120:123], v[56:59], v[160:175]
    v_mfma_f32_32x32x16_bf16 v[176:191], v[124:127], v[56:59], v[176:191]
    v_mfma_f32_32x32x16_bf16 v[192:207], v[120:123], v[60:63], v[192:207]
    v_mfma_f32_32x32x16_bf16 v[208:223], v[124:127], v[60:63], v[208:223]
    s_mov_b32 s27, 27648
    buffer_load_dwordx4 v[56:59], v232, s[4:7], s27 offen
    buffer_load_dwordx4 v[60:63], v233, s[4:7], s27 offen
    buffer_load_dwordx4 v[120:123], v234, s[8:11], s27 offen
    buffer_load_dwordx4 v[124:127], v235, s[8:11], s27 offen
    s_waitcnt vmcnt(28)
    v_mfma_f32_32x32x16_bf16 v[160:175], v[128:131], v[64:67], v[160:175]
    v_mfma_f32_32x32x16_bf16 v[176:191], v[132:135], v[64:67], v[176:191]
    v_mfma_f32_32x32x16_bf16 v[192:207], v[128:131], v[68:71], v[192:207]
    v_mfma_f32_32x32x16_bf16 v[208:223], v[132:135], v[68:71], v[208:223]
    s_mov_b32 s27, 28672
    buffer_load_dwordx4 v[64:67], v232, s[4:7], s27 offen
    buffer_load_dwordx4 v[68:71], v233, s[4:7], s27 offen
    buffer_load_dwordx4 v[128:131], v234, s[8:11], s27 offen
    buffer_load_dwordx4 v[132:135], v235, s[8:11], s27 offen
    s_waitcnt vmcnt(28)
    v_mfma_f32_32x32x16_bf16 v[160:175], v[136:139], v[72:75], v[160:175]
    v_mfma_f32_32x32x16_bf16 v[176:191], v[140:143], v[72:75], v[176:191]
    v_mfma_f32_32x32x16_bf16 v[192:207], v[136:139], v[76:79], v[192:207]
    v_mfma_f32_32x32x16_bf16 v[208:223], v[140:143], v[76:79], v[208:223]
    s_mov_b32 s27, 29696
    buffer_load_dwordx4 v[72:75], v232, s[4:7], s27 offen
    buffer_load_dwordx4 v[76:79], v233, s[4:7], s27 offen
    buffer_load_dwordx4 v[136:139], v234, s[8:11], s27 offen
    buffer_load_dwordx4 v[140:143], v235, s[8:11], s27 offen
    s_waitcnt vmcnt(28)
    v_mfma_f32_32x32x16_bf16 v[160:175], v[144:147], v[80:83], v[160:175]
    v_mfma_f32_32x32x16_bf16 v[176:191], v[148:151], v[80:83], v[176:191]
    v_mfma_f32_32x32x16_bf16 v[192:207], v[144:147], v[84:87], v[192:207]
    v_mfma_f32_32x32x16_bf16 v[208:223], v[148:151], v[84:87], v[208:223]
    s_mov_b32 s27, 30720
    buffer_load_dwordx4 v[80:83], v232, s[4:7], s27 offen
    buffer_load_dwordx4 v[84:87], v233, s[4:7], s27 offen
    buffer_load_dwordx4 v[144:147], v234, s[8:11], s27 offen
    buffer_load_dwordx4 v[148:151], v235, s[8:11], s27 offen
    s_waitcnt vmcnt(28)
    v_mfma_f32_32x32x16_bf16 v[160:175], v[152:155], v[88:91], v[160:175]
    v_mfma_f32_32x32x16_bf16 v[176:191], v[156:159], v[88:91], v[176:191]
    v_mfma_f32_32x32x16_bf16 v[192:207], v[152:155], v[92:95], v[192:207]
    v_mfma_f32_32x32x16_bf16 v[208:223], v[156:159], v[92:95], v[208:223]
    s_mov_b32 s27, 31744
    buffer_load_dwordx4 v[88:91], v232, s[4:7], s27 offen
    buffer_load_dwordx4 v[92:95], v233, s[4:7], s27 offen
    buffer_load_dwordx4 v[152:155], v234, s[8:11], s27 offen
    buffer_load_dwordx4 v[156:159], v235, s[8:11], s27 offen
    s_waitcnt vmcnt(28)
    v_mfma_f32_32x32x16_bf16 v[160:175], v[96:99], v[32:35], v[160:175]
    v_mfma_f32_32x32x16_bf16 v[176:191], v[100:103], v[32:35], v[176:191]
    v_mfma_f32_32x32x16_bf16 v[192:207], v[96:99], v[36:39], v[192:207]
    v_mfma_f32_32x32x16_bf16 v[208:223], v[100:103], v[36:39], v[208:223]
    s_waitcnt vmcnt(24)
    v_mfma_f32_32x32x16_bf16 v[160:175], v[104:107], v[40:43], v[160:175]
    v_mfma_f32_32x32x16_bf16 v[176:191], v[108:111], v[40:43], v[176:191]
    v_mfma_f32_32x32x16_bf16 v[192:207], v[104:107], v[44:47], v[192:207]
    v_mfma_f32_32x32x16_bf16 v[208:223], v[108:111], v[44:47], v[208:223]
    s_waitcnt vmcnt(20)
    v_mfma_f32_32x32x16_bf16 v[160:175], v[112:115], v[48:51], v[160:175]
    v_mfma_f32_32x32x16_bf16 v[176:191], v[116:119], v[48:51], v[176:191]
    v_mfma_f32_32x32x16_bf16 v[192:207], v[112:115], v[52:55], v[192:207]
    v_mfma_f32_32x32x16_bf16 v[208:223], v[116:119], v[52:55], v[208:223]
    s_waitcnt vmcnt(16)
    v_mfma_f32_32x32x16_bf16 v[160:175], v[120:123], v[56:59], v[160:175]
    v_mfma_f32_32x32x16_bf16 v[176:191], v[124:127], v[56:59], v[176:191]
    v_mfma_f32_32x32x16_bf16 v[192:207], v[120:123], v[60:63], v[192:207]
    v_mfma_f32_32x32x16_bf16 v[208:223], v[124:127], v[60:63], v[208:223]
    s_waitcnt vmcnt(12)
    v_mfma_f32_32x32x16_bf16 v[160:175], v[128:131], v[64:67], v[160:175]
    v_mfma_f32_32x32x16_bf16 v[176:191], v[132:135], v[64:67], v[176:191]
    v_mfma_f32_32x32x16_bf16 v[192:207], v[128:131], v[68:71], v[192:207]
    v_mfma_f32_32x32x16_bf16 v[208:223], v[132:135], v[68:71], v[208:223]
    s_waitcnt vmcnt(8)
    v_mfma_f32_32x32x16_bf16 v[160:175], v[136:139], v[72:75], v[160:175]
    v_mfma_f32_32x32x16_bf16 v[176:191], v[140:143], v[72:75], v[176:191]
    v_mfma_f32_32x32x16_bf16 v[192:207], v[136:139], v[76:79], v[192:207]
    v_mfma_f32_32x32x16_bf16 v[208:223], v[140:143], v[76:79], v[208:223]
    s_waitcnt vmcnt(4)
    v_mfma_f32_32x32x16_bf16 v[160:175], v[144:147], v[80:83], v[160:175]
    v_mfma_f32_32x32x16_bf16 v[176:191], v[148:151], v[80:83], v[176:191]
    v_mfma_f32_32x32x16_bf16 v[192:207], v[144:147], v[84:87], v[192:207]
    v_mfma_f32_32x32x16_bf16 v[208:223], v[148:151], v[84:87], v[208:223]
    s_waitcnt vmcnt(0)
    v_mfma_f32_32x32x16_bf16 v[160:175], v[152:155], v[88:91], v[160:175]
    v_mfma_f32_32x32x16_bf16 v[176:191], v[156:159], v[88:91], v[176:191]
    v_mfma_f32_32x32x16_bf16 v[192:207], v[152:155], v[92:95], v[192:207]
    v_mfma_f32_32x32x16_bf16 v[208:223], v[156:159], v[92:95], v[208:223]
    s_nop 7
    s_nop 7
    s_lshl_b32 s23, s21, 6
    s_add_u32 s23, s23, 0
    s_lshl_b32 s24, s22, 6
    s_add_u32 s24, s24, 0
    s_cmp_ge_u32 s24, 1376
    s_cbranch_scc1 L_w3_kernel_skip00
    v_add_u32 v4, s23, v2
    v_mov_b32 v16, v160
    v_mov_b32 v17, v161
    v_mov_b32 v18, v162
    v_mov_b32 v19, v163
    v_mov_b32 v20, v164
    v_mov_b32 v21, v165
    v_mov_b32 v22, v166
    v_mov_b32 v23, v167
    v_mov_b32 v24, v168
    v_mov_b32 v25, v169
    v_mov_b32 v26, v170
    v_mov_b32 v27, v171
    v_mov_b32 v28, v172
    v_mov_b32 v29, v173
    v_mov_b32 v30, v174
    v_mov_b32 v31, v175
    v_lshlrev_b32 v9, 2, v3
    v_add_u32 v9, s24, v9
    s_waitcnt lgkmcnt(0)
    s_add_u32 s12, s84, 0x1a00000
    s_addc_u32 s13, s85, 0
    s_mov_b32 s14, 0x560000
    s_mov_b32 s15, 0x00020000
    s_mov_b32 s25, 2752
    v_mul_lo_u32 v10, v4, s25
    v_lshlrev_b32 v11, 1, v9
    v_add_u32 v10, v10, v11
    v_add_u32 v11, 0, v9
    v_lshrrev_b32 v12, 5, v4
    s_mov_b32 s36, 86
    v_mul_lo_u32 v12, v12, s36
    v_lshrrev_b32 v13, 4, v11
    v_add_u32 v12, v12, v13
    v_lshlrev_b32 v60, 10, v12
    v_and_b32 v12, 31, v4
    v_lshlrev_b32 v12, 4, v12
    v_add_u32 v60, v60, v12
    v_lshrrev_b32 v12, 3, v11
    v_and_b32 v12, 1, v12
    v_lshlrev_b32 v12, 9, v12
    v_add_u32 v60, v60, v12
    v_and_b32 v12, 7, v11
    v_lshlrev_b32 v12, 1, v12
    v_add_u32 v60, v60, v12
    v_add_u32 v64, 0, v10
    v_add_u32 v11, 8, v9
    v_lshrrev_b32 v12, 5, v4
    s_mov_b32 s36, 86
    v_mul_lo_u32 v12, v12, s36
    v_lshrrev_b32 v13, 4, v11
    v_add_u32 v12, v12, v13
    v_lshlrev_b32 v61, 10, v12
    v_and_b32 v12, 31, v4
    v_lshlrev_b32 v12, 4, v12
    v_add_u32 v61, v61, v12
    v_lshrrev_b32 v12, 3, v11
    v_and_b32 v12, 1, v12
    v_lshlrev_b32 v12, 9, v12
    v_add_u32 v61, v61, v12
    v_and_b32 v12, 7, v11
    v_lshlrev_b32 v12, 1, v12
    v_add_u32 v61, v61, v12
    v_add_u32 v65, 16, v10
    v_add_u32 v11, 16, v9
    v_lshrrev_b32 v12, 5, v4
    s_mov_b32 s36, 86
    v_mul_lo_u32 v12, v12, s36
    v_lshrrev_b32 v13, 4, v11
    v_add_u32 v12, v12, v13
    v_lshlrev_b32 v62, 10, v12
    v_and_b32 v12, 31, v4
    v_lshlrev_b32 v12, 4, v12
    v_add_u32 v62, v62, v12
    v_lshrrev_b32 v12, 3, v11
    v_and_b32 v12, 1, v12
    v_lshlrev_b32 v12, 9, v12
    v_add_u32 v62, v62, v12
    v_and_b32 v12, 7, v11
    v_lshlrev_b32 v12, 1, v12
    v_add_u32 v62, v62, v12
    v_add_u32 v66, 32, v10
    v_add_u32 v11, 24, v9
    v_lshrrev_b32 v12, 5, v4
    s_mov_b32 s36, 86
    v_mul_lo_u32 v12, v12, s36
    v_lshrrev_b32 v13, 4, v11
    v_add_u32 v12, v12, v13
    v_lshlrev_b32 v63, 10, v12
    v_and_b32 v12, 31, v4
    v_lshlrev_b32 v12, 4, v12
    v_add_u32 v63, v63, v12
    v_lshrrev_b32 v12, 3, v11
    v_and_b32 v12, 1, v12
    v_lshlrev_b32 v12, 9, v12
    v_add_u32 v63, v63, v12
    v_and_b32 v12, 7, v11
    v_lshlrev_b32 v12, 1, v12
    v_add_u32 v63, v63, v12
    v_add_u32 v67, 48, v10
    s_waitcnt vmcnt(0)
    v_cvt_pk_bf16_f32 v13, v16, v16
    v_lshlrev_b32 v16, 16, v13
    v_mul_f32 v13, v16, v16
    v_mov_b32 v14, 0x3d372713
    v_fma_f32 v13, v13, v14, 1.0
    v_mul_f32 v13, v13, v16
    v_mul_f32 v13, 0xc0135761, v13
    v_exp_f32 v13, v13
    s_nop 0
    v_add_f32 v13, 1.0, v13
    v_rcp_f32 v13, v13
    s_nop 0
    v_mul_f32 v16, v16, v13
    v_cvt_pk_bf16_f32 v13, v17, v17
    v_lshlrev_b32 v17, 16, v13
    v_mul_f32 v13, v17, v17
    v_mov_b32 v14, 0x3d372713
    v_fma_f32 v13, v13, v14, 1.0
    v_mul_f32 v13, v13, v17
    v_mul_f32 v13, 0xc0135761, v13
    v_exp_f32 v13, v13
    s_nop 0
    v_add_f32 v13, 1.0, v13
    v_rcp_f32 v13, v13
    s_nop 0
    v_mul_f32 v17, v17, v13
    v_cvt_pk_bf16_f32 v13, v18, v18
    v_lshlrev_b32 v18, 16, v13
    v_mul_f32 v13, v18, v18
    v_mov_b32 v14, 0x3d372713
    v_fma_f32 v13, v13, v14, 1.0
    v_mul_f32 v13, v13, v18
    v_mul_f32 v13, 0xc0135761, v13
    v_exp_f32 v13, v13
    s_nop 0
    v_add_f32 v13, 1.0, v13
    v_rcp_f32 v13, v13
    s_nop 0
    v_mul_f32 v18, v18, v13
    v_cvt_pk_bf16_f32 v13, v19, v19
    v_lshlrev_b32 v19, 16, v13
    v_mul_f32 v13, v19, v19
    v_mov_b32 v14, 0x3d372713
    v_fma_f32 v13, v13, v14, 1.0
    v_mul_f32 v13, v13, v19
    v_mul_f32 v13, 0xc0135761, v13
    v_exp_f32 v13, v13
    s_nop 0
    v_add_f32 v13, 1.0, v13
    v_rcp_f32 v13, v13
    s_nop 0
    v_mul_f32 v19, v19, v13
    v_cvt_pk_bf16_f32 v14, v16, v17
    v_cvt_pk_bf16_f32 v15, v18, v19
    buffer_store_dwordx2 v[14:15], v60, s[12:15], 0 offen
    v_cvt_pk_bf16_f32 v13, v20, v20
    v_lshlrev_b32 v20, 16, v13
    v_mul_f32 v13, v20, v20
    v_mov_b32 v14, 0x3d372713
    v_fma_f32 v13, v13, v14, 1.0
    v_mul_f32 v13, v13, v20
    v_mul_f32 v13, 0xc0135761, v13
    v_exp_f32 v13, v13
    s_nop 0
    v_add_f32 v13, 1.0, v13
    v_rcp_f32 v13, v13
    s_nop 0
    v_mul_f32 v20, v20, v13
    v_cvt_pk_bf16_f32 v13, v21, v21
    v_lshlrev_b32 v21, 16, v13
    v_mul_f32 v13, v21, v21
    v_mov_b32 v14, 0x3d372713
    v_fma_f32 v13, v13, v14, 1.0
    v_mul_f32 v13, v13, v21
    v_mul_f32 v13, 0xc0135761, v13
    v_exp_f32 v13, v13
    s_nop 0
    v_add_f32 v13, 1.0, v13
    v_rcp_f32 v13, v13
    s_nop 0
    v_mul_f32 v21, v21, v13
    v_cvt_pk_bf16_f32 v13, v22, v22
    v_lshlrev_b32 v22, 16, v13
    v_mul_f32 v13, v22, v22
    v_mov_b32 v14, 0x3d372713
    v_fma_f32 v13, v13, v14, 1.0
    v_mul_f32 v13, v13, v22
    v_mul_f32 v13, 0xc0135761, v13
    v_exp_f32 v13, v13
    s_nop 0
    v_add_f32 v13, 1.0, v13
    v_rcp_f32 v13, v13
    s_nop 0
    v_mul_f32 v22, v22, v13
    v_cvt_pk_bf16_f32 v13, v23, v23
    v_lshlrev_b32 v23, 16, v13
    v_mul_f32 v13, v23, v23
    v_mov_b32 v14, 0x3d372713
    v_fma_f32 v13, v13, v14, 1.0
    v_mul_f32 v13, v13, v23
    v_mul_f32 v13, 0xc0135761, v13
    v_exp_f32 v13, v13
    s_nop 0
    v_add_f32 v13, 1.0, v13
    v_rcp_f32 v13, v13
    s_nop 0
    v_mul_f32 v23, v23, v13
    v_cvt_pk_bf16_f32 v14, v20, v21
    v_cvt_pk_bf16_f32 v15, v22, v23
    buffer_store_dwordx2 v[14:15], v61, s[12:15], 0 offen
    v_cvt_pk_bf16_f32 v13, v24, v24
    v_lshlrev_b32 v24, 16, v13
    v_mul_f32 v13, v24, v24
    v_mov_b32 v14, 0x3d372713
    v_fma_f32 v13, v13, v14, 1.0
    v_mul_f32 v13, v13, v24
    v_mul_f32 v13, 0xc0135761, v13
    v_exp_f32 v13, v13
    s_nop 0
    v_add_f32 v13, 1.0, v13
    v_rcp_f32 v13, v13
    s_nop 0
    v_mul_f32 v24, v24, v13
    v_cvt_pk_bf16_f32 v13, v25, v25
    v_lshlrev_b32 v25, 16, v13
    v_mul_f32 v13, v25, v25
    v_mov_b32 v14, 0x3d372713
    v_fma_f32 v13, v13, v14, 1.0
    v_mul_f32 v13, v13, v25
    v_mul_f32 v13, 0xc0135761, v13
    v_exp_f32 v13, v13
    s_nop 0
    v_add_f32 v13, 1.0, v13
    v_rcp_f32 v13, v13
    s_nop 0
    v_mul_f32 v25, v25, v13
    v_cvt_pk_bf16_f32 v13, v26, v26
    v_lshlrev_b32 v26, 16, v13
    v_mul_f32 v13, v26, v26
    v_mov_b32 v14, 0x3d372713
    v_fma_f32 v13, v13, v14, 1.0
    v_mul_f32 v13, v13, v26
    v_mul_f32 v13, 0xc0135761, v13
    v_exp_f32 v13, v13
    s_nop 0
    v_add_f32 v13, 1.0, v13
    v_rcp_f32 v13, v13
    s_nop 0
    v_mul_f32 v26, v26, v13
    v_cvt_pk_bf16_f32 v13, v27, v27
    v_lshlrev_b32 v27, 16, v13
    v_mul_f32 v13, v27, v27
    v_mov_b32 v14, 0x3d372713
    v_fma_f32 v13, v13, v14, 1.0
    v_mul_f32 v13, v13, v27
    v_mul_f32 v13, 0xc0135761, v13
    v_exp_f32 v13, v13
    s_nop 0
    v_add_f32 v13, 1.0, v13
    v_rcp_f32 v13, v13
    s_nop 0
    v_mul_f32 v27, v27, v13
    v_cvt_pk_bf16_f32 v14, v24, v25
    v_cvt_pk_bf16_f32 v15, v26, v27
    buffer_store_dwordx2 v[14:15], v62, s[12:15], 0 offen
    v_cvt_pk_bf16_f32 v13, v28, v28
    v_lshlrev_b32 v28, 16, v13
    v_mul_f32 v13, v28, v28
    v_mov_b32 v14, 0x3d372713
    v_fma_f32 v13, v13, v14, 1.0
    v_mul_f32 v13, v13, v28
    v_mul_f32 v13, 0xc0135761, v13
    v_exp_f32 v13, v13
    s_nop 0
    v_add_f32 v13, 1.0, v13
    v_rcp_f32 v13, v13
    s_nop 0
    v_mul_f32 v28, v28, v13
    v_cvt_pk_bf16_f32 v13, v29, v29
    v_lshlrev_b32 v29, 16, v13
    v_mul_f32 v13, v29, v29
    v_mov_b32 v14, 0x3d372713
    v_fma_f32 v13, v13, v14, 1.0
    v_mul_f32 v13, v13, v29
    v_mul_f32 v13, 0xc0135761, v13
    v_exp_f32 v13, v13
    s_nop 0
    v_add_f32 v13, 1.0, v13
    v_rcp_f32 v13, v13
    s_nop 0
    v_mul_f32 v29, v29, v13
    v_cvt_pk_bf16_f32 v13, v30, v30
    v_lshlrev_b32 v30, 16, v13
    v_mul_f32 v13, v30, v30
    v_mov_b32 v14, 0x3d372713
    v_fma_f32 v13, v13, v14, 1.0
    v_mul_f32 v13, v13, v30
    v_mul_f32 v13, 0xc0135761, v13
    v_exp_f32 v13, v13
    s_nop 0
    v_add_f32 v13, 1.0, v13
    v_rcp_f32 v13, v13
    s_nop 0
    v_mul_f32 v30, v30, v13
    v_cvt_pk_bf16_f32 v13, v31, v31
    v_lshlrev_b32 v31, 16, v13
    v_mul_f32 v13, v31, v31
    v_mov_b32 v14, 0x3d372713
    v_fma_f32 v13, v13, v14, 1.0
    v_mul_f32 v13, v13, v31
    v_mul_f32 v13, 0xc0135761, v13
    v_exp_f32 v13, v13
    s_nop 0
    v_add_f32 v13, 1.0, v13
    v_rcp_f32 v13, v13
    s_nop 0
    v_mul_f32 v31, v31, v13
    v_cvt_pk_bf16_f32 v14, v28, v29
    v_cvt_pk_bf16_f32 v15, v30, v31
    buffer_store_dwordx2 v[14:15], v63, s[12:15], 0 offen
L_w3_kernel_skip00:
    s_lshl_b32 s23, s21, 6
    s_add_u32 s23, s23, 0
    s_lshl_b32 s24, s22, 6
    s_add_u32 s24, s24, 32
    s_cmp_ge_u32 s24, 1376
    s_cbranch_scc1 L_w3_kernel_skip01
    v_add_u32 v4, s23, v2
    v_mov_b32 v16, v176
    v_mov_b32 v17, v177
    v_mov_b32 v18, v178
    v_mov_b32 v19, v179
    v_mov_b32 v20, v180
    v_mov_b32 v21, v181
    v_mov_b32 v22, v182
    v_mov_b32 v23, v183
    v_mov_b32 v24, v184
    v_mov_b32 v25, v185
    v_mov_b32 v26, v186
    v_mov_b32 v27, v187
    v_mov_b32 v28, v188
    v_mov_b32 v29, v189
    v_mov_b32 v30, v190
    v_mov_b32 v31, v191
    v_lshlrev_b32 v9, 2, v3
    v_add_u32 v9, s24, v9
    s_waitcnt lgkmcnt(0)
    s_add_u32 s12, s84, 0x1a00000
    s_addc_u32 s13, s85, 0
    s_mov_b32 s14, 0x560000
    s_mov_b32 s15, 0x00020000
    s_mov_b32 s25, 2752
    v_mul_lo_u32 v10, v4, s25
    v_lshlrev_b32 v11, 1, v9
    v_add_u32 v10, v10, v11
    v_add_u32 v11, 0, v9
    v_lshrrev_b32 v12, 5, v4
    s_mov_b32 s36, 86
    v_mul_lo_u32 v12, v12, s36
    v_lshrrev_b32 v13, 4, v11
    v_add_u32 v12, v12, v13
    v_lshlrev_b32 v60, 10, v12
    v_and_b32 v12, 31, v4
    v_lshlrev_b32 v12, 4, v12
    v_add_u32 v60, v60, v12
    v_lshrrev_b32 v12, 3, v11
    v_and_b32 v12, 1, v12
    v_lshlrev_b32 v12, 9, v12
    v_add_u32 v60, v60, v12
    v_and_b32 v12, 7, v11
    v_lshlrev_b32 v12, 1, v12
    v_add_u32 v60, v60, v12
    v_add_u32 v64, 0, v10
    v_add_u32 v11, 8, v9
    v_lshrrev_b32 v12, 5, v4
    s_mov_b32 s36, 86
    v_mul_lo_u32 v12, v12, s36
    v_lshrrev_b32 v13, 4, v11
    v_add_u32 v12, v12, v13
    v_lshlrev_b32 v61, 10, v12
    v_and_b32 v12, 31, v4
    v_lshlrev_b32 v12, 4, v12
    v_add_u32 v61, v61, v12
    v_lshrrev_b32 v12, 3, v11
    v_and_b32 v12, 1, v12
    v_lshlrev_b32 v12, 9, v12
    v_add_u32 v61, v61, v12
    v_and_b32 v12, 7, v11
    v_lshlrev_b32 v12, 1, v12
    v_add_u32 v61, v61, v12
    v_add_u32 v65, 16, v10
    v_add_u32 v11, 16, v9
    v_lshrrev_b32 v12, 5, v4
    s_mov_b32 s36, 86
    v_mul_lo_u32 v12, v12, s36
    v_lshrrev_b32 v13, 4, v11
    v_add_u32 v12, v12, v13
    v_lshlrev_b32 v62, 10, v12
    v_and_b32 v12, 31, v4
    v_lshlrev_b32 v12, 4, v12
    v_add_u32 v62, v62, v12
    v_lshrrev_b32 v12, 3, v11
    v_and_b32 v12, 1, v12
    v_lshlrev_b32 v12, 9, v12
    v_add_u32 v62, v62, v12
    v_and_b32 v12, 7, v11
    v_lshlrev_b32 v12, 1, v12
    v_add_u32 v62, v62, v12
    v_add_u32 v66, 32, v10
    v_add_u32 v11, 24, v9
    v_lshrrev_b32 v12, 5, v4
    s_mov_b32 s36, 86
    v_mul_lo_u32 v12, v12, s36
    v_lshrrev_b32 v13, 4, v11
    v_add_u32 v12, v12, v13
    v_lshlrev_b32 v63, 10, v12
    v_and_b32 v12, 31, v4
    v_lshlrev_b32 v12, 4, v12
    v_add_u32 v63, v63, v12
    v_lshrrev_b32 v12, 3, v11
    v_and_b32 v12, 1, v12
    v_lshlrev_b32 v12, 9, v12
    v_add_u32 v63, v63, v12
    v_and_b32 v12, 7, v11
    v_lshlrev_b32 v12, 1, v12
    v_add_u32 v63, v63, v12
    v_add_u32 v67, 48, v10
    s_waitcnt vmcnt(0)
    v_cvt_pk_bf16_f32 v13, v16, v16
    v_lshlrev_b32 v16, 16, v13
    v_mul_f32 v13, v16, v16
    v_mov_b32 v14, 0x3d372713
    v_fma_f32 v13, v13, v14, 1.0
    v_mul_f32 v13, v13, v16
    v_mul_f32 v13, 0xc0135761, v13
    v_exp_f32 v13, v13
    s_nop 0
    v_add_f32 v13, 1.0, v13
    v_rcp_f32 v13, v13
    s_nop 0
    v_mul_f32 v16, v16, v13
    v_cvt_pk_bf16_f32 v13, v17, v17
    v_lshlrev_b32 v17, 16, v13
    v_mul_f32 v13, v17, v17
    v_mov_b32 v14, 0x3d372713
    v_fma_f32 v13, v13, v14, 1.0
    v_mul_f32 v13, v13, v17
    v_mul_f32 v13, 0xc0135761, v13
    v_exp_f32 v13, v13
    s_nop 0
    v_add_f32 v13, 1.0, v13
    v_rcp_f32 v13, v13
    s_nop 0
    v_mul_f32 v17, v17, v13
    v_cvt_pk_bf16_f32 v13, v18, v18
    v_lshlrev_b32 v18, 16, v13
    v_mul_f32 v13, v18, v18
    v_mov_b32 v14, 0x3d372713
    v_fma_f32 v13, v13, v14, 1.0
    v_mul_f32 v13, v13, v18
    v_mul_f32 v13, 0xc0135761, v13
    v_exp_f32 v13, v13
    s_nop 0
    v_add_f32 v13, 1.0, v13
    v_rcp_f32 v13, v13
    s_nop 0
    v_mul_f32 v18, v18, v13
    v_cvt_pk_bf16_f32 v13, v19, v19
    v_lshlrev_b32 v19, 16, v13
    v_mul_f32 v13, v19, v19
    v_mov_b32 v14, 0x3d372713
    v_fma_f32 v13, v13, v14, 1.0
    v_mul_f32 v13, v13, v19
    v_mul_f32 v13, 0xc0135761, v13
    v_exp_f32 v13, v13
    s_nop 0
    v_add_f32 v13, 1.0, v13
    v_rcp_f32 v13, v13
    s_nop 0
    v_mul_f32 v19, v19, v13
    v_cvt_pk_bf16_f32 v14, v16, v17
    v_cvt_pk_bf16_f32 v15, v18, v19
    buffer_store_dwordx2 v[14:15], v60, s[12:15], 0 offen
    v_cvt_pk_bf16_f32 v13, v20, v20
    v_lshlrev_b32 v20, 16, v13
    v_mul_f32 v13, v20, v20
    v_mov_b32 v14, 0x3d372713
    v_fma_f32 v13, v13, v14, 1.0
    v_mul_f32 v13, v13, v20
    v_mul_f32 v13, 0xc0135761, v13
    v_exp_f32 v13, v13
    s_nop 0
    v_add_f32 v13, 1.0, v13
    v_rcp_f32 v13, v13
    s_nop 0
    v_mul_f32 v20, v20, v13
    v_cvt_pk_bf16_f32 v13, v21, v21
    v_lshlrev_b32 v21, 16, v13
    v_mul_f32 v13, v21, v21
    v_mov_b32 v14, 0x3d372713
    v_fma_f32 v13, v13, v14, 1.0
    v_mul_f32 v13, v13, v21
    v_mul_f32 v13, 0xc0135761, v13
    v_exp_f32 v13, v13
    s_nop 0
    v_add_f32 v13, 1.0, v13
    v_rcp_f32 v13, v13
    s_nop 0
    v_mul_f32 v21, v21, v13
    v_cvt_pk_bf16_f32 v13, v22, v22
    v_lshlrev_b32 v22, 16, v13
    v_mul_f32 v13, v22, v22
    v_mov_b32 v14, 0x3d372713
    v_fma_f32 v13, v13, v14, 1.0
    v_mul_f32 v13, v13, v22
    v_mul_f32 v13, 0xc0135761, v13
    v_exp_f32 v13, v13
    s_nop 0
    v_add_f32 v13, 1.0, v13
    v_rcp_f32 v13, v13
    s_nop 0
    v_mul_f32 v22, v22, v13
    v_cvt_pk_bf16_f32 v13, v23, v23
    v_lshlrev_b32 v23, 16, v13
    v_mul_f32 v13, v23, v23
    v_mov_b32 v14, 0x3d372713
    v_fma_f32 v13, v13, v14, 1.0
    v_mul_f32 v13, v13, v23
    v_mul_f32 v13, 0xc0135761, v13
    v_exp_f32 v13, v13
    s_nop 0
    v_add_f32 v13, 1.0, v13
    v_rcp_f32 v13, v13
    s_nop 0
    v_mul_f32 v23, v23, v13
    v_cvt_pk_bf16_f32 v14, v20, v21
    v_cvt_pk_bf16_f32 v15, v22, v23
    buffer_store_dwordx2 v[14:15], v61, s[12:15], 0 offen
    v_cvt_pk_bf16_f32 v13, v24, v24
    v_lshlrev_b32 v24, 16, v13
    v_mul_f32 v13, v24, v24
    v_mov_b32 v14, 0x3d372713
    v_fma_f32 v13, v13, v14, 1.0
    v_mul_f32 v13, v13, v24
    v_mul_f32 v13, 0xc0135761, v13
    v_exp_f32 v13, v13
    s_nop 0
    v_add_f32 v13, 1.0, v13
    v_rcp_f32 v13, v13
    s_nop 0
    v_mul_f32 v24, v24, v13
    v_cvt_pk_bf16_f32 v13, v25, v25
    v_lshlrev_b32 v25, 16, v13
    v_mul_f32 v13, v25, v25
    v_mov_b32 v14, 0x3d372713
    v_fma_f32 v13, v13, v14, 1.0
    v_mul_f32 v13, v13, v25
    v_mul_f32 v13, 0xc0135761, v13
    v_exp_f32 v13, v13
    s_nop 0
    v_add_f32 v13, 1.0, v13
    v_rcp_f32 v13, v13
    s_nop 0
    v_mul_f32 v25, v25, v13
    v_cvt_pk_bf16_f32 v13, v26, v26
    v_lshlrev_b32 v26, 16, v13
    v_mul_f32 v13, v26, v26
    v_mov_b32 v14, 0x3d372713
    v_fma_f32 v13, v13, v14, 1.0
    v_mul_f32 v13, v13, v26
    v_mul_f32 v13, 0xc0135761, v13
    v_exp_f32 v13, v13
    s_nop 0
    v_add_f32 v13, 1.0, v13
    v_rcp_f32 v13, v13
    s_nop 0
    v_mul_f32 v26, v26, v13
    v_cvt_pk_bf16_f32 v13, v27, v27
    v_lshlrev_b32 v27, 16, v13
    v_mul_f32 v13, v27, v27
    v_mov_b32 v14, 0x3d372713
    v_fma_f32 v13, v13, v14, 1.0
    v_mul_f32 v13, v13, v27
    v_mul_f32 v13, 0xc0135761, v13
    v_exp_f32 v13, v13
    s_nop 0
    v_add_f32 v13, 1.0, v13
    v_rcp_f32 v13, v13
    s_nop 0
    v_mul_f32 v27, v27, v13
    v_cvt_pk_bf16_f32 v14, v24, v25
    v_cvt_pk_bf16_f32 v15, v26, v27
    buffer_store_dwordx2 v[14:15], v62, s[12:15], 0 offen
    v_cvt_pk_bf16_f32 v13, v28, v28
    v_lshlrev_b32 v28, 16, v13
    v_mul_f32 v13, v28, v28
    v_mov_b32 v14, 0x3d372713
    v_fma_f32 v13, v13, v14, 1.0
    v_mul_f32 v13, v13, v28
    v_mul_f32 v13, 0xc0135761, v13
    v_exp_f32 v13, v13
    s_nop 0
    v_add_f32 v13, 1.0, v13
    v_rcp_f32 v13, v13
    s_nop 0
    v_mul_f32 v28, v28, v13
    v_cvt_pk_bf16_f32 v13, v29, v29
    v_lshlrev_b32 v29, 16, v13
    v_mul_f32 v13, v29, v29
    v_mov_b32 v14, 0x3d372713
    v_fma_f32 v13, v13, v14, 1.0
    v_mul_f32 v13, v13, v29
    v_mul_f32 v13, 0xc0135761, v13
    v_exp_f32 v13, v13
    s_nop 0
    v_add_f32 v13, 1.0, v13
    v_rcp_f32 v13, v13
    s_nop 0
    v_mul_f32 v29, v29, v13
    v_cvt_pk_bf16_f32 v13, v30, v30
    v_lshlrev_b32 v30, 16, v13
    v_mul_f32 v13, v30, v30
    v_mov_b32 v14, 0x3d372713
    v_fma_f32 v13, v13, v14, 1.0
    v_mul_f32 v13, v13, v30
    v_mul_f32 v13, 0xc0135761, v13
    v_exp_f32 v13, v13
    s_nop 0
    v_add_f32 v13, 1.0, v13
    v_rcp_f32 v13, v13
    s_nop 0
    v_mul_f32 v30, v30, v13
    v_cvt_pk_bf16_f32 v13, v31, v31
    v_lshlrev_b32 v31, 16, v13
    v_mul_f32 v13, v31, v31
    v_mov_b32 v14, 0x3d372713
    v_fma_f32 v13, v13, v14, 1.0
    v_mul_f32 v13, v13, v31
    v_mul_f32 v13, 0xc0135761, v13
    v_exp_f32 v13, v13
    s_nop 0
    v_add_f32 v13, 1.0, v13
    v_rcp_f32 v13, v13
    s_nop 0
    v_mul_f32 v31, v31, v13
    v_cvt_pk_bf16_f32 v14, v28, v29
    v_cvt_pk_bf16_f32 v15, v30, v31
    buffer_store_dwordx2 v[14:15], v63, s[12:15], 0 offen
L_w3_kernel_skip01:
    s_lshl_b32 s23, s21, 6
    s_add_u32 s23, s23, 32
    s_lshl_b32 s24, s22, 6
    s_add_u32 s24, s24, 0
    s_cmp_ge_u32 s24, 1376
    s_cbranch_scc1 L_w3_kernel_skip10
    v_add_u32 v4, s23, v2
    v_mov_b32 v16, v192
    v_mov_b32 v17, v193
    v_mov_b32 v18, v194
    v_mov_b32 v19, v195
    v_mov_b32 v20, v196
    v_mov_b32 v21, v197
    v_mov_b32 v22, v198
    v_mov_b32 v23, v199
    v_mov_b32 v24, v200
    v_mov_b32 v25, v201
    v_mov_b32 v26, v202
    v_mov_b32 v27, v203
    v_mov_b32 v28, v204
    v_mov_b32 v29, v205
    v_mov_b32 v30, v206
    v_mov_b32 v31, v207
    v_lshlrev_b32 v9, 2, v3
    v_add_u32 v9, s24, v9
    s_waitcnt lgkmcnt(0)
    s_add_u32 s12, s84, 0x1a00000
    s_addc_u32 s13, s85, 0
    s_mov_b32 s14, 0x560000
    s_mov_b32 s15, 0x00020000
    s_mov_b32 s25, 2752
    v_mul_lo_u32 v10, v4, s25
    v_lshlrev_b32 v11, 1, v9
    v_add_u32 v10, v10, v11
    v_add_u32 v11, 0, v9
    v_lshrrev_b32 v12, 5, v4
    s_mov_b32 s36, 86
    v_mul_lo_u32 v12, v12, s36
    v_lshrrev_b32 v13, 4, v11
    v_add_u32 v12, v12, v13
    v_lshlrev_b32 v60, 10, v12
    v_and_b32 v12, 31, v4
    v_lshlrev_b32 v12, 4, v12
    v_add_u32 v60, v60, v12
    v_lshrrev_b32 v12, 3, v11
    v_and_b32 v12, 1, v12
    v_lshlrev_b32 v12, 9, v12
    v_add_u32 v60, v60, v12
    v_and_b32 v12, 7, v11
    v_lshlrev_b32 v12, 1, v12
    v_add_u32 v60, v60, v12
    v_add_u32 v64, 0, v10
    v_add_u32 v11, 8, v9
    v_lshrrev_b32 v12, 5, v4
    s_mov_b32 s36, 86
    v_mul_lo_u32 v12, v12, s36
    v_lshrrev_b32 v13, 4, v11
    v_add_u32 v12, v12, v13
    v_lshlrev_b32 v61, 10, v12
    v_and_b32 v12, 31, v4
    v_lshlrev_b32 v12, 4, v12
    v_add_u32 v61, v61, v12
    v_lshrrev_b32 v12, 3, v11
    v_and_b32 v12, 1, v12
    v_lshlrev_b32 v12, 9, v12
    v_add_u32 v61, v61, v12
    v_and_b32 v12, 7, v11
    v_lshlrev_b32 v12, 1, v12
    v_add_u32 v61, v61, v12
    v_add_u32 v65, 16, v10
    v_add_u32 v11, 16, v9
    v_lshrrev_b32 v12, 5, v4
    s_mov_b32 s36, 86
    v_mul_lo_u32 v12, v12, s36
    v_lshrrev_b32 v13, 4, v11
    v_add_u32 v12, v12, v13
    v_lshlrev_b32 v62, 10, v12
    v_and_b32 v12, 31, v4
    v_lshlrev_b32 v12, 4, v12
    v_add_u32 v62, v62, v12
    v_lshrrev_b32 v12, 3, v11
    v_and_b32 v12, 1, v12
    v_lshlrev_b32 v12, 9, v12
    v_add_u32 v62, v62, v12
    v_and_b32 v12, 7, v11
    v_lshlrev_b32 v12, 1, v12
    v_add_u32 v62, v62, v12
    v_add_u32 v66, 32, v10
    v_add_u32 v11, 24, v9
    v_lshrrev_b32 v12, 5, v4
    s_mov_b32 s36, 86
    v_mul_lo_u32 v12, v12, s36
    v_lshrrev_b32 v13, 4, v11
    v_add_u32 v12, v12, v13
    v_lshlrev_b32 v63, 10, v12
    v_and_b32 v12, 31, v4
    v_lshlrev_b32 v12, 4, v12
    v_add_u32 v63, v63, v12
    v_lshrrev_b32 v12, 3, v11
    v_and_b32 v12, 1, v12
    v_lshlrev_b32 v12, 9, v12
    v_add_u32 v63, v63, v12
    v_and_b32 v12, 7, v11
    v_lshlrev_b32 v12, 1, v12
    v_add_u32 v63, v63, v12
    v_add_u32 v67, 48, v10
    s_waitcnt vmcnt(0)
    v_cvt_pk_bf16_f32 v13, v16, v16
    v_lshlrev_b32 v16, 16, v13
    v_mul_f32 v13, v16, v16
    v_mov_b32 v14, 0x3d372713
    v_fma_f32 v13, v13, v14, 1.0
    v_mul_f32 v13, v13, v16
    v_mul_f32 v13, 0xc0135761, v13
    v_exp_f32 v13, v13
    s_nop 0
    v_add_f32 v13, 1.0, v13
    v_rcp_f32 v13, v13
    s_nop 0
    v_mul_f32 v16, v16, v13
    v_cvt_pk_bf16_f32 v13, v17, v17
    v_lshlrev_b32 v17, 16, v13
    v_mul_f32 v13, v17, v17
    v_mov_b32 v14, 0x3d372713
    v_fma_f32 v13, v13, v14, 1.0
    v_mul_f32 v13, v13, v17
    v_mul_f32 v13, 0xc0135761, v13
    v_exp_f32 v13, v13
    s_nop 0
    v_add_f32 v13, 1.0, v13
    v_rcp_f32 v13, v13
    s_nop 0
    v_mul_f32 v17, v17, v13
    v_cvt_pk_bf16_f32 v13, v18, v18
    v_lshlrev_b32 v18, 16, v13
    v_mul_f32 v13, v18, v18
    v_mov_b32 v14, 0x3d372713
    v_fma_f32 v13, v13, v14, 1.0
    v_mul_f32 v13, v13, v18
    v_mul_f32 v13, 0xc0135761, v13
    v_exp_f32 v13, v13
    s_nop 0
    v_add_f32 v13, 1.0, v13
    v_rcp_f32 v13, v13
    s_nop 0
    v_mul_f32 v18, v18, v13
    v_cvt_pk_bf16_f32 v13, v19, v19
    v_lshlrev_b32 v19, 16, v13
    v_mul_f32 v13, v19, v19
    v_mov_b32 v14, 0x3d372713
    v_fma_f32 v13, v13, v14, 1.0
    v_mul_f32 v13, v13, v19
    v_mul_f32 v13, 0xc0135761, v13
    v_exp_f32 v13, v13
    s_nop 0
    v_add_f32 v13, 1.0, v13
    v_rcp_f32 v13, v13
    s_nop 0
    v_mul_f32 v19, v19, v13
    v_cvt_pk_bf16_f32 v14, v16, v17
    v_cvt_pk_bf16_f32 v15, v18, v19
    buffer_store_dwordx2 v[14:15], v60, s[12:15], 0 offen
    v_cvt_pk_bf16_f32 v13, v20, v20
    v_lshlrev_b32 v20, 16, v13
    v_mul_f32 v13, v20, v20
    v_mov_b32 v14, 0x3d372713
    v_fma_f32 v13, v13, v14, 1.0
    v_mul_f32 v13, v13, v20
    v_mul_f32 v13, 0xc0135761, v13
    v_exp_f32 v13, v13
    s_nop 0
    v_add_f32 v13, 1.0, v13
    v_rcp_f32 v13, v13
    s_nop 0
    v_mul_f32 v20, v20, v13
    v_cvt_pk_bf16_f32 v13, v21, v21
    v_lshlrev_b32 v21, 16, v13
    v_mul_f32 v13, v21, v21
    v_mov_b32 v14, 0x3d372713
    v_fma_f32 v13, v13, v14, 1.0
    v_mul_f32 v13, v13, v21
    v_mul_f32 v13, 0xc0135761, v13
    v_exp_f32 v13, v13
    s_nop 0
    v_add_f32 v13, 1.0, v13
    v_rcp_f32 v13, v13
    s_nop 0
    v_mul_f32 v21, v21, v13
    v_cvt_pk_bf16_f32 v13, v22, v22
    v_lshlrev_b32 v22, 16, v13
    v_mul_f32 v13, v22, v22
    v_mov_b32 v14, 0x3d372713
    v_fma_f32 v13, v13, v14, 1.0
    v_mul_f32 v13, v13, v22
    v_mul_f32 v13, 0xc0135761, v13
    v_exp_f32 v13, v13
    s_nop 0
    v_add_f32 v13, 1.0, v13
    v_rcp_f32 v13, v13
    s_nop 0
    v_mul_f32 v22, v22, v13
    v_cvt_pk_bf16_f32 v13, v23, v23
    v_lshlrev_b32 v23, 16, v13
    v_mul_f32 v13, v23, v23
    v_mov_b32 v14, 0x3d372713
    v_fma_f32 v13, v13, v14, 1.0
    v_mul_f32 v13, v13, v23
    v_mul_f32 v13, 0xc0135761, v13
    v_exp_f32 v13, v13
    s_nop 0
    v_add_f32 v13, 1.0, v13
    v_rcp_f32 v13, v13
    s_nop 0
    v_mul_f32 v23, v23, v13
    v_cvt_pk_bf16_f32 v14, v20, v21
    v_cvt_pk_bf16_f32 v15, v22, v23
    buffer_store_dwordx2 v[14:15], v61, s[12:15], 0 offen
    v_cvt_pk_bf16_f32 v13, v24, v24
    v_lshlrev_b32 v24, 16, v13
    v_mul_f32 v13, v24, v24
    v_mov_b32 v14, 0x3d372713
    v_fma_f32 v13, v13, v14, 1.0
    v_mul_f32 v13, v13, v24
    v_mul_f32 v13, 0xc0135761, v13
    v_exp_f32 v13, v13
    s_nop 0
    v_add_f32 v13, 1.0, v13
    v_rcp_f32 v13, v13
    s_nop 0
    v_mul_f32 v24, v24, v13
    v_cvt_pk_bf16_f32 v13, v25, v25
    v_lshlrev_b32 v25, 16, v13
    v_mul_f32 v13, v25, v25
    v_mov_b32 v14, 0x3d372713
    v_fma_f32 v13, v13, v14, 1.0
    v_mul_f32 v13, v13, v25
    v_mul_f32 v13, 0xc0135761, v13
    v_exp_f32 v13, v13
    s_nop 0
    v_add_f32 v13, 1.0, v13
    v_rcp_f32 v13, v13
    s_nop 0
    v_mul_f32 v25, v25, v13
    v_cvt_pk_bf16_f32 v13, v26, v26
    v_lshlrev_b32 v26, 16, v13
    v_mul_f32 v13, v26, v26
    v_mov_b32 v14, 0x3d372713
    v_fma_f32 v13, v13, v14, 1.0
    v_mul_f32 v13, v13, v26
    v_mul_f32 v13, 0xc0135761, v13
    v_exp_f32 v13, v13
    s_nop 0
    v_add_f32 v13, 1.0, v13
    v_rcp_f32 v13, v13
    s_nop 0
    v_mul_f32 v26, v26, v13
    v_cvt_pk_bf16_f32 v13, v27, v27
    v_lshlrev_b32 v27, 16, v13
    v_mul_f32 v13, v27, v27
    v_mov_b32 v14, 0x3d372713
    v_fma_f32 v13, v13, v14, 1.0
    v_mul_f32 v13, v13, v27
    v_mul_f32 v13, 0xc0135761, v13
    v_exp_f32 v13, v13
    s_nop 0
    v_add_f32 v13, 1.0, v13
    v_rcp_f32 v13, v13
    s_nop 0
    v_mul_f32 v27, v27, v13
    v_cvt_pk_bf16_f32 v14, v24, v25
    v_cvt_pk_bf16_f32 v15, v26, v27
    buffer_store_dwordx2 v[14:15], v62, s[12:15], 0 offen
    v_cvt_pk_bf16_f32 v13, v28, v28
    v_lshlrev_b32 v28, 16, v13
    v_mul_f32 v13, v28, v28
    v_mov_b32 v14, 0x3d372713
    v_fma_f32 v13, v13, v14, 1.0
    v_mul_f32 v13, v13, v28
    v_mul_f32 v13, 0xc0135761, v13
    v_exp_f32 v13, v13
    s_nop 0
    v_add_f32 v13, 1.0, v13
    v_rcp_f32 v13, v13
    s_nop 0
    v_mul_f32 v28, v28, v13
    v_cvt_pk_bf16_f32 v13, v29, v29
    v_lshlrev_b32 v29, 16, v13
    v_mul_f32 v13, v29, v29
    v_mov_b32 v14, 0x3d372713
    v_fma_f32 v13, v13, v14, 1.0
    v_mul_f32 v13, v13, v29
    v_mul_f32 v13, 0xc0135761, v13
    v_exp_f32 v13, v13
    s_nop 0
    v_add_f32 v13, 1.0, v13
    v_rcp_f32 v13, v13
    s_nop 0
    v_mul_f32 v29, v29, v13
    v_cvt_pk_bf16_f32 v13, v30, v30
    v_lshlrev_b32 v30, 16, v13
    v_mul_f32 v13, v30, v30
    v_mov_b32 v14, 0x3d372713
    v_fma_f32 v13, v13, v14, 1.0
    v_mul_f32 v13, v13, v30
    v_mul_f32 v13, 0xc0135761, v13
    v_exp_f32 v13, v13
    s_nop 0
    v_add_f32 v13, 1.0, v13
    v_rcp_f32 v13, v13
    s_nop 0
    v_mul_f32 v30, v30, v13
    v_cvt_pk_bf16_f32 v13, v31, v31
    v_lshlrev_b32 v31, 16, v13
    v_mul_f32 v13, v31, v31
    v_mov_b32 v14, 0x3d372713
    v_fma_f32 v13, v13, v14, 1.0
    v_mul_f32 v13, v13, v31
    v_mul_f32 v13, 0xc0135761, v13
    v_exp_f32 v13, v13
    s_nop 0
    v_add_f32 v13, 1.0, v13
    v_rcp_f32 v13, v13
    s_nop 0
    v_mul_f32 v31, v31, v13
    v_cvt_pk_bf16_f32 v14, v28, v29
    v_cvt_pk_bf16_f32 v15, v30, v31
    buffer_store_dwordx2 v[14:15], v63, s[12:15], 0 offen
L_w3_kernel_skip10:
    s_lshl_b32 s23, s21, 6
    s_add_u32 s23, s23, 32
    s_lshl_b32 s24, s22, 6
    s_add_u32 s24, s24, 32
    s_cmp_ge_u32 s24, 1376
    s_cbranch_scc1 L_w3_kernel_skip11
    v_add_u32 v4, s23, v2
    v_mov_b32 v16, v208
    v_mov_b32 v17, v209
    v_mov_b32 v18, v210
    v_mov_b32 v19, v211
    v_mov_b32 v20, v212
    v_mov_b32 v21, v213
    v_mov_b32 v22, v214
    v_mov_b32 v23, v215
    v_mov_b32 v24, v216
    v_mov_b32 v25, v217
    v_mov_b32 v26, v218
    v_mov_b32 v27, v219
    v_mov_b32 v28, v220
    v_mov_b32 v29, v221
    v_mov_b32 v30, v222
    v_mov_b32 v31, v223
    v_lshlrev_b32 v9, 2, v3
    v_add_u32 v9, s24, v9
    s_waitcnt lgkmcnt(0)
    s_add_u32 s12, s84, 0x1a00000
    s_addc_u32 s13, s85, 0
    s_mov_b32 s14, 0x560000
    s_mov_b32 s15, 0x00020000
    s_mov_b32 s25, 2752
    v_mul_lo_u32 v10, v4, s25
    v_lshlrev_b32 v11, 1, v9
    v_add_u32 v10, v10, v11
    v_add_u32 v11, 0, v9
    v_lshrrev_b32 v12, 5, v4
    s_mov_b32 s36, 86
    v_mul_lo_u32 v12, v12, s36
    v_lshrrev_b32 v13, 4, v11
    v_add_u32 v12, v12, v13
    v_lshlrev_b32 v60, 10, v12
    v_and_b32 v12, 31, v4
    v_lshlrev_b32 v12, 4, v12
    v_add_u32 v60, v60, v12
    v_lshrrev_b32 v12, 3, v11
    v_and_b32 v12, 1, v12
    v_lshlrev_b32 v12, 9, v12
    v_add_u32 v60, v60, v12
    v_and_b32 v12, 7, v11
    v_lshlrev_b32 v12, 1, v12
    v_add_u32 v60, v60, v12
    v_add_u32 v64, 0, v10
    v_add_u32 v11, 8, v9
    v_lshrrev_b32 v12, 5, v4
    s_mov_b32 s36, 86
    v_mul_lo_u32 v12, v12, s36
    v_lshrrev_b32 v13, 4, v11
    v_add_u32 v12, v12, v13
    v_lshlrev_b32 v61, 10, v12
    v_and_b32 v12, 31, v4
    v_lshlrev_b32 v12, 4, v12
    v_add_u32 v61, v61, v12
    v_lshrrev_b32 v12, 3, v11
    v_and_b32 v12, 1, v12
    v_lshlrev_b32 v12, 9, v12
    v_add_u32 v61, v61, v12
    v_and_b32 v12, 7, v11
    v_lshlrev_b32 v12, 1, v12
    v_add_u32 v61, v61, v12
    v_add_u32 v65, 16, v10
    v_add_u32 v11, 16, v9
    v_lshrrev_b32 v12, 5, v4
    s_mov_b32 s36, 86
    v_mul_lo_u32 v12, v12, s36
    v_lshrrev_b32 v13, 4, v11
    v_add_u32 v12, v12, v13
    v_lshlrev_b32 v62, 10, v12
    v_and_b32 v12, 31, v4
    v_lshlrev_b32 v12, 4, v12
    v_add_u32 v62, v62, v12
    v_lshrrev_b32 v12, 3, v11
    v_and_b32 v12, 1, v12
    v_lshlrev_b32 v12, 9, v12
    v_add_u32 v62, v62, v12
    v_and_b32 v12, 7, v11
    v_lshlrev_b32 v12, 1, v12
    v_add_u32 v62, v62, v12
    v_add_u32 v66, 32, v10
    v_add_u32 v11, 24, v9
    v_lshrrev_b32 v12, 5, v4
    s_mov_b32 s36, 86
    v_mul_lo_u32 v12, v12, s36
    v_lshrrev_b32 v13, 4, v11
    v_add_u32 v12, v12, v13
    v_lshlrev_b32 v63, 10, v12
    v_and_b32 v12, 31, v4
    v_lshlrev_b32 v12, 4, v12
    v_add_u32 v63, v63, v12
    v_lshrrev_b32 v12, 3, v11
    v_and_b32 v12, 1, v12
    v_lshlrev_b32 v12, 9, v12
    v_add_u32 v63, v63, v12
    v_and_b32 v12, 7, v11
    v_lshlrev_b32 v12, 1, v12
    v_add_u32 v63, v63, v12
    v_add_u32 v67, 48, v10
    s_waitcnt vmcnt(0)
    v_cvt_pk_bf16_f32 v13, v16, v16
    v_lshlrev_b32 v16, 16, v13
    v_mul_f32 v13, v16, v16
    v_mov_b32 v14, 0x3d372713
    v_fma_f32 v13, v13, v14, 1.0
    v_mul_f32 v13, v13, v16
    v_mul_f32 v13, 0xc0135761, v13
    v_exp_f32 v13, v13
    s_nop 0
    v_add_f32 v13, 1.0, v13
    v_rcp_f32 v13, v13
    s_nop 0
    v_mul_f32 v16, v16, v13
    v_cvt_pk_bf16_f32 v13, v17, v17
    v_lshlrev_b32 v17, 16, v13
    v_mul_f32 v13, v17, v17
    v_mov_b32 v14, 0x3d372713
    v_fma_f32 v13, v13, v14, 1.0
    v_mul_f32 v13, v13, v17
    v_mul_f32 v13, 0xc0135761, v13
    v_exp_f32 v13, v13
    s_nop 0
    v_add_f32 v13, 1.0, v13
    v_rcp_f32 v13, v13
    s_nop 0
    v_mul_f32 v17, v17, v13
    v_cvt_pk_bf16_f32 v13, v18, v18
    v_lshlrev_b32 v18, 16, v13
    v_mul_f32 v13, v18, v18
    v_mov_b32 v14, 0x3d372713
    v_fma_f32 v13, v13, v14, 1.0
    v_mul_f32 v13, v13, v18
    v_mul_f32 v13, 0xc0135761, v13
    v_exp_f32 v13, v13
    s_nop 0
    v_add_f32 v13, 1.0, v13
    v_rcp_f32 v13, v13
    s_nop 0
    v_mul_f32 v18, v18, v13
    v_cvt_pk_bf16_f32 v13, v19, v19
    v_lshlrev_b32 v19, 16, v13
    v_mul_f32 v13, v19, v19
    v_mov_b32 v14, 0x3d372713
    v_fma_f32 v13, v13, v14, 1.0
    v_mul_f32 v13, v13, v19
    v_mul_f32 v13, 0xc0135761, v13
    v_exp_f32 v13, v13
    s_nop 0
    v_add_f32 v13, 1.0, v13
    v_rcp_f32 v13, v13
    s_nop 0
    v_mul_f32 v19, v19, v13
    v_cvt_pk_bf16_f32 v14, v16, v17
    v_cvt_pk_bf16_f32 v15, v18, v19
    buffer_store_dwordx2 v[14:15], v60, s[12:15], 0 offen
    v_cvt_pk_bf16_f32 v13, v20, v20
    v_lshlrev_b32 v20, 16, v13
    v_mul_f32 v13, v20, v20
    v_mov_b32 v14, 0x3d372713
    v_fma_f32 v13, v13, v14, 1.0
    v_mul_f32 v13, v13, v20
    v_mul_f32 v13, 0xc0135761, v13
    v_exp_f32 v13, v13
    s_nop 0
    v_add_f32 v13, 1.0, v13
    v_rcp_f32 v13, v13
    s_nop 0
    v_mul_f32 v20, v20, v13
    v_cvt_pk_bf16_f32 v13, v21, v21
    v_lshlrev_b32 v21, 16, v13
    v_mul_f32 v13, v21, v21
    v_mov_b32 v14, 0x3d372713
    v_fma_f32 v13, v13, v14, 1.0
    v_mul_f32 v13, v13, v21
    v_mul_f32 v13, 0xc0135761, v13
    v_exp_f32 v13, v13
    s_nop 0
    v_add_f32 v13, 1.0, v13
    v_rcp_f32 v13, v13
    s_nop 0
    v_mul_f32 v21, v21, v13
    v_cvt_pk_bf16_f32 v13, v22, v22
    v_lshlrev_b32 v22, 16, v13
    v_mul_f32 v13, v22, v22
    v_mov_b32 v14, 0x3d372713
    v_fma_f32 v13, v13, v14, 1.0
    v_mul_f32 v13, v13, v22
    v_mul_f32 v13, 0xc0135761, v13
    v_exp_f32 v13, v13
    s_nop 0
    v_add_f32 v13, 1.0, v13
    v_rcp_f32 v13, v13
    s_nop 0
    v_mul_f32 v22, v22, v13
    v_cvt_pk_bf16_f32 v13, v23, v23
    v_lshlrev_b32 v23, 16, v13
    v_mul_f32 v13, v23, v23
    v_mov_b32 v14, 0x3d372713
    v_fma_f32 v13, v13, v14, 1.0
    v_mul_f32 v13, v13, v23
    v_mul_f32 v13, 0xc0135761, v13
    v_exp_f32 v13, v13
    s_nop 0
    v_add_f32 v13, 1.0, v13
    v_rcp_f32 v13, v13
    s_nop 0
    v_mul_f32 v23, v23, v13
    v_cvt_pk_bf16_f32 v14, v20, v21
    v_cvt_pk_bf16_f32 v15, v22, v23
    buffer_store_dwordx2 v[14:15], v61, s[12:15], 0 offen
    v_cvt_pk_bf16_f32 v13, v24, v24
    v_lshlrev_b32 v24, 16, v13
    v_mul_f32 v13, v24, v24
    v_mov_b32 v14, 0x3d372713
    v_fma_f32 v13, v13, v14, 1.0
    v_mul_f32 v13, v13, v24
    v_mul_f32 v13, 0xc0135761, v13
    v_exp_f32 v13, v13
    s_nop 0
    v_add_f32 v13, 1.0, v13
    v_rcp_f32 v13, v13
    s_nop 0
    v_mul_f32 v24, v24, v13
    v_cvt_pk_bf16_f32 v13, v25, v25
    v_lshlrev_b32 v25, 16, v13
    v_mul_f32 v13, v25, v25
    v_mov_b32 v14, 0x3d372713
    v_fma_f32 v13, v13, v14, 1.0
    v_mul_f32 v13, v13, v25
    v_mul_f32 v13, 0xc0135761, v13
    v_exp_f32 v13, v13
    s_nop 0
    v_add_f32 v13, 1.0, v13
    v_rcp_f32 v13, v13
    s_nop 0
    v_mul_f32 v25, v25, v13
    v_cvt_pk_bf16_f32 v13, v26, v26
    v_lshlrev_b32 v26, 16, v13
    v_mul_f32 v13, v26, v26
    v_mov_b32 v14, 0x3d372713
    v_fma_f32 v13, v13, v14, 1.0
    v_mul_f32 v13, v13, v26
    v_mul_f32 v13, 0xc0135761, v13
    v_exp_f32 v13, v13
    s_nop 0
    v_add_f32 v13, 1.0, v13
    v_rcp_f32 v13, v13
    s_nop 0
    v_mul_f32 v26, v26, v13
    v_cvt_pk_bf16_f32 v13, v27, v27
    v_lshlrev_b32 v27, 16, v13
    v_mul_f32 v13, v27, v27
    v_mov_b32 v14, 0x3d372713
    v_fma_f32 v13, v13, v14, 1.0
    v_mul_f32 v13, v13, v27
    v_mul_f32 v13, 0xc0135761, v13
    v_exp_f32 v13, v13
    s_nop 0
    v_add_f32 v13, 1.0, v13
    v_rcp_f32 v13, v13
    s_nop 0
    v_mul_f32 v27, v27, v13
    v_cvt_pk_bf16_f32 v14, v24, v25
    v_cvt_pk_bf16_f32 v15, v26, v27
    buffer_store_dwordx2 v[14:15], v62, s[12:15], 0 offen
    v_cvt_pk_bf16_f32 v13, v28, v28
    v_lshlrev_b32 v28, 16, v13
    v_mul_f32 v13, v28, v28
    v_mov_b32 v14, 0x3d372713
    v_fma_f32 v13, v13, v14, 1.0
    v_mul_f32 v13, v13, v28
    v_mul_f32 v13, 0xc0135761, v13
    v_exp_f32 v13, v13
    s_nop 0
    v_add_f32 v13, 1.0, v13
    v_rcp_f32 v13, v13
    s_nop 0
    v_mul_f32 v28, v28, v13
    v_cvt_pk_bf16_f32 v13, v29, v29
    v_lshlrev_b32 v29, 16, v13
    v_mul_f32 v13, v29, v29
    v_mov_b32 v14, 0x3d372713
    v_fma_f32 v13, v13, v14, 1.0
    v_mul_f32 v13, v13, v29
    v_mul_f32 v13, 0xc0135761, v13
    v_exp_f32 v13, v13
    s_nop 0
    v_add_f32 v13, 1.0, v13
    v_rcp_f32 v13, v13
    s_nop 0
    v_mul_f32 v29, v29, v13
    v_cvt_pk_bf16_f32 v13, v30, v30
    v_lshlrev_b32 v30, 16, v13
    v_mul_f32 v13, v30, v30
    v_mov_b32 v14, 0x3d372713
    v_fma_f32 v13, v13, v14, 1.0
    v_mul_f32 v13, v13, v30
    v_mul_f32 v13, 0xc0135761, v13
    v_exp_f32 v13, v13
    s_nop 0
    v_add_f32 v13, 1.0, v13
    v_rcp_f32 v13, v13
    s_nop 0
    v_mul_f32 v30, v30, v13
    v_cvt_pk_bf16_f32 v13, v31, v31
    v_lshlrev_b32 v31, 16, v13
    v_mul_f32 v13, v31, v31
    v_mov_b32 v14, 0x3d372713
    v_fma_f32 v13, v13, v14, 1.0
    v_mul_f32 v13, v13, v31
    v_mul_f32 v13, 0xc0135761, v13
    v_exp_f32 v13, v13
    s_nop 0
    v_add_f32 v13, 1.0, v13
    v_rcp_f32 v13, v13
    s_nop 0
    v_mul_f32 v31, v31, v13
    v_cvt_pk_bf16_f32 v14, v28, v29
    v_cvt_pk_bf16_f32 v15, v30, v31
    buffer_store_dwordx2 v[14:15], v63, s[12:15], 0 offen
L_w3_kernel_skip11:
L_end_w3_kernel:
    s_endpgm
.globl w4_kernel
.p2align 8
.type w4_kernel,@function
w4_kernel:
    s_load_dwordx16 s[64:79], s[0:1], 0
    s_load_dwordx4 s[80:83], s[0:1], 64
    s_load_dwordx2 s[84:85], s[0:1], 80
    v_lshrrev_b32 v1, 6, v0
    s_nop 1
    v_readfirstlane_b32 s20, v1
    s_lshl_b32 s3, s2, 2
    s_add_u32 s20, s20, s3
    s_cmp_ge_u32 s20, 1024
    s_cbranch_scc1 L_end_w4_kernel
    v_and_b32 v0, 63, v0
    s_and_b32 s21, s20, 63
    s_lshr_b32 s22, s20, 6
    s_waitcnt lgkmcnt(0)
    s_add_u32 s4, s84, 0x1a00000
    s_addc_u32 s5, s85, 0
    s_mov_b32 s6, 0x560000
    s_mov_b32 s7, 0x00020000
    s_waitcnt lgkmcnt(0)
    s_add_u32 s8, s84, 0x480000
    s_addc_u32 s9, s85, 0
    s_mov_b32 s10, 0x158000
    s_mov_b32 s11, 0x00020000
    v_and_b32 v2, 31, v0
    v_lshrrev_b32 v3, 5, v0
    v_lshlrev_b32 v8, 4, v0
    s_mul_i32 s25, s21, 88064
    s_add_u32 s25, s25, 0
    v_add_u32 v232, s25, v8
    s_mul_i32 s25, s22, 88064
    s_add_u32 s25, s25, 0
    v_add_u32 v234, s25, v8
    v_mov_b32 v160, 0
    v_mov_b32 v161, 0
    v_mov_b32 v162, 0
    v_mov_b32 v163, 0
    v_mov_b32 v164, 0
    v_mov_b32 v165, 0
    v_mov_b32 v166, 0
    v_mov_b32 v167, 0
    v_mov_b32 v168, 0
    v_mov_b32 v169, 0
    v_mov_b32 v170, 0
    v_mov_b32 v171, 0
    v_mov_b32 v172, 0
    v_mov_b32 v173, 0
    v_mov_b32 v174, 0
    v_mov_b32 v175, 0
    s_mov_b32 s27, 0
    buffer_load_dwordx4 v[32:35], v232, s[4:7], s27 offen
    buffer_load_dwordx4 v[96:99], v234, s[8:11], s27 offen
    s_mov_b32 s27, 1024
    buffer_load_dwordx4 v[40:43], v232, s[4:7], s27 offen
    buffer_load_dwordx4 v[104:107], v234, s[8:11], s27 offen
    s_mov_b32 s27, 2048
    buffer_load_dwordx4 v[48:51], v232, s[4:7], s27 offen
    buffer_load_dwordx4 v[112:115], v234, s[8:11], s27 offen
    s_mov_b32 s27, 3072
    buffer_load_dwordx4 v[56:59], v232, s[4:7], s27 offen
    buffer_load_dwordx4 v[120:123], v234, s[8:11], s27 offen
    s_mov_b32 s27, 4096
    buffer_load_dwordx4 v[64:67], v232, s[4:7], s27 offen
    buffer_load_dwordx4 v[128:131], v234, s[8:11], s27 offen
    s_mov_b32 s27, 5120
    buffer_load_dwordx4 v[72:75], v232, s[4:7], s27 offen
    buffer_load_dwordx4 v[136:139], v234, s[8:11], s27 offen
    s_mov_b32 s27, 6144
    buffer_load_dwordx4 v[80:83], v232, s[4:7], s27 offen
    buffer_load_dwordx4 v[144:147], v234, s[8:11], s27 offen
    s_mov_b32 s27, 7168
    buffer_load_dwordx4 v[88:91], v232, s[4:7], s27 offen
    buffer_load_dwordx4 v[152:155], v234, s[8:11], s27 offen
    s_waitcnt vmcnt(14)
    v_mfma_f32_32x32x16_bf16 v[160:175], v[96:99], v[32:35], v[160:175]
    s_mov_b32 s27, 8192
    buffer_load_dwordx4 v[32:35], v232, s[4:7], s27 offen
    buffer_load_dwordx4 v[96:99], v234, s[8:11], s27 offen
    s_waitcnt vmcnt(14)
    v_mfma_f32_32x32x16_bf16 v[160:175], v[104:107], v[40:43], v[160:175]
    s_mov_b32 s27, 9216
    buffer_load_dwordx4 v[40:43], v232, s[4:7], s27 offen
    buffer_load_dwordx4 v[104:107], v234, s[8:11], s27 offen
    s_waitcnt vmcnt(14)
    v_mfma_f32_32x32x16_bf16 v[160:175], v[112:115], v[48:51], v[160:175]
    s_mov_b32 s27, 10240
    buffer_load_dwordx4 v[48:51], v232, s[4:7], s27 offen
    buffer_load_dwordx4 v[112:115], v234, s[8:11], s27 offen
    s_waitcnt vmcnt(14)
    v_mfma_f32_32x32x16_bf16 v[160:175], v[120:123], v[56:59], v[160:175]
    s_mov_b32 s27, 11264
    buffer_load_dwordx4 v[56:59], v232, s[4:7], s27 offen
    buffer_load_dwordx4 v[120:123], v234, s[8:11], s27 offen
    s_waitcnt vmcnt(14)
    v_mfma_f32_32x32x16_bf16 v[160:175], v[128:131], v[64:67], v[160:175]
    s_mov_b32 s27, 12288
    buffer_load_dwordx4 v[64:67], v232, s[4:7], s27 offen
    buffer_load_dwordx4 v[128:131], v234, s[8:11], s27 offen
    s_waitcnt vmcnt(14)
    v_mfma_f32_32x32x16_bf16 v[160:175], v[136:139], v[72:75], v[160:175]
    s_mov_b32 s27, 13312
    buffer_load_dwordx4 v[72:75], v232, s[4:7], s27 offen
    buffer_load_dwordx4 v[136:139], v234, s[8:11], s27 offen
    s_waitcnt vmcnt(14)
    v_mfma_f32_32x32x16_bf16 v[160:175], v[144:147], v[80:83], v[160:175]
    s_mov_b32 s27, 14336
    buffer_load_dwordx4 v[80:83], v232, s[4:7], s27 offen
    buffer_load_dwordx4 v[144:147], v234, s[8:11], s27 offen
    s_waitcnt vmcnt(14)
    v_mfma_f32_32x32x16_bf16 v[160:175], v[152:155], v[88:91], v[160:175]
    s_mov_b32 s27, 15360
    buffer_load_dwordx4 v[88:91], v232, s[4:7], s27 offen
    buffer_load_dwordx4 v[152:155], v234, s[8:11], s27 offen
    s_waitcnt vmcnt(14)
    v_mfma_f32_32x32x16_bf16 v[160:175], v[96:99], v[32:35], v[160:175]
    s_mov_b32 s27, 16384
    buffer_load_dwordx4 v[32:35], v232, s[4:7], s27 offen
    buffer_load_dwordx4 v[96:99], v234, s[8:11], s27 offen
    s_waitcnt vmcnt(14)
    v_mfma_f32_32x32x16_bf16 v[160:175], v[104:107], v[40:43], v[160:175]
    s_mov_b32 s27, 17408
    buffer_load_dwordx4 v[40:43], v232, s[4:7], s27 offen
    buffer_load_dwordx4 v[104:107], v234, s[8:11], s27 offen
    s_waitcnt vmcnt(14)
    v_mfma_f32_32x32x16_bf16 v[160:175], v[112:115], v[48:51], v[160:175]
    s_mov_b32 s27, 18432
    buffer_load_dwordx4 v[48:51], v232, s[4:7], s27 offen
    buffer_load_dwordx4 v[112:115], v234, s[8:11], s27 offen
    s_waitcnt vmcnt(14)
    v_mfma_f32_32x32x16_bf16 v[160:175], v[120:123], v[56:59], v[160:175]
    s_mov_b32 s27, 19456
    buffer_load_dwordx4 v[56:59], v232, s[4:7], s27 offen
    buffer_load_dwordx4 v[120:123], v234, s[8:11], s27 offen
    s_waitcnt vmcnt(14)
    v_mfma_f32_32x32x16_bf16 v[160:175], v[128:131], v[64:67], v[160:175]
    s_mov_b32 s27, 20480
    buffer_load_dwordx4 v[64:67], v232, s[4:7], s27 offen
    buffer_load_dwordx4 v[128:131], v234, s[8:11], s27 offen
    s_waitcnt vmcnt(14)
    v_mfma_f32_32x32x16_bf16 v[160:175], v[136:139], v[72:75], v[160:175]
    s_mov_b32 s27, 21504
    buffer_load_dwordx4 v[72:75], v232, s[4:7], s27 offen
    buffer_load_dwordx4 v[136:139], v234, s[8:11], s27 offen
    s_waitcnt vmcnt(14)
    v_mfma_f32_32x32x16_bf16 v[160:175], v[144:147], v[80:83], v[160:175]
    s_mov_b32 s27, 22528
    buffer_load_dwordx4 v[80:83], v232, s[4:7], s27 offen
    buffer_load_dwordx4 v[144:147], v234, s[8:11], s27 offen
    s_waitcnt vmcnt(14)
    v_mfma_f32_32x32x16_bf16 v[160:175], v[152:155], v[88:91], v[160:175]
    s_mov_b32 s27, 23552
    buffer_load_dwordx4 v[88:91], v232, s[4:7], s27 offen
    buffer_load_dwordx4 v[152:155], v234, s[8:11], s27 offen
    s_waitcnt vmcnt(14)
    v_mfma_f32_32x32x16_bf16 v[160:175], v[96:99], v[32:35], v[160:175]
    s_mov_b32 s27, 24576
    buffer_load_dwordx4 v[32:35], v232, s[4:7], s27 offen
    buffer_load_dwordx4 v[96:99], v234, s[8:11], s27 offen
    s_waitcnt vmcnt(14)
    v_mfma_f32_32x32x16_bf16 v[160:175], v[104:107], v[40:43], v[160:175]
    s_mov_b32 s27, 25600
    buffer_load_dwordx4 v[40:43], v232, s[4:7], s27 offen
    buffer_load_dwordx4 v[104:107], v234, s[8:11], s27 offen
    s_waitcnt vmcnt(14)
    v_mfma_f32_32x32x16_bf16 v[160:175], v[112:115], v[48:51], v[160:175]
    s_mov_b32 s27, 26624
    buffer_load_dwordx4 v[48:51], v232, s[4:7], s27 offen
    buffer_load_dwordx4 v[112:115], v234, s[8:11], s27 offen
    s_waitcnt vmcnt(14)
    v_mfma_f32_32x32x16_bf16 v[160:175], v[120:123], v[56:59], v[160:175]
    s_mov_b32 s27, 27648
    buffer_load_dwordx4 v[56:59], v232, s[4:7], s27 offen
    buffer_load_dwordx4 v[120:123], v234, s[8:11], s27 offen
    s_waitcnt vmcnt(14)
    v_mfma_f32_32x32x16_bf16 v[160:175], v[128:131], v[64:67], v[160:175]
    s_mov_b32 s27, 28672
    buffer_load_dwordx4 v[64:67], v232, s[4:7], s27 offen
    buffer_load_dwordx4 v[128:131], v234, s[8:11], s27 offen
    s_waitcnt vmcnt(14)
    v_mfma_f32_32x32x16_bf16 v[160:175], v[136:139], v[72:75], v[160:175]
    s_mov_b32 s27, 29696
    buffer_load_dwordx4 v[72:75], v232, s[4:7], s27 offen
    buffer_load_dwordx4 v[136:139], v234, s[8:11], s27 offen
    s_waitcnt vmcnt(14)
    v_mfma_f32_32x32x16_bf16 v[160:175], v[144:147], v[80:83], v[160:175]
    s_mov_b32 s27, 30720
    buffer_load_dwordx4 v[80:83], v232, s[4:7], s27 offen
    buffer_load_dwordx4 v[144:147], v234, s[8:11], s27 offen
    s_waitcnt vmcnt(14)
    v_mfma_f32_32x32x16_bf16 v[160:175], v[152:155], v[88:91], v[160:175]
    s_mov_b32 s27, 31744
    buffer_load_dwordx4 v[88:91], v232, s[4:7], s27 offen
    buffer_load_dwordx4 v[152:155], v234, s[8:11], s27 offen
    s_waitcnt vmcnt(14)
    v_mfma_f32_32x32x16_bf16 v[160:175], v[96:99], v[32:35], v[160:175]
    s_mov_b32 s27, 32768
    buffer_load_dwordx4 v[32:35], v232, s[4:7], s27 offen
    buffer_load_dwordx4 v[96:99], v234, s[8:11], s27 offen
    s_waitcnt vmcnt(14)
    v_mfma_f32_32x32x16_bf16 v[160:175], v[104:107], v[40:43], v[160:175]
    s_mov_b32 s27, 33792
    buffer_load_dwordx4 v[40:43], v232, s[4:7], s27 offen
    buffer_load_dwordx4 v[104:107], v234, s[8:11], s27 offen
    s_waitcnt vmcnt(14)
    v_mfma_f32_32x32x16_bf16 v[160:175], v[112:115], v[48:51], v[160:175]
    s_mov_b32 s27, 34816
    buffer_load_dwordx4 v[48:51], v232, s[4:7], s27 offen
    buffer_load_dwordx4 v[112:115], v234, s[8:11], s27 offen
    s_waitcnt vmcnt(14)
    v_mfma_f32_32x32x16_bf16 v[160:175], v[120:123], v[56:59], v[160:175]
    s_mov_b32 s27, 35840
    buffer_load_dwordx4 v[56:59], v232, s[4:7], s27 offen
    buffer_load_dwordx4 v[120:123], v234, s[8:11], s27 offen
    s_waitcnt vmcnt(14)
    v_mfma_f32_32x32x16_bf16 v[160:175], v[128:131], v[64:67], v[160:175]
    s_mov_b32 s27, 36864
    buffer_load_dwordx4 v[64:67], v232, s[4:7], s27 offen
    buffer_load_dwordx4 v[128:131], v234, s[8:11], s27 offen
    s_waitcnt vmcnt(14)
    v_mfma_f32_32x32x16_bf16 v[160:175], v[136:139], v[72:75], v[160:175]
    s_mov_b32 s27, 37888
    buffer_load_dwordx4 v[72:75], v232, s[4:7], s27 offen
    buffer_load_dwordx4 v[136:139], v234, s[8:11], s27 offen
    s_waitcnt vmcnt(14)
    v_mfma_f32_32x32x16_bf16 v[160:175], v[144:147], v[80:83], v[160:175]
    s_mov_b32 s27, 38912
    buffer_load_dwordx4 v[80:83], v232, s[4:7], s27 offen
    buffer_load_dwordx4 v[144:147], v234, s[8:11], s27 offen
    s_waitcnt vmcnt(14)
    v_mfma_f32_32x32x16_bf16 v[160:175], v[152:155], v[88:91], v[160:175]
    s_mov_b32 s27, 39936
    buffer_load_dwordx4 v[88:91], v232, s[4:7], s27 offen
    buffer_load_dwordx4 v[152:155], v234, s[8:11], s27 offen
    s_waitcnt vmcnt(14)
    v_mfma_f32_32x32x16_bf16 v[160:175], v[96:99], v[32:35], v[160:175]
    s_mov_b32 s27, 40960
    buffer_load_dwordx4 v[32:35], v232, s[4:7], s27 offen
    buffer_load_dwordx4 v[96:99], v234, s[8:11], s27 offen
    s_waitcnt vmcnt(14)
    v_mfma_f32_32x32x16_bf16 v[160:175], v[104:107], v[40:43], v[160:175]
    s_mov_b32 s27, 41984
    buffer_load_dwordx4 v[40:43], v232, s[4:7], s27 offen
    buffer_load_dwordx4 v[104:107], v234, s[8:11], s27 offen
    s_waitcnt vmcnt(14)
    v_mfma_f32_32x32x16_bf16 v[160:175], v[112:115], v[48:51], v[160:175]
    s_mov_b32 s27, 43008
    buffer_load_dwordx4 v[48:51], v232, s[4:7], s27 offen
    buffer_load_dwordx4 v[112:115], v234, s[8:11], s27 offen
    s_waitcnt vmcnt(14)
    v_mfma_f32_32x32x16_bf16 v[160:175], v[120:123], v[56:59], v[160:175]
    s_mov_b32 s27, 44032
    buffer_load_dwordx4 v[56:59], v232, s[4:7], s27 offen
    buffer_load_dwordx4 v[120:123], v234, s[8:11], s27 offen
    s_waitcnt vmcnt(14)
    v_mfma_f32_32x32x16_bf16 v[160:175], v[128:131], v[64:67], v[160:175]
    s_mov_b32 s27, 45056
    buffer_load_dwordx4 v[64:67], v232, s[4:7], s27 offen
    buffer_load_dwordx4 v[128:131], v234, s[8:11], s27 offen
    s_waitcnt vmcnt(14)
    v_mfma_f32_32x32x16_bf16 v[160:175], v[136:139], v[72:75], v[160:175]
    s_mov_b32 s27, 46080
    buffer_load_dwordx4 v[72:75], v232, s[4:7], s27 offen
    buffer_load_dwordx4 v[136:139], v234, s[8:11], s27 offen
    s_waitcnt vmcnt(14)
    v_mfma_f32_32x32x16_bf16 v[160:175], v[144:147], v[80:83], v[160:175]
    s_mov_b32 s27, 47104
    buffer_load_dwordx4 v[80:83], v232, s[4:7], s27 offen
    buffer_load_dwordx4 v[144:147], v234, s[8:11], s27 offen
    s_waitcnt vmcnt(14)
    v_mfma_f32_32x32x16_bf16 v[160:175], v[152:155], v[88:91], v[160:175]
    s_mov_b32 s27, 48128
    buffer_load_dwordx4 v[88:91], v232, s[4:7], s27 offen
    buffer_load_dwordx4 v[152:155], v234, s[8:11], s27 offen
    s_waitcnt vmcnt(14)
    v_mfma_f32_32x32x16_bf16 v[160:175], v[96:99], v[32:35], v[160:175]
    s_mov_b32 s27, 49152
    buffer_load_dwordx4 v[32:35], v232, s[4:7], s27 offen
    buffer_load_dwordx4 v[96:99], v234, s[8:11], s27 offen
    s_waitcnt vmcnt(14)
    v_mfma_f32_32x32x16_bf16 v[160:175], v[104:107], v[40:43], v[160:175]
    s_mov_b32 s27, 50176
    buffer_load_dwordx4 v[40:43], v232, s[4:7], s27 offen
    buffer_load_dwordx4 v[104:107], v234, s[8:11], s27 offen
    s_waitcnt vmcnt(14)
    v_mfma_f32_32x32x16_bf16 v[160:175], v[112:115], v[48:51], v[160:175]
    s_mov_b32 s27, 51200
    buffer_load_dwordx4 v[48:51], v232, s[4:7], s27 offen
    buffer_load_dwordx4 v[112:115], v234, s[8:11], s27 offen
    s_waitcnt vmcnt(14)
    v_mfma_f32_32x32x16_bf16 v[160:175], v[120:123], v[56:59], v[160:175]
    s_mov_b32 s27, 52224
    buffer_load_dwordx4 v[56:59], v232, s[4:7], s27 offen
    buffer_load_dwordx4 v[120:123], v234, s[8:11], s27 offen
    s_waitcnt vmcnt(14)
    v_mfma_f32_32x32x16_bf16 v[160:175], v[128:131], v[64:67], v[160:175]
    s_mov_b32 s27, 53248
    buffer_load_dwordx4 v[64:67], v232, s[4:7], s27 offen
    buffer_load_dwordx4 v[128:131], v234, s[8:11], s27 offen
    s_waitcnt vmcnt(14)
    v_mfma_f32_32x32x16_bf16 v[160:175], v[136:139], v[72:75], v[160:175]
    s_mov_b32 s27, 54272
    buffer_load_dwordx4 v[72:75], v232, s[4:7], s27 offen
    buffer_load_dwordx4 v[136:139], v234, s[8:11], s27 offen
    s_waitcnt vmcnt(14)
    v_mfma_f32_32x32x16_bf16 v[160:175], v[144:147], v[80:83], v[160:175]
    s_mov_b32 s27, 55296
    buffer_load_dwordx4 v[80:83], v232, s[4:7], s27 offen
    buffer_load_dwordx4 v[144:147], v234, s[8:11], s27 offen
    s_waitcnt vmcnt(14)
    v_mfma_f32_32x32x16_bf16 v[160:175], v[152:155], v[88:91], v[160:175]
    s_mov_b32 s27, 56320
    buffer_load_dwordx4 v[88:91], v232, s[4:7], s27 offen
    buffer_load_dwordx4 v[152:155], v234, s[8:11], s27 offen
    s_waitcnt vmcnt(14)
    v_mfma_f32_32x32x16_bf16 v[160:175], v[96:99], v[32:35], v[160:175]
    s_mov_b32 s27, 57344
    buffer_load_dwordx4 v[32:35], v232, s[4:7], s27 offen
    buffer_load_dwordx4 v[96:99], v234, s[8:11], s27 offen
    s_waitcnt vmcnt(14)
    v_mfma_f32_32x32x16_bf16 v[160:175], v[104:107], v[40:43], v[160:175]
    s_mov_b32 s27, 58368
    buffer_load_dwordx4 v[40:43], v232, s[4:7], s27 offen
    buffer_load_dwordx4 v[104:107], v234, s[8:11], s27 offen
    s_waitcnt vmcnt(14)
    v_mfma_f32_32x32x16_bf16 v[160:175], v[112:115], v[48:51], v[160:175]
    s_mov_b32 s27, 59392
    buffer_load_dwordx4 v[48:51], v232, s[4:7], s27 offen
    buffer_load_dwordx4 v[112:115], v234, s[8:11], s27 offen
    s_waitcnt vmcnt(14)
    v_mfma_f32_32x32x16_bf16 v[160:175], v[120:123], v[56:59], v[160:175]
    s_mov_b32 s27, 60416
    buffer_load_dwordx4 v[56:59], v232, s[4:7], s27 offen
    buffer_load_dwordx4 v[120:123], v234, s[8:11], s27 offen
    s_waitcnt vmcnt(14)
    v_mfma_f32_32x32x16_bf16 v[160:175], v[128:131], v[64:67], v[160:175]
    s_mov_b32 s27, 61440
    buffer_load_dwordx4 v[64:67], v232, s[4:7], s27 offen
    buffer_load_dwordx4 v[128:131], v234, s[8:11], s27 offen
    s_waitcnt vmcnt(14)
    v_mfma_f32_32x32x16_bf16 v[160:175], v[136:139], v[72:75], v[160:175]
    s_mov_b32 s27, 62464
    buffer_load_dwordx4 v[72:75], v232, s[4:7], s27 offen
    buffer_load_dwordx4 v[136:139], v234, s[8:11], s27 offen
    s_waitcnt vmcnt(14)
    v_mfma_f32_32x32x16_bf16 v[160:175], v[144:147], v[80:83], v[160:175]
    s_mov_b32 s27, 63488
    buffer_load_dwordx4 v[80:83], v232, s[4:7], s27 offen
    buffer_load_dwordx4 v[144:147], v234, s[8:11], s27 offen
    s_waitcnt vmcnt(14)
    v_mfma_f32_32x32x16_bf16 v[160:175], v[152:155], v[88:91], v[160:175]
    s_mov_b32 s27, 64512
    buffer_load_dwordx4 v[88:91], v232, s[4:7], s27 offen
    buffer_load_dwordx4 v[152:155], v234, s[8:11], s27 offen
    s_waitcnt vmcnt(14)
    v_mfma_f32_32x32x16_bf16 v[160:175], v[96:99], v[32:35], v[160:175]
    s_mov_b32 s27, 65536
    buffer_load_dwordx4 v[32:35], v232, s[4:7], s27 offen
    buffer_load_dwordx4 v[96:99], v234, s[8:11], s27 offen
    s_waitcnt vmcnt(14)
    v_mfma_f32_32x32x16_bf16 v[160:175], v[104:107], v[40:43], v[160:175]
    s_mov_b32 s27, 66560
    buffer_load_dwordx4 v[40:43], v232, s[4:7], s27 offen
    buffer_load_dwordx4 v[104:107], v234, s[8:11], s27 offen
    s_waitcnt vmcnt(14)
    v_mfma_f32_32x32x16_bf16 v[160:175], v[112:115], v[48:51], v[160:175]
    s_mov_b32 s27, 67584
    buffer_load_dwordx4 v[48:51], v232, s[4:7], s27 offen
    buffer_load_dwordx4 v[112:115], v234, s[8:11], s27 offen
    s_waitcnt vmcnt(14)
    v_mfma_f32_32x32x16_bf16 v[160:175], v[120:123], v[56:59], v[160:175]
    s_mov_b32 s27, 68608
    buffer_load_dwordx4 v[56:59], v232, s[4:7], s27 offen
    buffer_load_dwordx4 v[120:123], v234, s[8:11], s27 offen
    s_waitcnt vmcnt(14)
    v_mfma_f32_32x32x16_bf16 v[160:175], v[128:131], v[64:67], v[160:175]
    s_mov_b32 s27, 69632
    buffer_load_dwordx4 v[64:67], v232, s[4:7], s27 offen
    buffer_load_dwordx4 v[128:131], v234, s[8:11], s27 offen
    s_waitcnt vmcnt(14)
    v_mfma_f32_32x32x16_bf16 v[160:175], v[136:139], v[72:75], v[160:175]
    s_mov_b32 s27, 70656
    buffer_load_dwordx4 v[72:75], v232, s[4:7], s27 offen
    buffer_load_dwordx4 v[136:139], v234, s[8:11], s27 offen
    s_waitcnt vmcnt(14)
    v_mfma_f32_32x32x16_bf16 v[160:175], v[144:147], v[80:83], v[160:175]
    s_mov_b32 s27, 71680
    buffer_load_dwordx4 v[80:83], v232, s[4:7], s27 offen
    buffer_load_dwordx4 v[144:147], v234, s[8:11], s27 offen
    s_waitcnt vmcnt(14)
    v_mfma_f32_32x32x16_bf16 v[160:175], v[152:155], v[88:91], v[160:175]
    s_mov_b32 s27, 72704
    buffer_load_dwordx4 v[88:91], v232, s[4:7], s27 offen
    buffer_load_dwordx4 v[152:155], v234, s[8:11], s27 offen
    s_waitcnt vmcnt(14)
    v_mfma_f32_32x32x16_bf16 v[160:175], v[96:99], v[32:35], v[160:175]
    s_mov_b32 s27, 73728
    buffer_load_dwordx4 v[32:35], v232, s[4:7], s27 offen
    buffer_load_dwordx4 v[96:99], v234, s[8:11], s27 offen
    s_waitcnt vmcnt(14)
    v_mfma_f32_32x32x16_bf16 v[160:175], v[104:107], v[40:43], v[160:175]
    s_mov_b32 s27, 74752
    buffer_load_dwordx4 v[40:43], v232, s[4:7], s27 offen
    buffer_load_dwordx4 v[104:107], v234, s[8:11], s27 offen
    s_waitcnt vmcnt(14)
    v_mfma_f32_32x32x16_bf16 v[160:175], v[112:115], v[48:51], v[160:175]
    s_mov_b32 s27, 75776
    buffer_load_dwordx4 v[48:51], v232, s[4:7], s27 offen
    buffer_load_dwordx4 v[112:115], v234, s[8:11], s27 offen
    s_waitcnt vmcnt(14)
    v_mfma_f32_32x32x16_bf16 v[160:175], v[120:123], v[56:59], v[160:175]
    s_mov_b32 s27, 76800
    buffer_load_dwordx4 v[56:59], v232, s[4:7], s27 offen
    buffer_load_dwordx4 v[120:123], v234, s[8:11], s27 offen
    s_waitcnt vmcnt(14)
    v_mfma_f32_32x32x16_bf16 v[160:175], v[128:131], v[64:67], v[160:175]
    s_mov_b32 s27, 77824
    buffer_load_dwordx4 v[64:67], v232, s[4:7], s27 offen
    buffer_load_dwordx4 v[128:131], v234, s[8:11], s27 offen
    s_waitcnt vmcnt(14)
    v_mfma_f32_32x32x16_bf16 v[160:175], v[136:139], v[72:75], v[160:175]
    s_mov_b32 s27, 78848
    buffer_load_dwordx4 v[72:75], v232, s[4:7], s27 offen
    buffer_load_dwordx4 v[136:139], v234, s[8:11], s27 offen
    s_waitcnt vmcnt(14)
    v_mfma_f32_32x32x16_bf16 v[160:175], v[144:147], v[80:83], v[160:175]
    s_mov_b32 s27, 79872
    buffer_load_dwordx4 v[80:83], v232, s[4:7], s27 offen
    buffer_load_dwordx4 v[144:147], v234, s[8:11], s27 offen
    s_waitcnt vmcnt(14)
    v_mfma_f32_32x32x16_bf16 v[160:175], v[152:155], v[88:91], v[160:175]
    s_mov_b32 s27, 80896
    buffer_load_dwordx4 v[88:91], v232, s[4:7], s27 offen
    buffer_load_dwordx4 v[152:155], v234, s[8:11], s27 offen
    s_waitcnt vmcnt(14)
    v_mfma_f32_32x32x16_bf16 v[160:175], v[96:99], v[32:35], v[160:175]
    s_mov_b32 s27, 81920
    buffer_load_dwordx4 v[32:35], v232, s[4:7], s27 offen
    buffer_load_dwordx4 v[96:99], v234, s[8:11], s27 offen
    s_waitcnt vmcnt(14)
    v_mfma_f32_32x32x16_bf16 v[160:175], v[104:107], v[40:43], v[160:175]
    s_mov_b32 s27, 82944
    buffer_load_dwordx4 v[40:43], v232, s[4:7], s27 offen
    buffer_load_dwordx4 v[104:107], v234, s[8:11], s27 offen
    s_waitcnt vmcnt(14)
    v_mfma_f32_32x32x16_bf16 v[160:175], v[112:115], v[48:51], v[160:175]
    s_mov_b32 s27, 83968
    buffer_load_dwordx4 v[48:51], v232, s[4:7], s27 offen
    buffer_load_dwordx4 v[112:115], v234, s[8:11], s27 offen
    s_waitcnt vmcnt(14)
    v_mfma_f32_32x32x16_bf16 v[160:175], v[120:123], v[56:59], v[160:175]
    s_mov_b32 s27, 84992
    buffer_load_dwordx4 v[56:59], v232, s[4:7], s27 offen
    buffer_load_dwordx4 v[120:123], v234, s[8:11], s27 offen
    s_waitcnt vmcnt(14)
    v_mfma_f32_32x32x16_bf16 v[160:175], v[128:131], v[64:67], v[160:175]
    s_mov_b32 s27, 86016
    buffer_load_dwordx4 v[64:67], v232, s[4:7], s27 offen
    buffer_load_dwordx4 v[128:131], v234, s[8:11], s27 offen
    s_waitcnt vmcnt(14)
    v_mfma_f32_32x32x16_bf16 v[160:175], v[136:139], v[72:75], v[160:175]
    s_mov_b32 s27, 87040
    buffer_load_dwordx4 v[72:75], v232, s[4:7], s27 offen
    buffer_load_dwordx4 v[136:139], v234, s[8:11], s27 offen
    s_waitcnt vmcnt(14)
    v_mfma_f32_32x32x16_bf16 v[160:175], v[144:147], v[80:83], v[160:175]
    s_waitcnt vmcnt(12)
    v_mfma_f32_32x32x16_bf16 v[160:175], v[152:155], v[88:91], v[160:175]
    s_waitcnt vmcnt(10)
    v_mfma_f32_32x32x16_bf16 v[160:175], v[96:99], v[32:35], v[160:175]
    s_waitcnt vmcnt(8)
    v_mfma_f32_32x32x16_bf16 v[160:175], v[104:107], v[40:43], v[160:175]
    s_waitcnt vmcnt(6)
    v_mfma_f32_32x32x16_bf16 v[160:175], v[112:115], v[48:51], v[160:175]
    s_waitcnt vmcnt(4)
    v_mfma_f32_32x32x16_bf16 v[160:175], v[120:123], v[56:59], v[160:175]
    s_waitcnt vmcnt(2)
    v_mfma_f32_32x32x16_bf16 v[160:175], v[128:131], v[64:67], v[160:175]
    s_waitcnt vmcnt(0)
    v_mfma_f32_32x32x16_bf16 v[160:175], v[136:139], v[72:75], v[160:175]
    s_nop 7
    s_nop 7
    s_lshl_b32 s23, s21, 5
    s_add_u32 s23, s23, 0
    s_lshl_b32 s24, s22, 5
    s_add_u32 s24, s24, 0
    s_cmp_ge_u32 s24, 512
    s_cbranch_scc1 L_w4_kernel_skip00
    v_add_u32 v4, s23, v2
    v_mov_b32 v16, v160
    v_mov_b32 v17, v161
    v_mov_b32 v18, v162
    v_mov_b32 v19, v163
    v_mov_b32 v20, v164
    v_mov_b32 v21, v165
    v_mov_b32 v22, v166
    v_mov_b32 v23, v167
    v_mov_b32 v24, v168
    v_mov_b32 v25, v169
    v_mov_b32 v26, v170
    v_mov_b32 v27, v171
    v_mov_b32 v28, v172
    v_mov_b32 v29, v173
    v_mov_b32 v30, v174
    v_mov_b32 v31, v175
    v_lshlrev_b32 v9, 2, v3
    v_add_u32 v9, s24, v9
    s_waitcnt lgkmcnt(0)
    s_add_u32 s12, s80, 0x0
    s_addc_u32 s13, s81, 0
    s_mov_b32 s14, 0x200000
    s_mov_b32 s15, 0x00020000
    s_waitcnt lgkmcnt(0)
    s_add_u32 s28, s84, 0x1800000
    s_addc_u32 s29, s85, 0
    s_mov_b32 s30, 0x200000
    s_mov_b32 s31, 0x00020000
    s_waitcnt lgkmcnt(0)
    s_add_u32 s32, s84, 0x1000000
    s_addc_u32 s33, s85, 0
    s_mov_b32 s34, 0x200000
    s_mov_b32 s35, 0x00020000
    s_mov_b32 s25, 1024
    v_mul_lo_u32 v10, v4, s25
    v_lshlrev_b32 v11, 1, v9
    v_add_u32 v10, v10, v11
    v_add_u32 v11, 0, v9
    v_lshrrev_b32 v12, 5, v4
    s_mov_b32 s36, 32
    v_mul_lo_u32 v12, v12, s36
    v_lshrrev_b32 v13, 4, v11
    v_add_u32 v12, v12, v13
    v_lshlrev_b32 v60, 10, v12
    v_and_b32 v12, 31, v4
    v_lshlrev_b32 v12, 4, v12
    v_add_u32 v60, v60, v12
    v_lshrrev_b32 v12, 3, v11
    v_and_b32 v12, 1, v12
    v_lshlrev_b32 v12, 9, v12
    v_add_u32 v60, v60, v12
    v_and_b32 v12, 7, v11
    v_lshlrev_b32 v12, 1, v12
    v_add_u32 v60, v60, v12
    v_add_u32 v64, 0, v10
    v_add_u32 v11, 8, v9
    v_lshrrev_b32 v12, 5, v4
    s_mov_b32 s36, 32
    v_mul_lo_u32 v12, v12, s36
    v_lshrrev_b32 v13, 4, v11
    v_add_u32 v12, v12, v13
    v_lshlrev_b32 v61, 10, v12
    v_and_b32 v12, 31, v4
    v_lshlrev_b32 v12, 4, v12
    v_add_u32 v61, v61, v12
    v_lshrrev_b32 v12, 3, v11
    v_and_b32 v12, 1, v12
    v_lshlrev_b32 v12, 9, v12
    v_add_u32 v61, v61, v12
    v_and_b32 v12, 7, v11
    v_lshlrev_b32 v12, 1, v12
    v_add_u32 v61, v61, v12
    v_add_u32 v65, 16, v10
    v_add_u32 v11, 16, v9
    v_lshrrev_b32 v12, 5, v4
    s_mov_b32 s36, 32
    v_mul_lo_u32 v12, v12, s36
    v_lshrrev_b32 v13, 4, v11
    v_add_u32 v12, v12, v13
    v_lshlrev_b32 v62, 10, v12
    v_and_b32 v12, 31, v4
    v_lshlrev_b32 v12, 4, v12
    v_add_u32 v62, v62, v12
    v_lshrrev_b32 v12, 3, v11
    v_and_b32 v12, 1, v12
    v_lshlrev_b32 v12, 9, v12
    v_add_u32 v62, v62, v12
    v_and_b32 v12, 7, v11
    v_lshlrev_b32 v12, 1, v12
    v_add_u32 v62, v62, v12
    v_add_u32 v66, 32, v10
    v_add_u32 v11, 24, v9
    v_lshrrev_b32 v12, 5, v4
    s_mov_b32 s36, 32
    v_mul_lo_u32 v12, v12, s36
    v_lshrrev_b32 v13, 4, v11
    v_add_u32 v12, v12, v13
    v_lshlrev_b32 v63, 10, v12
    v_and_b32 v12, 31, v4
    v_lshlrev_b32 v12, 4, v12
    v_add_u32 v63, v63, v12
    v_lshrrev_b32 v12, 3, v11
    v_and_b32 v12, 1, v12
    v_lshlrev_b32 v12, 9, v12
    v_add_u32 v63, v63, v12
    v_and_b32 v12, 7, v11
    v_lshlrev_b32 v12, 1, v12
    v_add_u32 v63, v63, v12
    v_add_u32 v67, 48, v10
    buffer_load_dwordx2 v[40:41], v60, s[28:31], 0 offen
    buffer_load_dwordx2 v[42:43], v61, s[28:31], 0 offen
    buffer_load_dwordx2 v[44:45], v62, s[28:31], 0 offen
    buffer_load_dwordx2 v[46:47], v63, s[28:31], 0 offen
    buffer_load_dwordx2 v[50:51], v60, s[32:35], 0 offen
    buffer_load_dwordx2 v[52:53], v61, s[32:35], 0 offen
    buffer_load_dwordx2 v[54:55], v62, s[32:35], 0 offen
    buffer_load_dwordx2 v[56:57], v63, s[32:35], 0 offen
    s_waitcnt vmcnt(0)
    v_cvt_pk_bf16_f32 v13, v16, v16
    v_lshlrev_b32 v16, 16, v13
    v_lshlrev_b32 v13, 16, v40
    v_add_f32 v16, v16, v13
    v_cvt_pk_bf16_f32 v13, v16, v16
    v_lshlrev_b32 v16, 16, v13
    v_lshlrev_b32 v13, 16, v50
    v_add_f32 v16, v16, v13
    v_cvt_pk_bf16_f32 v13, v17, v17
    v_lshlrev_b32 v17, 16, v13
    v_and_b32 v13, 0xffff0000, v40
    v_add_f32 v17, v17, v13
    v_cvt_pk_bf16_f32 v13, v17, v17
    v_lshlrev_b32 v17, 16, v13
    v_and_b32 v13, 0xffff0000, v50
    v_add_f32 v17, v17, v13
    v_cvt_pk_bf16_f32 v13, v18, v18
    v_lshlrev_b32 v18, 16, v13
    v_lshlrev_b32 v13, 16, v41
    v_add_f32 v18, v18, v13
    v_cvt_pk_bf16_f32 v13, v18, v18
    v_lshlrev_b32 v18, 16, v13
    v_lshlrev_b32 v13, 16, v51
    v_add_f32 v18, v18, v13
    v_cvt_pk_bf16_f32 v13, v19, v19
    v_lshlrev_b32 v19, 16, v13
    v_and_b32 v13, 0xffff0000, v41
    v_add_f32 v19, v19, v13
    v_cvt_pk_bf16_f32 v13, v19, v19
    v_lshlrev_b32 v19, 16, v13
    v_and_b32 v13, 0xffff0000, v51
    v_add_f32 v19, v19, v13
    v_cvt_pk_bf16_f32 v14, v16, v17
    v_cvt_pk_bf16_f32 v15, v18, v19
    buffer_store_dwordx2 v[14:15], v64, s[12:15], 0 offen
    v_cvt_pk_bf16_f32 v13, v20, v20
    v_lshlrev_b32 v20, 16, v13
    v_lshlrev_b32 v13, 16, v42
    v_add_f32 v20, v20, v13
    v_cvt_pk_bf16_f32 v13, v20, v20
    v_lshlrev_b32 v20, 16, v13
    v_lshlrev_b32 v13, 16, v52
    v_add_f32 v20, v20, v13
    v_cvt_pk_bf16_f32 v13, v21, v21
    v_lshlrev_b32 v21, 16, v13
    v_and_b32 v13, 0xffff0000, v42
    v_add_f32 v21, v21, v13
    v_cvt_pk_bf16_f32 v13, v21, v21
    v_lshlrev_b32 v21, 16, v13
    v_and_b32 v13, 0xffff0000, v52
    v_add_f32 v21, v21, v13
    v_cvt_pk_bf16_f32 v13, v22, v22
    v_lshlrev_b32 v22, 16, v13
    v_lshlrev_b32 v13, 16, v43
    v_add_f32 v22, v22, v13
    v_cvt_pk_bf16_f32 v13, v22, v22
    v_lshlrev_b32 v22, 16, v13
    v_lshlrev_b32 v13, 16, v53
    v_add_f32 v22, v22, v13
    v_cvt_pk_bf16_f32 v13, v23, v23
    v_lshlrev_b32 v23, 16, v13
    v_and_b32 v13, 0xffff0000, v43
    v_add_f32 v23, v23, v13
    v_cvt_pk_bf16_f32 v13, v23, v23
    v_lshlrev_b32 v23, 16, v13
    v_and_b32 v13, 0xffff0000, v53
    v_add_f32 v23, v23, v13
    v_cvt_pk_bf16_f32 v14, v20, v21
    v_cvt_pk_bf16_f32 v15, v22, v23
    buffer_store_dwordx2 v[14:15], v65, s[12:15], 0 offen
    v_cvt_pk_bf16_f32 v13, v24, v24
    v_lshlrev_b32 v24, 16, v13
    v_lshlrev_b32 v13, 16, v44
    v_add_f32 v24, v24, v13
    v_cvt_pk_bf16_f32 v13, v24, v24
    v_lshlrev_b32 v24, 16, v13
    v_lshlrev_b32 v13, 16, v54
    v_add_f32 v24, v24, v13
    v_cvt_pk_bf16_f32 v13, v25, v25
    v_lshlrev_b32 v25, 16, v13
    v_and_b32 v13, 0xffff0000, v44
    v_add_f32 v25, v25, v13
    v_cvt_pk_bf16_f32 v13, v25, v25
    v_lshlrev_b32 v25, 16, v13
    v_and_b32 v13, 0xffff0000, v54
    v_add_f32 v25, v25, v13
    v_cvt_pk_bf16_f32 v13, v26, v26
    v_lshlrev_b32 v26, 16, v13
    v_lshlrev_b32 v13, 16, v45
    v_add_f32 v26, v26, v13
    v_cvt_pk_bf16_f32 v13, v26, v26
    v_lshlrev_b32 v26, 16, v13
    v_lshlrev_b32 v13, 16, v55
    v_add_f32 v26, v26, v13
    v_cvt_pk_bf16_f32 v13, v27, v27
    v_lshlrev_b32 v27, 16, v13
    v_and_b32 v13, 0xffff0000, v45
    v_add_f32 v27, v27, v13
    v_cvt_pk_bf16_f32 v13, v27, v27
    v_lshlrev_b32 v27, 16, v13
    v_and_b32 v13, 0xffff0000, v55
    v_add_f32 v27, v27, v13
    v_cvt_pk_bf16_f32 v14, v24, v25
    v_cvt_pk_bf16_f32 v15, v26, v27
    buffer_store_dwordx2 v[14:15], v66, s[12:15], 0 offen
    v_cvt_pk_bf16_f32 v13, v28, v28
    v_lshlrev_b32 v28, 16, v13
    v_lshlrev_b32 v13, 16, v46
    v_add_f32 v28, v28, v13
    v_cvt_pk_bf16_f32 v13, v28, v28
    v_lshlrev_b32 v28, 16, v13
    v_lshlrev_b32 v13, 16, v56
    v_add_f32 v28, v28, v13
    v_cvt_pk_bf16_f32 v13, v29, v29
    v_lshlrev_b32 v29, 16, v13
    v_and_b32 v13, 0xffff0000, v46
    v_add_f32 v29, v29, v13
    v_cvt_pk_bf16_f32 v13, v29, v29
    v_lshlrev_b32 v29, 16, v13
    v_and_b32 v13, 0xffff0000, v56
    v_add_f32 v29, v29, v13
    v_cvt_pk_bf16_f32 v13, v30, v30
    v_lshlrev_b32 v30, 16, v13
    v_lshlrev_b32 v13, 16, v47
    v_add_f32 v30, v30, v13
    v_cvt_pk_bf16_f32 v13, v30, v30
    v_lshlrev_b32 v30, 16, v13
    v_lshlrev_b32 v13, 16, v57
    v_add_f32 v30, v30, v13
    v_cvt_pk_bf16_f32 v13, v31, v31
    v_lshlrev_b32 v31, 16, v13
    v_and_b32 v13, 0xffff0000, v47
    v_add_f32 v31, v31, v13
    v_cvt_pk_bf16_f32 v13, v31, v31
    v_lshlrev_b32 v31, 16, v13
    v_and_b32 v13, 0xffff0000, v57
    v_add_f32 v31, v31, v13
    v_cvt_pk_bf16_f32 v14, v28, v29
    v_cvt_pk_bf16_f32 v15, v30, v31
    buffer_store_dwordx2 v[14:15], v67, s[12:15], 0 offen
L_w4_kernel_skip00:
L_end_w4_kernel:
    s_endpgm
.section .rodata,"a"
.p2align 6
.amdhsa_kernel prep_kernel
  .amdhsa_next_free_vgpr 80
  .amdhsa_next_free_sgpr 102
  .amdhsa_accum_offset 80
  .amdhsa_group_segment_fixed_size 0
  .amdhsa_kernarg_size 88
  .amdhsa_user_sgpr_count 2
  .amdhsa_user_sgpr_kernarg_segment_ptr 1
  .amdhsa_system_sgpr_workgroup_id_x 1
.end_amdhsa_kernel
.p2align 6
.amdhsa_kernel qkv_kernel
  .amdhsa_next_free_vgpr 256
  .amdhsa_next_free_sgpr 102
  .amdhsa_accum_offset 256
  .amdhsa_group_segment_fixed_size 0
  .amdhsa_kernarg_size 88
  .amdhsa_user_sgpr_count 2
  .amdhsa_user_sgpr_kernarg_segment_ptr 1
  .amdhsa_system_sgpr_workgroup_id_x 1
.end_amdhsa_kernel
.p2align 6
.amdhsa_kernel attn_kernel
  .amdhsa_next_free_vgpr 192
  .amdhsa_next_free_sgpr 102
  .amdhsa_accum_offset 192
  .amdhsa_group_segment_fixed_size 0
  .amdhsa_kernarg_size 88
  .amdhsa_user_sgpr_count 2
  .amdhsa_user_sgpr_kernarg_segment_ptr 1
  .amdhsa_system_sgpr_workgroup_id_x 1
.end_amdhsa_kernel
.p2align 6
.amdhsa_kernel wo_kernel
  .amdhsa_next_free_vgpr 256
  .amdhsa_next_free_sgpr 102
  .amdhsa_accum_offset 256
  .amdhsa_group_segment_fixed_size 0
  .amdhsa_kernarg_size 88
  .amdhsa_user_sgpr_count 2
  .amdhsa_user_sgpr_kernarg_segment_ptr 1
  .amdhsa_system_sgpr_workgroup_id_x 1
.end_amdhsa_kernel
.p2align 6
.amdhsa_kernel ln2_kernel
  .amdhsa_next_free_vgpr 64
  .amdhsa_next_free_sgpr 102
  .amdhsa_accum_offset 64
  .amdhsa_group_segment_fixed_size 0
  .amdhsa_kernarg_size 88
  .amdhsa_user_sgpr_count 2
  .amdhsa_user_sgpr_kernarg_segment_ptr 1
  .amdhsa_system_sgpr_workgroup_id_x 1
.end_amdhsa_kernel
.p2align 6
.amdhsa_kernel w1_kernel
  .amdhsa_next_free_vgpr 256
  .amdhsa_next_free_sgpr 102
  .amdhsa_accum_offset 256
  .amdhsa_group_segment_fixed_size 0
  .amdhsa_kernarg_size 88
  .amdhsa_user_sgpr_count 2
  .amdhsa_user_sgpr_kernarg_segment_ptr 1
  .amdhsa_system_sgpr_workgroup_id_x 1
.end_amdhsa_kernel
.p2align 6
.amdhsa_kernel w2_kernel
  .amdhsa_next_free_vgpr 256
  .amdhsa_next_free_sgpr 102
  .amdhsa_accum_offset 256
  .amdhsa_group_segment_fixed_size 0
  .amdhsa_kernarg_size 88
  .amdhsa_user_sgpr_count 2
  .amdhsa_user_sgpr_kernarg_segment_ptr 1
  .amdhsa_system_sgpr_workgroup_id_x 1
.end_amdhsa_kernel
.p2align 6
.amdhsa_kernel ln3_kernel
  .amdhsa_next_free_vgpr 64
  .amdhsa_next_free_sgpr 102
  .amdhsa_accum_offset 64
  .amdhsa_group_segment_fixed_size 0
  .amdhsa_kernarg_size 88
  .amdhsa_user_sgpr_count 2
  .amdhsa_user_sgpr_kernarg_segment_ptr 1
  .amdhsa_system_sgpr_workgroup_id_x 1
.end_amdhsa_kernel
.p2align 6
.amdhsa_kernel w3_kernel
  .amdhsa_next_free_vgpr 256
  .amdhsa_next_free_sgpr 102
  .amdhsa_accum_offset 256
  .amdhsa_group_segment_fixed_size 0
  .amdhsa_kernarg_size 88
  .amdhsa_user_sgpr_count 2
  .amdhsa_user_sgpr_kernarg_segment_ptr 1
  .amdhsa_system_sgpr_workgroup_id_x 1
.end_amdhsa_kernel
.p2align 6
.amdhsa_kernel w4_kernel
  .amdhsa_next_free_vgpr 256
  .amdhsa_next_free_sgpr 102
  .amdhsa_accum_offset 256
  .amdhsa_group_segment_fixed_size 0
  .amdhsa_kernarg_size 88
  .amdhsa_user_sgpr_count 2
  .amdhsa_user_sgpr_kernarg_segment_ptr 1
  .amdhsa_system_sgpr_workgroup_id_x 1
.end_amdhsa_kernel
```
